```python
import torch

def _softmax(x, axis=-1):
    return torch.softmax(x, dim=axis)
def _gelu(x):
    return torch.nn.functional.gelu(x, approximate="tanh")
def _silu(x):
    return torch.nn.functional.silu(x)
def _sigmoid(x):
    return torch.sigmoid(x)
def _layernorm(x, axis=-1, eps=1e-5):
    m = x.mean(dim=axis, keepdim=True)
    v = x.var(dim=axis, keepdim=True, unbiased=False)
    return (x - m) / torch.sqrt(v + eps)
def _scatter_add(tgt, idx, src, axis=0):
    return tgt.clone().index_add_(axis, idx, src)
def _segment_sum(src, seg, n):
    out = torch.zeros((n,) + src.shape[1:], dtype=src.dtype)
    return out.index_add_(0, seg, src)
def _pad(x, pw):
    flat = tuple(v for pair in reversed(pw) for v in pair)
    return torch.nn.functional.pad(x, flat)

kernel_name = 'standalone__mha_block_cached__near_ridge'

def setup_inputs():

    _w = (lambda a: (lambda t: t.to(torch.bfloat16) if t.is_floating_point() else t)(torch.as_tensor(a)))
    B, Sq, D = 8, 256, 640
    H, Sk, Dh = 32, 1024, 192
    return {
        "x": _w((lambda *s: torch.randn(*s, dtype=torch.bfloat16) * 0.8)(B, Sq, D)),
        "k_cache": _w((lambda *s: torch.randn(*s, dtype=torch.bfloat16) * 0.8)(B, H, Sk, Dh)),
        "v_cache": _w((lambda *s: torch.randn(*s, dtype=torch.bfloat16) * 0.05)(B, H, Sk, Dh)),
        "wq": _w((lambda *s: torch.randn(*s, dtype=torch.bfloat16) * 0.8)(D, H * Dh) * (D ** -0.5)),
        "wo": _w((lambda *s: torch.randn(*s, dtype=torch.bfloat16) * 0.05)(H * Dh, D) * ((H * Dh) ** -0.5)),
    }

def reference(x, k_cache, v_cache, wq, wo):
    B, Sq, D = x.shape
    H, Dh = 32, 192
    q = (lambda x, *d: x.permute(*d))((x @ wq).reshape(B, Sq, H, Dh), 0, 2, 1, 3)
    scores = torch.einsum("bhqd,bhkd->bhqk", q, k_cache) * (Dh ** -0.5)
    p = _softmax(scores, axis=-1)
    o = torch.einsum("bhqk,bhkd->bhqd", p, v_cache)
    return (lambda x, *d: x.permute(*d))(o, 0, 2, 1, 3).reshape(B, Sq, H * Dh) @ wo
```

```asm
; @launch kernel=attn_kernel grid=(256,1,1) block=(256,1,1) lds=163840
; @launch kernel=oproj_kernel grid=(256,1,1) block=(256,1,1) lds=163840
; @launch kernel=reduce_kernel grid=(320,1,1) block=(256,1,1) lds=0
.amdgcn_target "amdgcn-amd-amdhsa--gfx950"
.text
.globl attn_kernel
.globl oproj_kernel
.globl reduce_kernel
.p2align 8
.type attn_kernel,@function
attn_kernel:
  s_cmp_ge_u32 s2, 256
  s_cbranch_scc1 L_k1_end
  s_load_dwordx8 s[40:47], s[0:1], 0
  s_load_dwordx2 s[48:49], s[0:1], 56
  v_and_b32 v1, 63, v0
  v_lshrrev_b32 v2, 6, v0
  s_nop 0
  v_readfirstlane_b32 s24, v2
  s_and_b32 s36, s2, 7
  s_lshr_b32 s37, s2, 3
  s_and_b32 s38, s36, 1
  s_lshl_b32 s38, s38, 2
  s_and_b32 s39, s37, 3
  s_add_u32 s25, s38, s39
  s_lshr_b32 s38, s36, 1
  s_lshl_b32 s38, s38, 3
  s_lshr_b32 s39, s37, 2
  s_add_u32 s26, s38, s39
  s_and_b32 s25, s37, 7
  s_lshr_b32 s39, s37, 3
  s_lshl_b32 s38, s36, 2
  s_add_u32 s26, s38, s39
  s_lshl_b32 s27, s25, 5
  s_add_u32 s27, s27, s26
  s_mul_i32 s28, s24, 3072
  s_lshl_b32 s36, s24, 13
  s_add_u32 s37, s36, 147456
  s_add_u32 s38, s36, 32768
  s_cmp_lt_u32 s24, 2
  s_cselect_b32 s29, s37, s38
  s_mov_b32 s34, 0x3dd53b95
  s_mov_b32 s35, 0x3dd53b95
  s_mov_b32 s32, 0
  s_waitcnt lgkmcnt(0)
  s_mul_i32 s36, s25, 327680
  s_add_u32 s40, s40, s36
  s_addc_u32 s41, s41, 0
  s_mov_b32 s4, s40
  s_and_b32 s5, s41, 0xffff
  s_mov_b32 s6, 327680
  s_mov_b32 s7, 0x20000
  s_mul_i32 s36, s27, 393216
  s_add_u32 s42, s42, s36
  s_addc_u32 s43, s43, 0
  s_mov_b32 s12, s42
  s_and_b32 s13, s43, 0xffff
  s_mov_b32 s14, 393216
  s_mov_b32 s15, 0x20000
  s_add_u32 s44, s44, s36
  s_addc_u32 s45, s45, 0
  s_mov_b32 s16, s44
  s_and_b32 s17, s45, 0xffff
  s_mov_b32 s18, 393216
  s_mov_b32 s19, 0x20000
  s_mul_i32 s36, s26, 384
  s_add_u32 s46, s46, s36
  s_addc_u32 s47, s47, 0
  s_mov_b32 s8, s46
  s_and_b32 s9, s47, 0xffff
  s_mov_b32 s10, 0
  s_mov_b32 s11, 0x20000
  s_sub_u32 s10, 7864320, s36
  s_mul_i32 s36, s27, 98304
  s_add_u32 s48, s48, s36
  s_addc_u32 s49, s49, 0
  s_mov_b32 s20, s48
  s_and_b32 s21, s49, 0xffff
  s_mov_b32 s22, 98304
  s_mov_b32 s23, 0x20000
  s_mul_i32 s44, s26, 11
  s_mul_i32 s45, s25, 5
  s_add_u32 s44, s44, s45
  s_and_b32 s44, s44, 31
  s_mul_i32 s48, s44, 12288
  v_mov_b32 v64, s24
  v_mul_u32_u24 v64, 192, v64
  v_add_u32 v64, v64, v1
  v_add_u32 v64, 0, v64
  v_mul_u32_u24 v65, 2731, v64
  v_lshrrev_b32 v65, 16, v65
  v_mul_u32_u24 v68, 24, v65
  v_sub_u32 v66, v64, v68
  v_lshlrev_b32 v68, 1, v65
  v_and_b32 v68, 4, v68
  v_xor_b32 v67, v66, v68
  s_mov_b32 s36, 12288
  v_mul_lo_u32 v68, v65, s36
  v_lshlrev_b32 v67, 4, v67
  v_add_u32 v68, v68, v67
  v_add_u32 v2, 0, v68
  v_mov_b32 v64, s24
  v_mul_u32_u24 v64, 192, v64
  v_add_u32 v64, v64, v1
  v_add_u32 v64, 64, v64
  v_mul_u32_u24 v65, 2731, v64
  v_lshrrev_b32 v65, 16, v65
  v_mul_u32_u24 v68, 24, v65
  v_sub_u32 v66, v64, v68
  v_lshlrev_b32 v68, 1, v65
  v_and_b32 v68, 4, v68
  v_xor_b32 v67, v66, v68
  s_mov_b32 s36, 12288
  v_mul_lo_u32 v68, v65, s36
  v_lshlrev_b32 v67, 4, v67
  v_add_u32 v68, v68, v67
  v_add_u32 v3, 4294966272, v68
  v_mov_b32 v64, s24
  v_mul_u32_u24 v64, 192, v64
  v_add_u32 v64, v64, v1
  v_add_u32 v64, 128, v64
  v_mul_u32_u24 v65, 2731, v64
  v_lshrrev_b32 v65, 16, v65
  v_mul_u32_u24 v68, 24, v65
  v_sub_u32 v66, v64, v68
  v_lshlrev_b32 v68, 1, v65
  v_and_b32 v68, 4, v68
  v_xor_b32 v67, v66, v68
  s_mov_b32 s36, 12288
  v_mul_lo_u32 v68, v65, s36
  v_lshlrev_b32 v67, 4, v67
  v_add_u32 v68, v68, v67
  v_add_u32 v4, 4294965248, v68
  v_lshrrev_b32 v64, 3, v1
  v_add_u32 v64, 0, v64
  v_bfe_u32 v65, v64, 1, 3
  v_and_b32 v66, 7, v1
  v_xor_b32 v65, v65, v66
  v_mov_b32 v66, s24
  v_lshlrev_b32 v66, 6, v66
  v_add_u32 v64, v64, v66
  v_mul_u32_u24 v64, 1280, v64
  v_lshlrev_b32 v65, 4, v65
  v_add_u32 v64, v64, v65
  v_subrev_u32 v22, 0, v64
  v_lshrrev_b32 v64, 3, v1
  v_add_u32 v64, 8, v64
  v_bfe_u32 v65, v64, 1, 3
  v_and_b32 v66, 7, v1
  v_xor_b32 v65, v65, v66
  v_mov_b32 v66, s24
  v_lshlrev_b32 v66, 6, v66
  v_add_u32 v64, v64, v66
  v_mul_u32_u24 v64, 1280, v64
  v_lshlrev_b32 v65, 4, v65
  v_add_u32 v64, v64, v65
  v_subrev_u32 v23, 1024, v64
  v_lshrrev_b32 v64, 3, v1
  v_add_u32 v64, 16, v64
  v_bfe_u32 v65, v64, 1, 3
  v_and_b32 v66, 7, v1
  v_xor_b32 v65, v65, v66
  v_mov_b32 v66, s24
  v_lshlrev_b32 v66, 6, v66
  v_add_u32 v64, v64, v66
  v_mul_u32_u24 v64, 1280, v64
  v_lshlrev_b32 v65, 4, v65
  v_add_u32 v64, v64, v65
  v_subrev_u32 v24, 2048, v64
  v_lshrrev_b32 v64, 3, v1
  v_add_u32 v64, 24, v64
  v_bfe_u32 v65, v64, 1, 3
  v_and_b32 v66, 7, v1
  v_xor_b32 v65, v65, v66
  v_mov_b32 v66, s24
  v_lshlrev_b32 v66, 6, v66
  v_add_u32 v64, v64, v66
  v_mul_u32_u24 v64, 1280, v64
  v_lshlrev_b32 v65, 4, v65
  v_add_u32 v64, v64, v65
  v_subrev_u32 v25, 3072, v64
  v_lshrrev_b32 v64, 3, v1
  v_add_u32 v64, 32, v64
  v_bfe_u32 v65, v64, 1, 3
  v_and_b32 v66, 7, v1
  v_xor_b32 v65, v65, v66
  v_mov_b32 v66, s24
  v_lshlrev_b32 v66, 6, v66
  v_add_u32 v64, v64, v66
  v_mul_u32_u24 v64, 1280, v64
  v_lshlrev_b32 v65, 4, v65
  v_add_u32 v64, v64, v65
  v_subrev_u32 v26, 0, v64
  v_lshrrev_b32 v64, 3, v1
  v_add_u32 v64, 40, v64
  v_bfe_u32 v65, v64, 1, 3
  v_and_b32 v66, 7, v1
  v_xor_b32 v65, v65, v66
  v_mov_b32 v66, s24
  v_lshlrev_b32 v66, 6, v66
  v_add_u32 v64, v64, v66
  v_mul_u32_u24 v64, 1280, v64
  v_lshlrev_b32 v65, 4, v65
  v_add_u32 v64, v64, v65
  v_subrev_u32 v27, 1024, v64
  v_lshrrev_b32 v64, 3, v1
  v_add_u32 v64, 48, v64
  v_bfe_u32 v65, v64, 1, 3
  v_and_b32 v66, 7, v1
  v_xor_b32 v65, v65, v66
  v_mov_b32 v66, s24
  v_lshlrev_b32 v66, 6, v66
  v_add_u32 v64, v64, v66
  v_mul_u32_u24 v64, 1280, v64
  v_lshlrev_b32 v65, 4, v65
  v_add_u32 v64, v64, v65
  v_subrev_u32 v28, 2048, v64
  v_lshrrev_b32 v64, 3, v1
  v_add_u32 v64, 56, v64
  v_bfe_u32 v65, v64, 1, 3
  v_and_b32 v66, 7, v1
  v_xor_b32 v65, v65, v66
  v_mov_b32 v66, s24
  v_lshlrev_b32 v66, 6, v66
  v_add_u32 v64, v64, v66
  v_mul_u32_u24 v64, 1280, v64
  v_lshlrev_b32 v65, 4, v65
  v_add_u32 v64, v64, v65
  v_subrev_u32 v29, 3072, v64
  s_lshr_b32 s50, s2, 3
  s_and_b32 s51, s50, 7
  s_lshr_b32 s50, s50, 3
  s_add_u32 s50, s50, s51
  s_sub_u32 s51, s50, 9
  s_cmp_ge_u32 s50, 9
  s_cselect_b32 s50, s51, s50
  s_add_u32 s50, s50, 1
  s_lshl_b32 s51, s50, 1
  s_mov_b32 s38, 0
  s_add_u32 m0, s29, 0
  s_nop 0
  buffer_load_dwordx4 v22, s[4:7], s38 offen offset:0 lds
  s_add_u32 m0, s29, 0
  s_nop 0
  buffer_load_dwordx4 v23, s[4:7], s38 offen offset:1024 lds
  s_add_u32 m0, s29, 0
  s_nop 0
  buffer_load_dwordx4 v24, s[4:7], s38 offen offset:2048 lds
  s_add_u32 m0, s29, 0
  s_nop 0
  buffer_load_dwordx4 v25, s[4:7], s38 offen offset:3072 lds
  s_add_u32 m0, s29, 4096
  s_nop 0
  buffer_load_dwordx4 v26, s[4:7], s38 offen offset:0 lds
  s_add_u32 m0, s29, 4096
  s_nop 0
  buffer_load_dwordx4 v27, s[4:7], s38 offen offset:1024 lds
  s_add_u32 m0, s29, 4096
  s_nop 0
  buffer_load_dwordx4 v28, s[4:7], s38 offen offset:2048 lds
  s_add_u32 m0, s29, 4096
  s_nop 0
  buffer_load_dwordx4 v29, s[4:7], s38 offen offset:3072 lds
  s_mov_b32 s39, 0
  s_add_u32 m0, s28, 98304
  s_nop 0
  buffer_load_dwordx4 v2, s[8:11], s39 offen offset:0 lds
  s_add_u32 m0, s28, 98304
  s_nop 0
  buffer_load_dwordx4 v3, s[8:11], s39 offen offset:1024 lds
  s_add_u32 m0, s28, 98304
  s_nop 0
  buffer_load_dwordx4 v4, s[8:11], s39 offen offset:2048 lds
  s_mov_b32 s39, 393216
  s_add_u32 m0, s28, 110592
  s_nop 0
  buffer_load_dwordx4 v2, s[8:11], s39 offen offset:0 lds
  s_add_u32 m0, s28, 110592
  s_nop 0
  buffer_load_dwordx4 v3, s[8:11], s39 offen offset:1024 lds
  s_add_u32 m0, s28, 110592
  s_nop 0
  buffer_load_dwordx4 v4, s[8:11], s39 offen offset:2048 lds
  s_mul_i32 s39, s51, 393216
  s_add_u32 s51, s51, 1
  s_cmp_eq_u32 s51, 20
  s_cselect_b32 s51, 2, s51
  s_add_u32 m0, s28, 122880
  s_nop 0
  buffer_load_dwordx4 v2, s[8:11], s39 offen offset:0 lds
  s_add_u32 m0, s28, 122880
  s_nop 0
  buffer_load_dwordx4 v3, s[8:11], s39 offen offset:1024 lds
  s_add_u32 m0, s28, 122880
  s_nop 0
  buffer_load_dwordx4 v4, s[8:11], s39 offen offset:2048 lds
  v_mov_b32 v64, s24
  v_mul_u32_u24 v64, 192, v64
  v_add_u32 v64, v64, v1
  v_add_u32 v64, 0, v64
  v_mul_u32_u24 v65, 2731, v64
  v_lshrrev_b32 v65, 16, v65
  v_mul_u32_u24 v68, 24, v65
  v_sub_u32 v66, v64, v68
  v_lshrrev_b32 v68, 1, v65
  v_and_b32 v68, 7, v68
  v_xor_b32 v67, v66, v68
  s_mov_b32 s36, 384
  v_mul_lo_u32 v68, v65, s36
  v_lshlrev_b32 v67, 4, v67
  v_add_u32 v68, v68, v67
  v_add_u32 v10, 0, v68
  v_mov_b32 v64, s24
  v_mul_u32_u24 v64, 192, v64
  v_add_u32 v64, v64, v1
  v_add_u32 v64, 64, v64
  v_mul_u32_u24 v65, 2731, v64
  v_lshrrev_b32 v65, 16, v65
  v_mul_u32_u24 v68, 24, v65
  v_sub_u32 v66, v64, v68
  v_lshrrev_b32 v68, 1, v65
  v_and_b32 v68, 7, v68
  v_xor_b32 v67, v66, v68
  s_mov_b32 s36, 384
  v_mul_lo_u32 v68, v65, s36
  v_lshlrev_b32 v67, 4, v67
  v_add_u32 v68, v68, v67
  v_add_u32 v11, 4294966272, v68
  v_mov_b32 v64, s24
  v_mul_u32_u24 v64, 192, v64
  v_add_u32 v64, v64, v1
  v_add_u32 v64, 128, v64
  v_mul_u32_u24 v65, 2731, v64
  v_lshrrev_b32 v65, 16, v65
  v_mul_u32_u24 v68, 24, v65
  v_sub_u32 v66, v64, v68
  v_lshrrev_b32 v68, 1, v65
  v_and_b32 v68, 7, v68
  v_xor_b32 v67, v66, v68
  s_mov_b32 s36, 384
  v_mul_lo_u32 v68, v65, s36
  v_lshlrev_b32 v67, 4, v67
  v_add_u32 v68, v68, v67
  v_add_u32 v12, 4294965248, v68
  v_mov_b32 v64, s24
  v_mul_u32_u24 v64, 192, v64
  v_add_u32 v64, v64, v1
  v_add_u32 v64, 0, v64
  v_mul_u32_u24 v65, 2731, v64
  v_lshrrev_b32 v65, 16, v65
  v_mul_u32_u24 v68, 24, v65
  v_sub_u32 v66, v64, v68
  v_lshlrev_b32 v68, 1, v65
  v_and_b32 v68, 4, v68
  v_xor_b32 v67, v66, v68
  s_mov_b32 s36, 384
  v_mul_lo_u32 v68, v65, s36
  v_lshlrev_b32 v67, 4, v67
  v_add_u32 v68, v68, v67
  v_add_u32 v13, 0, v68
  v_mov_b32 v64, s24
  v_mul_u32_u24 v64, 192, v64
  v_add_u32 v64, v64, v1
  v_add_u32 v64, 64, v64
  v_mul_u32_u24 v65, 2731, v64
  v_lshrrev_b32 v65, 16, v65
  v_mul_u32_u24 v68, 24, v65
  v_sub_u32 v66, v64, v68
  v_lshlrev_b32 v68, 1, v65
  v_and_b32 v68, 4, v68
  v_xor_b32 v67, v66, v68
  s_mov_b32 s36, 384
  v_mul_lo_u32 v68, v65, s36
  v_lshlrev_b32 v67, 4, v67
  v_add_u32 v68, v68, v67
  v_add_u32 v14, 4294966272, v68
  v_mov_b32 v64, s24
  v_mul_u32_u24 v64, 192, v64
  v_add_u32 v64, v64, v1
  v_add_u32 v64, 128, v64
  v_mul_u32_u24 v65, 2731, v64
  v_lshrrev_b32 v65, 16, v65
  v_mul_u32_u24 v68, 24, v65
  v_sub_u32 v66, v64, v68
  v_lshlrev_b32 v68, 1, v65
  v_and_b32 v68, 4, v68
  v_xor_b32 v67, v66, v68
  s_mov_b32 s36, 384
  v_mul_lo_u32 v68, v65, s36
  v_lshlrev_b32 v67, 4, v67
  v_add_u32 v68, v68, v67
  v_add_u32 v15, 4294965248, v68
  v_and_b32 v64, 31, v1
  v_lshrrev_b32 v65, 5, v1
  v_bfe_u32 v66, v64, 1, 3
  v_xor_b32 v65, v65, v66
  v_lshlrev_b32 v65, 4, v65
  v_lshlrev_b32 v64, 7, v64
  v_add_u32 v64, s29, v64
  v_xor_b32 v66, 0, v65
  v_add_u32 v16, v64, v66
  v_xor_b32 v66, 32, v65
  v_add_u32 v17, v64, v66
  v_xor_b32 v66, 64, v65
  v_add_u32 v18, v64, v66
  v_xor_b32 v66, 96, v65
  v_add_u32 v19, v64, v66
  v_bfe_u32 v64, v1, 4, 1
  v_lshrrev_b32 v65, 5, v1
  v_bfe_u32 v66, v1, 2, 2
  v_and_b32 v67, 3, v1
  v_lshrrev_b32 v68, 1, v66
  v_mul_u32_u24 v69, 8, v65
  v_add_u32 v69, v69, v66
  v_mul_u32_u24 v69, 384, v69
  v_lshlrev_b32 v70, 5, v64
  v_add_u32 v69, v69, v70
  v_and_b32 v70, 1, v67
  v_lshlrev_b32 v70, 4, v70
  v_add_u32 v69, v69, v70
  v_lshrrev_b32 v70, 1, v67
  v_lshlrev_b32 v70, 3, v70
  v_add_u32 v69, v69, v70
  v_add_u32 v69, 98304, v69
  v_lshlrev_b32 v70, 6, v68
  v_add_u32 v20, v69, v70
  v_sub_u32 v21, v69, v70
  v_add_u32 v21, 64, v21
  s_waitcnt vmcnt(9)
  ds_read_b128 v[32:35], v16 offset:0
  ds_read_b128 v[36:39], v17 offset:0
  ds_read_b128 v[40:43], v18 offset:0
  ds_read_b128 v[44:47], v19 offset:0
  ds_read_b128 v[48:51], v16 offset:4096
  ds_read_b128 v[52:55], v17 offset:4096
  ds_read_b128 v[56:59], v18 offset:4096
  ds_read_b128 v[60:63], v19 offset:4096
  s_waitcnt lgkmcnt(0)
  s_lshl_b32 s38, s50, 7
  s_add_u32 s50, s50, 1
  s_cmp_eq_u32 s50, 10
  s_cselect_b32 s50, 1, s50
  s_add_u32 m0, s29, 0
  s_nop 0
  buffer_load_dwordx4 v22, s[4:7], s38 offen offset:0 lds
  s_add_u32 m0, s29, 0
  s_nop 0
  buffer_load_dwordx4 v23, s[4:7], s38 offen offset:1024 lds
  s_add_u32 m0, s29, 0
  s_nop 0
  buffer_load_dwordx4 v24, s[4:7], s38 offen offset:2048 lds
  s_add_u32 m0, s29, 0
  s_nop 0
  buffer_load_dwordx4 v25, s[4:7], s38 offen offset:3072 lds
  s_add_u32 m0, s29, 4096
  s_nop 0
  buffer_load_dwordx4 v26, s[4:7], s38 offen offset:0 lds
  s_add_u32 m0, s29, 4096
  s_nop 0
  buffer_load_dwordx4 v27, s[4:7], s38 offen offset:1024 lds
  s_add_u32 m0, s29, 4096
  s_nop 0
  buffer_load_dwordx4 v28, s[4:7], s38 offen offset:2048 lds
  s_add_u32 m0, s29, 4096
  s_nop 0
  buffer_load_dwordx4 v29, s[4:7], s38 offen offset:3072 lds
  s_waitcnt vmcnt(14)
  s_barrier
  ds_read_b64_tr_b16 a[224:225], v20 offset:0
  ds_read_b64_tr_b16 a[226:227], v20 offset:1536
  ds_read_b64_tr_b16 a[228:229], v21 offset:0
  ds_read_b64_tr_b16 a[230:231], v21 offset:1536
  ds_read_b64_tr_b16 a[232:233], v20 offset:128
  ds_read_b64_tr_b16 a[234:235], v20 offset:1664
  ds_read_b64_tr_b16 a[236:237], v21 offset:128
  ds_read_b64_tr_b16 a[238:239], v21 offset:1664
  s_waitcnt vmcnt(11)
  s_barrier
  s_waitcnt lgkmcnt(6)
  v_mfma_f32_32x32x16_bf16 v[64:79], a[224:227], v[32:35], 0
  s_mul_i32 s39, s51, 393216
  s_add_u32 s51, s51, 1
  s_cmp_eq_u32 s51, 20
  s_cselect_b32 s51, 2, s51
  s_add_u32 m0, s28, 135168
  s_nop 0
  buffer_load_dwordx4 v2, s[8:11], s39 offen offset:0 lds
  v_mfma_f32_32x32x16_bf16 v[80:95], a[224:227], v[48:51], 0
  ds_read_b64_tr_b16 a[240:241], v20 offset:256
  ds_read_b64_tr_b16 a[242:243], v20 offset:1792
  s_waitcnt lgkmcnt(6)
  v_mfma_f32_32x32x16_bf16 v[96:111], a[228:231], v[32:35], 0
  s_add_u32 m0, s28, 135168
  s_nop 0
  buffer_load_dwordx4 v3, s[8:11], s39 offen offset:1024 lds
  v_accvgpr_write_b32 a0, 0
  v_mfma_f32_32x32x16_bf16 v[112:127], a[228:231], v[48:51], 0
  ds_read_b64_tr_b16 a[244:245], v21 offset:256
  ds_read_b64_tr_b16 a[246:247], v21 offset:1792
  s_waitcnt lgkmcnt(6)
  v_mfma_f32_32x32x16_bf16 v[128:143], a[232:235], v[32:35], 0
  s_add_u32 m0, s28, 135168
  s_nop 0
  buffer_load_dwordx4 v4, s[8:11], s39 offen offset:2048 lds
  v_accvgpr_write_b32 a1, 0
  v_mfma_f32_32x32x16_bf16 v[144:159], a[232:235], v[48:51], 0
  ds_read_b64_tr_b16 a[224:225], v20 offset:6144
  ds_read_b64_tr_b16 a[226:227], v20 offset:7680
  s_waitcnt lgkmcnt(6)
  v_mfma_f32_32x32x16_bf16 v[160:175], a[236:239], v[32:35], 0
  v_accvgpr_write_b32 a2, 0
  v_mfma_f32_32x32x16_bf16 v[176:191], a[236:239], v[48:51], 0
  ds_read_b64_tr_b16 a[228:229], v21 offset:6144
  ds_read_b64_tr_b16 a[230:231], v21 offset:7680
  s_waitcnt lgkmcnt(6)
  v_mfma_f32_32x32x16_bf16 v[192:207], a[240:243], v[32:35], 0
  v_accvgpr_write_b32 a3, 0
  v_mfma_f32_32x32x16_bf16 v[208:223], a[240:243], v[48:51], 0
  ds_read_b64_tr_b16 a[232:233], v20 offset:6272
  ds_read_b64_tr_b16 a[234:235], v20 offset:7808
  s_waitcnt lgkmcnt(6)
  v_mfma_f32_32x32x16_bf16 v[224:239], a[244:247], v[32:35], 0
  v_accvgpr_write_b32 a4, 0
  v_mfma_f32_32x32x16_bf16 v[240:255], a[244:247], v[48:51], 0
  ds_read_b64_tr_b16 a[236:237], v21 offset:6272
  ds_read_b64_tr_b16 a[238:239], v21 offset:7808
  s_waitcnt lgkmcnt(6)
  v_mfma_f32_32x32x16_bf16 v[64:79], a[224:227], v[36:39], v[64:79]
  v_accvgpr_write_b32 a5, 0
  v_mfma_f32_32x32x16_bf16 v[80:95], a[224:227], v[52:55], v[80:95]
  ds_read_b64_tr_b16 a[240:241], v20 offset:6400
  ds_read_b64_tr_b16 a[242:243], v20 offset:7936
  s_waitcnt lgkmcnt(6)
  v_mfma_f32_32x32x16_bf16 v[96:111], a[228:231], v[36:39], v[96:111]
  v_accvgpr_write_b32 a6, 0
  v_mfma_f32_32x32x16_bf16 v[112:127], a[228:231], v[52:55], v[112:127]
  ds_read_b64_tr_b16 a[244:245], v21 offset:6400
  ds_read_b64_tr_b16 a[246:247], v21 offset:7936
  s_waitcnt lgkmcnt(6)
  v_mfma_f32_32x32x16_bf16 v[128:143], a[232:235], v[36:39], v[128:143]
  v_accvgpr_write_b32 a7, 0
  v_mfma_f32_32x32x16_bf16 v[144:159], a[232:235], v[52:55], v[144:159]
  ds_read_b64_tr_b16 a[224:225], v20 offset:12288
  ds_read_b64_tr_b16 a[226:227], v20 offset:13824
  s_waitcnt lgkmcnt(6)
  v_mfma_f32_32x32x16_bf16 v[160:175], a[236:239], v[36:39], v[160:175]
  v_accvgpr_write_b32 a8, 0
  v_mfma_f32_32x32x16_bf16 v[176:191], a[236:239], v[52:55], v[176:191]
  ds_read_b64_tr_b16 a[228:229], v21 offset:12288
  ds_read_b64_tr_b16 a[230:231], v21 offset:13824
  s_waitcnt lgkmcnt(6)
  v_mfma_f32_32x32x16_bf16 v[192:207], a[240:243], v[36:39], v[192:207]
  v_accvgpr_write_b32 a9, 0
  v_mfma_f32_32x32x16_bf16 v[208:223], a[240:243], v[52:55], v[208:223]
  ds_read_b64_tr_b16 a[232:233], v20 offset:12416
  ds_read_b64_tr_b16 a[234:235], v20 offset:13952
  s_waitcnt lgkmcnt(6)
  v_mfma_f32_32x32x16_bf16 v[224:239], a[244:247], v[36:39], v[224:239]
  v_mfma_f32_32x32x16_bf16 v[240:255], a[244:247], v[52:55], v[240:255]
  ds_read_b64_tr_b16 a[236:237], v21 offset:12416
  ds_read_b64_tr_b16 a[238:239], v21 offset:13952
  s_waitcnt vmcnt(11)
  s_barrier
  s_waitcnt lgkmcnt(6)
  v_mfma_f32_32x32x16_bf16 v[64:79], a[224:227], v[40:43], v[64:79]
  s_mul_i32 s39, s51, 393216
  s_add_u32 s51, s51, 1
  s_cmp_eq_u32 s51, 20
  s_cselect_b32 s51, 2, s51
  s_add_u32 m0, s28, 98304
  s_nop 0
  buffer_load_dwordx4 v2, s[8:11], s39 offen offset:0 lds
  v_mfma_f32_32x32x16_bf16 v[80:95], a[224:227], v[56:59], v[80:95]
  ds_read_b64_tr_b16 a[240:241], v20 offset:12544
  ds_read_b64_tr_b16 a[242:243], v20 offset:14080
  s_waitcnt lgkmcnt(6)
  v_mfma_f32_32x32x16_bf16 v[96:111], a[228:231], v[40:43], v[96:111]
  s_add_u32 m0, s28, 98304
  s_nop 0
  buffer_load_dwordx4 v3, s[8:11], s39 offen offset:1024 lds
  s_waitcnt vmcnt(5)
  ds_read_b128 a[192:195], v16 offset:0
  v_accvgpr_write_b32 a10, 0
  v_mfma_f32_32x32x16_bf16 v[112:127], a[228:231], v[56:59], v[112:127]
  ds_read_b64_tr_b16 a[244:245], v21 offset:12544
  ds_read_b64_tr_b16 a[246:247], v21 offset:14080
  ds_read_b128 a[196:199], v17 offset:0
  s_waitcnt lgkmcnt(8)
  v_mfma_f32_32x32x16_bf16 v[128:143], a[232:235], v[40:43], v[128:143]
  s_add_u32 m0, s28, 98304
  s_nop 0
  buffer_load_dwordx4 v4, s[8:11], s39 offen offset:2048 lds
  ds_read_b128 a[200:203], v18 offset:0
  v_accvgpr_write_b32 a11, 0
  v_mfma_f32_32x32x16_bf16 v[144:159], a[232:235], v[56:59], v[144:159]
  ds_read_b64_tr_b16 a[224:225], v20 offset:18432
  ds_read_b64_tr_b16 a[226:227], v20 offset:19968
  ds_read_b128 a[204:207], v19 offset:0
  s_waitcnt lgkmcnt(10)
  v_mfma_f32_32x32x16_bf16 v[160:175], a[236:239], v[40:43], v[160:175]
  ds_read_b128 a[208:211], v16 offset:4096
  v_accvgpr_write_b32 a12, 0
  v_mfma_f32_32x32x16_bf16 v[176:191], a[236:239], v[56:59], v[176:191]
  ds_read_b64_tr_b16 a[228:229], v21 offset:18432
  ds_read_b64_tr_b16 a[230:231], v21 offset:19968
  ds_read_b128 a[212:215], v17 offset:4096
  s_add_u32 s33, s48, 0
  s_sub_u32 s44, s33, 393216
  s_cmp_ge_u32 s33, 393216
  s_cselect_b32 s33, s44, s33
  s_add_u32 m0, s28, 0
  s_nop 0
  buffer_load_dwordx4 v10, s[12:15], s33 offen offset:0 nt lds
  s_waitcnt lgkmcnt(12)
  v_mfma_f32_32x32x16_bf16 v[192:207], a[240:243], v[40:43], v[192:207]
  ds_read_b128 a[216:219], v18 offset:4096
  v_accvgpr_write_b32 a13, 0
  v_mfma_f32_32x32x16_bf16 v[208:223], a[240:243], v[56:59], v[208:223]
  ds_read_b64_tr_b16 a[232:233], v20 offset:18560
  ds_read_b64_tr_b16 a[234:235], v20 offset:20096
  ds_read_b128 a[220:223], v19 offset:4096
  s_add_u32 m0, s28, 0
  s_nop 0
  buffer_load_dwordx4 v11, s[12:15], s33 offen offset:1024 nt lds
  s_waitcnt lgkmcnt(13)
  v_mfma_f32_32x32x16_bf16 v[224:239], a[244:247], v[40:43], v[224:239]
  v_accvgpr_write_b32 a14, 0
  v_mfma_f32_32x32x16_bf16 v[240:255], a[244:247], v[56:59], v[240:255]
  ds_read_b64_tr_b16 a[236:237], v21 offset:18560
  ds_read_b64_tr_b16 a[238:239], v21 offset:20096
  s_add_u32 m0, s28, 0
  s_nop 0
  buffer_load_dwordx4 v12, s[12:15], s33 offen offset:2048 nt lds
  s_waitcnt lgkmcnt(11)
  v_mfma_f32_32x32x16_bf16 v[64:79], a[224:227], v[44:47], v[64:79]
  v_accvgpr_write_b32 a15, 0
  v_mfma_f32_32x32x16_bf16 v[80:95], a[224:227], v[60:63], v[80:95]
  ds_read_b64_tr_b16 a[240:241], v20 offset:18688
  ds_read_b64_tr_b16 a[242:243], v20 offset:20224
  s_waitcnt lgkmcnt(9)
  v_mfma_f32_32x32x16_bf16 v[96:111], a[228:231], v[44:47], v[96:111]
  s_waitcnt lgkmcnt(4)
  v_accvgpr_write_b32 a16, 0
  v_mfma_f32_32x32x16_bf16 v[112:127], a[228:231], v[60:63], v[112:127]
  ds_read_b64_tr_b16 a[244:245], v21 offset:18688
  ds_read_b64_tr_b16 a[246:247], v21 offset:20224
  s_lshl_b32 s38, s50, 7
  s_add_u32 s50, s50, 1
  s_cmp_eq_u32 s50, 10
  s_cselect_b32 s50, 1, s50
  s_add_u32 m0, s29, 0
  s_nop 0
  buffer_load_dwordx4 v22, s[4:7], s38 offen offset:0 lds
  v_mfma_f32_32x32x16_bf16 v[128:143], a[232:235], v[44:47], v[128:143]
  s_add_u32 m0, s29, 0
  s_nop 0
  buffer_load_dwordx4 v23, s[4:7], s38 offen offset:1024 lds
  v_accvgpr_write_b32 a17, 0
  v_mfma_f32_32x32x16_bf16 v[144:159], a[232:235], v[60:63], v[144:159]
  ds_read_b64_tr_b16 a[224:225], v20 offset:24576
  ds_read_b64_tr_b16 a[226:227], v20 offset:26112
  s_add_u32 m0, s29, 0
  s_nop 0
  buffer_load_dwordx4 v24, s[4:7], s38 offen offset:2048 lds
  s_waitcnt lgkmcnt(6)
  v_mfma_f32_32x32x16_bf16 v[160:175], a[236:239], v[44:47], v[160:175]
  s_add_u32 m0, s29, 0
  s_nop 0
  buffer_load_dwordx4 v25, s[4:7], s38 offen offset:3072 lds
  v_accvgpr_write_b32 a18, 0
  v_mfma_f32_32x32x16_bf16 v[176:191], a[236:239], v[60:63], v[176:191]
  ds_read_b64_tr_b16 a[228:229], v21 offset:24576
  ds_read_b64_tr_b16 a[230:231], v21 offset:26112
  s_add_u32 m0, s29, 4096
  s_nop 0
  buffer_load_dwordx4 v26, s[4:7], s38 offen offset:0 lds
  s_waitcnt lgkmcnt(6)
  v_mfma_f32_32x32x16_bf16 v[192:207], a[240:243], v[44:47], v[192:207]
  s_add_u32 m0, s29, 4096
  s_nop 0
  buffer_load_dwordx4 v27, s[4:7], s38 offen offset:1024 lds
  v_accvgpr_write_b32 a19, 0
  v_mfma_f32_32x32x16_bf16 v[208:223], a[240:243], v[60:63], v[208:223]
  ds_read_b64_tr_b16 a[232:233], v20 offset:24704
  ds_read_b64_tr_b16 a[234:235], v20 offset:26240
  s_add_u32 m0, s29, 4096
  s_nop 0
  buffer_load_dwordx4 v28, s[4:7], s38 offen offset:2048 lds
  s_waitcnt lgkmcnt(6)
  v_mfma_f32_32x32x16_bf16 v[224:239], a[244:247], v[44:47], v[224:239]
  s_add_u32 m0, s29, 4096
  s_nop 0
  buffer_load_dwordx4 v29, s[4:7], s38 offen offset:3072 lds
  v_mfma_f32_32x32x16_bf16 v[240:255], a[244:247], v[60:63], v[240:255]
  ds_read_b64_tr_b16 a[236:237], v21 offset:24704
  ds_read_b64_tr_b16 a[238:239], v21 offset:26240
  s_waitcnt vmcnt(14)
  s_barrier
  s_waitcnt lgkmcnt(6)
  v_mfma_f32_32x32x16_bf16 v[64:79], a[224:227], a[192:195], v[64:79]
  s_mul_i32 s39, s51, 393216
  s_add_u32 s51, s51, 1
  s_cmp_eq_u32 s51, 20
  s_cselect_b32 s51, 2, s51
  s_add_u32 m0, s28, 110592
  s_nop 0
  buffer_load_dwordx4 v2, s[8:11], s39 offen offset:0 lds
  v_mfma_f32_32x32x16_bf16 v[80:95], a[224:227], a[208:211], v[80:95]
  ds_read_b64_tr_b16 a[240:241], v20 offset:24832
  ds_read_b64_tr_b16 a[242:243], v20 offset:26368
  s_waitcnt lgkmcnt(6)
  v_mfma_f32_32x32x16_bf16 v[96:111], a[228:231], a[192:195], v[96:111]
  s_add_u32 m0, s28, 110592
  s_nop 0
  buffer_load_dwordx4 v3, s[8:11], s39 offen offset:1024 lds
  v_accvgpr_write_b32 a20, 0
  v_mfma_f32_32x32x16_bf16 v[112:127], a[228:231], a[208:211], v[112:127]
  ds_read_b64_tr_b16 a[244:245], v21 offset:24832
  ds_read_b64_tr_b16 a[246:247], v21 offset:26368
  s_waitcnt lgkmcnt(6)
  v_mfma_f32_32x32x16_bf16 v[128:143], a[232:235], a[192:195], v[128:143]
  s_add_u32 m0, s28, 110592
  s_nop 0
  buffer_load_dwordx4 v4, s[8:11], s39 offen offset:2048 lds
  v_accvgpr_write_b32 a21, 0
  v_mfma_f32_32x32x16_bf16 v[144:159], a[232:235], a[208:211], v[144:159]
  ds_read_b64_tr_b16 a[224:225], v20 offset:30720
  ds_read_b64_tr_b16 a[226:227], v20 offset:32256
  s_waitcnt lgkmcnt(6)
  v_mfma_f32_32x32x16_bf16 v[160:175], a[236:239], a[192:195], v[160:175]
  v_accvgpr_write_b32 a22, 0
  v_mfma_f32_32x32x16_bf16 v[176:191], a[236:239], a[208:211], v[176:191]
  ds_read_b64_tr_b16 a[228:229], v21 offset:30720
  ds_read_b64_tr_b16 a[230:231], v21 offset:32256
  s_waitcnt lgkmcnt(6)
  v_mfma_f32_32x32x16_bf16 v[192:207], a[240:243], a[192:195], v[192:207]
  v_accvgpr_write_b32 a23, 0
  v_mfma_f32_32x32x16_bf16 v[208:223], a[240:243], a[208:211], v[208:223]
  ds_read_b64_tr_b16 a[232:233], v20 offset:30848
  ds_read_b64_tr_b16 a[234:235], v20 offset:32384
  s_waitcnt lgkmcnt(6)
  v_mfma_f32_32x32x16_bf16 v[224:239], a[244:247], a[192:195], v[224:239]
  v_accvgpr_write_b32 a24, 0
  v_mfma_f32_32x32x16_bf16 v[240:255], a[244:247], a[208:211], v[240:255]
  ds_read_b64_tr_b16 a[236:237], v21 offset:30848
  ds_read_b64_tr_b16 a[238:239], v21 offset:32384
  s_waitcnt lgkmcnt(6)
  v_mfma_f32_32x32x16_bf16 v[64:79], a[224:227], a[196:199], v[64:79]
  v_accvgpr_write_b32 a25, 0
  v_mfma_f32_32x32x16_bf16 v[80:95], a[224:227], a[212:215], v[80:95]
  ds_read_b64_tr_b16 a[240:241], v20 offset:30976
  ds_read_b64_tr_b16 a[242:243], v20 offset:32512
  s_waitcnt lgkmcnt(6)
  v_mfma_f32_32x32x16_bf16 v[96:111], a[228:231], a[196:199], v[96:111]
  v_accvgpr_write_b32 a26, 0
  v_mfma_f32_32x32x16_bf16 v[112:127], a[228:231], a[212:215], v[112:127]
  ds_read_b64_tr_b16 a[244:245], v21 offset:30976
  ds_read_b64_tr_b16 a[246:247], v21 offset:32512
  s_waitcnt lgkmcnt(6)
  v_mfma_f32_32x32x16_bf16 v[128:143], a[232:235], a[196:199], v[128:143]
  v_accvgpr_write_b32 a27, 0
  v_mfma_f32_32x32x16_bf16 v[144:159], a[232:235], a[212:215], v[144:159]
  ds_read_b64_tr_b16 a[224:225], v20 offset:36864
  ds_read_b64_tr_b16 a[226:227], v20 offset:38400
  s_waitcnt lgkmcnt(6)
  v_mfma_f32_32x32x16_bf16 v[160:175], a[236:239], a[196:199], v[160:175]
  v_accvgpr_write_b32 a28, 0
  v_mfma_f32_32x32x16_bf16 v[176:191], a[236:239], a[212:215], v[176:191]
  ds_read_b64_tr_b16 a[228:229], v21 offset:36864
  ds_read_b64_tr_b16 a[230:231], v21 offset:38400
  s_waitcnt lgkmcnt(6)
  v_mfma_f32_32x32x16_bf16 v[192:207], a[240:243], a[196:199], v[192:207]
  v_accvgpr_write_b32 a29, 0
  v_mfma_f32_32x32x16_bf16 v[208:223], a[240:243], a[212:215], v[208:223]
  ds_read_b64_tr_b16 a[232:233], v20 offset:36992
  ds_read_b64_tr_b16 a[234:235], v20 offset:38528
  s_waitcnt lgkmcnt(6)
  v_mfma_f32_32x32x16_bf16 v[224:239], a[244:247], a[196:199], v[224:239]
  v_mfma_f32_32x32x16_bf16 v[240:255], a[244:247], a[212:215], v[240:255]
  ds_read_b64_tr_b16 a[236:237], v21 offset:36992
  ds_read_b64_tr_b16 a[238:239], v21 offset:38528
  s_waitcnt vmcnt(14)
  s_barrier
  s_waitcnt lgkmcnt(6)
  v_mfma_f32_32x32x16_bf16 v[64:79], a[224:227], a[200:203], v[64:79]
  s_mul_i32 s39, s51, 393216
  s_add_u32 s51, s51, 1
  s_cmp_eq_u32 s51, 20
  s_cselect_b32 s51, 2, s51
  s_add_u32 m0, s28, 122880
  s_nop 0
  buffer_load_dwordx4 v2, s[8:11], s39 offen offset:0 lds
  v_mfma_f32_32x32x16_bf16 v[80:95], a[224:227], a[216:219], v[80:95]
  ds_read_b64_tr_b16 a[240:241], v20 offset:37120
  ds_read_b64_tr_b16 a[242:243], v20 offset:38656
  s_waitcnt lgkmcnt(6)
  v_mfma_f32_32x32x16_bf16 v[96:111], a[228:231], a[200:203], v[96:111]
  s_add_u32 m0, s28, 122880
  s_nop 0
  buffer_load_dwordx4 v3, s[8:11], s39 offen offset:1024 lds
  s_waitcnt vmcnt(5)
  ds_read_b128 v[32:35], v16 offset:0
  v_accvgpr_write_b32 a30, 0
  v_mfma_f32_32x32x16_bf16 v[112:127], a[228:231], a[216:219], v[112:127]
  ds_read_b64_tr_b16 a[244:245], v21 offset:37120
  ds_read_b64_tr_b16 a[246:247], v21 offset:38656
  ds_read_b128 v[36:39], v17 offset:0
  s_waitcnt lgkmcnt(8)
  v_mfma_f32_32x32x16_bf16 v[128:143], a[232:235], a[200:203], v[128:143]
  s_add_u32 m0, s28, 122880
  s_nop 0
  buffer_load_dwordx4 v4, s[8:11], s39 offen offset:2048 lds
  ds_read_b128 v[40:43], v18 offset:0
  v_accvgpr_write_b32 a31, 0
  v_mfma_f32_32x32x16_bf16 v[144:159], a[232:235], a[216:219], v[144:159]
  ds_read_b64_tr_b16 a[224:225], v20 offset:43008
  ds_read_b64_tr_b16 a[226:227], v20 offset:44544
  ds_read_b128 v[44:47], v19 offset:0
  s_waitcnt lgkmcnt(10)
  v_mfma_f32_32x32x16_bf16 v[160:175], a[236:239], a[200:203], v[160:175]
  ds_read_b128 v[48:51], v16 offset:4096
  v_accvgpr_write_b32 a32, 0
  v_mfma_f32_32x32x16_bf16 v[176:191], a[236:239], a[216:219], v[176:191]
  ds_read_b64_tr_b16 a[228:229], v21 offset:43008
  ds_read_b64_tr_b16 a[230:231], v21 offset:44544
  ds_read_b128 v[52:55], v17 offset:4096
  s_add_u32 s33, s48, 12288
  s_sub_u32 s44, s33, 393216
  s_cmp_ge_u32 s33, 393216
  s_cselect_b32 s33, s44, s33
  s_add_u32 m0, s28, 12288
  s_nop 0
  buffer_load_dwordx4 v10, s[12:15], s33 offen offset:0 nt lds
  s_waitcnt lgkmcnt(12)
  v_mfma_f32_32x32x16_bf16 v[192:207], a[240:243], a[200:203], v[192:207]
  ds_read_b128 v[56:59], v18 offset:4096
  v_accvgpr_write_b32 a33, 0
  v_mfma_f32_32x32x16_bf16 v[208:223], a[240:243], a[216:219], v[208:223]
  ds_read_b64_tr_b16 a[232:233], v20 offset:43136
  ds_read_b64_tr_b16 a[234:235], v20 offset:44672
  ds_read_b128 v[60:63], v19 offset:4096
  s_add_u32 m0, s28, 12288
  s_nop 0
  buffer_load_dwordx4 v11, s[12:15], s33 offen offset:1024 nt lds
  s_waitcnt lgkmcnt(13)
  v_mfma_f32_32x32x16_bf16 v[224:239], a[244:247], a[200:203], v[224:239]
  v_accvgpr_write_b32 a34, 0
  v_mfma_f32_32x32x16_bf16 v[240:255], a[244:247], a[216:219], v[240:255]
  ds_read_b64_tr_b16 a[236:237], v21 offset:43136
  ds_read_b64_tr_b16 a[238:239], v21 offset:44672
  s_add_u32 m0, s28, 12288
  s_nop 0
  buffer_load_dwordx4 v12, s[12:15], s33 offen offset:2048 nt lds
  s_waitcnt lgkmcnt(11)
  v_mfma_f32_32x32x16_bf16 v[64:79], a[224:227], a[204:207], v[64:79]
  v_accvgpr_write_b32 a35, 0
  v_mfma_f32_32x32x16_bf16 v[80:95], a[224:227], a[220:223], v[80:95]
  ds_read_b64_tr_b16 a[240:241], v20 offset:43264
  ds_read_b64_tr_b16 a[242:243], v20 offset:44800
  s_waitcnt lgkmcnt(9)
  v_mfma_f32_32x32x16_bf16 v[96:111], a[228:231], a[204:207], v[96:111]
  s_waitcnt lgkmcnt(4)
  v_accvgpr_write_b32 a36, 0
  v_mfma_f32_32x32x16_bf16 v[112:127], a[228:231], a[220:223], v[112:127]
  ds_read_b64_tr_b16 a[244:245], v21 offset:43264
  ds_read_b64_tr_b16 a[246:247], v21 offset:44800
  s_lshl_b32 s38, s50, 7
  s_add_u32 s50, s50, 1
  s_cmp_eq_u32 s50, 10
  s_cselect_b32 s50, 1, s50
  s_add_u32 m0, s29, 0
  s_nop 0
  buffer_load_dwordx4 v22, s[4:7], s38 offen offset:0 lds
  v_mfma_f32_32x32x16_bf16 v[128:143], a[232:235], a[204:207], v[128:143]
  s_add_u32 m0, s29, 0
  s_nop 0
  buffer_load_dwordx4 v23, s[4:7], s38 offen offset:1024 lds
  v_accvgpr_write_b32 a37, 0
  v_mfma_f32_32x32x16_bf16 v[144:159], a[232:235], a[220:223], v[144:159]
  ds_read_b64_tr_b16 a[224:225], v20 offset:0
  ds_read_b64_tr_b16 a[226:227], v20 offset:1536
  s_add_u32 m0, s29, 0
  s_nop 0
  buffer_load_dwordx4 v24, s[4:7], s38 offen offset:2048 lds
  s_waitcnt lgkmcnt(6)
  v_mfma_f32_32x32x16_bf16 v[160:175], a[236:239], a[204:207], v[160:175]
  s_add_u32 m0, s29, 0
  s_nop 0
  buffer_load_dwordx4 v25, s[4:7], s38 offen offset:3072 lds
  v_accvgpr_write_b32 a38, 0
  v_mfma_f32_32x32x16_bf16 v[176:191], a[236:239], a[220:223], v[176:191]
  ds_read_b64_tr_b16 a[228:229], v21 offset:0
  ds_read_b64_tr_b16 a[230:231], v21 offset:1536
  s_add_u32 m0, s29, 4096
  s_nop 0
  buffer_load_dwordx4 v26, s[4:7], s38 offen offset:0 lds
  s_waitcnt lgkmcnt(6)
  v_mfma_f32_32x32x16_bf16 v[192:207], a[240:243], a[204:207], v[192:207]
  s_add_u32 m0, s29, 4096
  s_nop 0
  buffer_load_dwordx4 v27, s[4:7], s38 offen offset:1024 lds
  v_accvgpr_write_b32 a39, 0
  v_mfma_f32_32x32x16_bf16 v[208:223], a[240:243], a[220:223], v[208:223]
  ds_read_b64_tr_b16 a[232:233], v20 offset:128
  ds_read_b64_tr_b16 a[234:235], v20 offset:1664
  s_add_u32 m0, s29, 4096
  s_nop 0
  buffer_load_dwordx4 v28, s[4:7], s38 offen offset:2048 lds
  s_waitcnt lgkmcnt(6)
  v_mfma_f32_32x32x16_bf16 v[224:239], a[244:247], a[204:207], v[224:239]
  s_add_u32 m0, s29, 4096
  s_nop 0
  buffer_load_dwordx4 v29, s[4:7], s38 offen offset:3072 lds
  v_mfma_f32_32x32x16_bf16 v[240:255], a[244:247], a[220:223], v[240:255]
  ds_read_b64_tr_b16 a[236:237], v21 offset:128
  ds_read_b64_tr_b16 a[238:239], v21 offset:1664
  s_waitcnt vmcnt(14)
  s_barrier
  s_waitcnt lgkmcnt(6)
  v_mfma_f32_32x32x16_bf16 v[64:79], a[224:227], v[32:35], v[64:79]
  s_mul_i32 s39, s51, 393216
  s_add_u32 s51, s51, 1
  s_cmp_eq_u32 s51, 20
  s_cselect_b32 s51, 2, s51
  s_add_u32 m0, s28, 135168
  s_nop 0
  buffer_load_dwordx4 v2, s[8:11], s39 offen offset:0 lds
  v_mfma_f32_32x32x16_bf16 v[80:95], a[224:227], v[48:51], v[80:95]
  ds_read_b64_tr_b16 a[240:241], v20 offset:256
  ds_read_b64_tr_b16 a[242:243], v20 offset:1792
  s_waitcnt lgkmcnt(6)
  v_mfma_f32_32x32x16_bf16 v[96:111], a[228:231], v[32:35], v[96:111]
  s_add_u32 m0, s28, 135168
  s_nop 0
  buffer_load_dwordx4 v3, s[8:11], s39 offen offset:1024 lds
  v_accvgpr_write_b32 a40, 0
  v_mfma_f32_32x32x16_bf16 v[112:127], a[228:231], v[48:51], v[112:127]
  ds_read_b64_tr_b16 a[244:245], v21 offset:256
  ds_read_b64_tr_b16 a[246:247], v21 offset:1792
  s_waitcnt lgkmcnt(6)
  v_mfma_f32_32x32x16_bf16 v[128:143], a[232:235], v[32:35], v[128:143]
  s_add_u32 m0, s28, 135168
  s_nop 0
  buffer_load_dwordx4 v4, s[8:11], s39 offen offset:2048 lds
  v_accvgpr_write_b32 a41, 0
  v_mfma_f32_32x32x16_bf16 v[144:159], a[232:235], v[48:51], v[144:159]
  ds_read_b64_tr_b16 a[224:225], v20 offset:6144
  ds_read_b64_tr_b16 a[226:227], v20 offset:7680
  s_waitcnt lgkmcnt(6)
  v_mfma_f32_32x32x16_bf16 v[160:175], a[236:239], v[32:35], v[160:175]
  v_accvgpr_write_b32 a42, 0
  v_mfma_f32_32x32x16_bf16 v[176:191], a[236:239], v[48:51], v[176:191]
  ds_read_b64_tr_b16 a[228:229], v21 offset:6144
  ds_read_b64_tr_b16 a[230:231], v21 offset:7680
  s_waitcnt lgkmcnt(6)
  v_mfma_f32_32x32x16_bf16 v[192:207], a[240:243], v[32:35], v[192:207]
  v_accvgpr_write_b32 a43, 0
  v_mfma_f32_32x32x16_bf16 v[208:223], a[240:243], v[48:51], v[208:223]
  ds_read_b64_tr_b16 a[232:233], v20 offset:6272
  ds_read_b64_tr_b16 a[234:235], v20 offset:7808
  s_waitcnt lgkmcnt(6)
  v_mfma_f32_32x32x16_bf16 v[224:239], a[244:247], v[32:35], v[224:239]
  v_accvgpr_write_b32 a44, 0
  v_mfma_f32_32x32x16_bf16 v[240:255], a[244:247], v[48:51], v[240:255]
  ds_read_b64_tr_b16 a[236:237], v21 offset:6272
  ds_read_b64_tr_b16 a[238:239], v21 offset:7808
  s_waitcnt lgkmcnt(6)
  v_mfma_f32_32x32x16_bf16 v[64:79], a[224:227], v[36:39], v[64:79]
  v_accvgpr_write_b32 a45, 0
  v_mfma_f32_32x32x16_bf16 v[80:95], a[224:227], v[52:55], v[80:95]
  ds_read_b64_tr_b16 a[240:241], v20 offset:6400
  ds_read_b64_tr_b16 a[242:243], v20 offset:7936
  s_waitcnt lgkmcnt(6)
  v_mfma_f32_32x32x16_bf16 v[96:111], a[228:231], v[36:39], v[96:111]
  v_accvgpr_write_b32 a46, 0
  v_mfma_f32_32x32x16_bf16 v[112:127], a[228:231], v[52:55], v[112:127]
  ds_read_b64_tr_b16 a[244:245], v21 offset:6400
  ds_read_b64_tr_b16 a[246:247], v21 offset:7936
  s_waitcnt lgkmcnt(6)
  v_mfma_f32_32x32x16_bf16 v[128:143], a[232:235], v[36:39], v[128:143]
  v_accvgpr_write_b32 a47, 0
  v_mfma_f32_32x32x16_bf16 v[144:159], a[232:235], v[52:55], v[144:159]
  ds_read_b64_tr_b16 a[224:225], v20 offset:12288
  ds_read_b64_tr_b16 a[226:227], v20 offset:13824
  s_waitcnt lgkmcnt(6)
  v_mfma_f32_32x32x16_bf16 v[160:175], a[236:239], v[36:39], v[160:175]
  v_accvgpr_write_b32 a48, 0
  v_mfma_f32_32x32x16_bf16 v[176:191], a[236:239], v[52:55], v[176:191]
  ds_read_b64_tr_b16 a[228:229], v21 offset:12288
  ds_read_b64_tr_b16 a[230:231], v21 offset:13824
  s_waitcnt lgkmcnt(6)
  v_mfma_f32_32x32x16_bf16 v[192:207], a[240:243], v[36:39], v[192:207]
  v_accvgpr_write_b32 a49, 0
  v_mfma_f32_32x32x16_bf16 v[208:223], a[240:243], v[52:55], v[208:223]
  ds_read_b64_tr_b16 a[232:233], v20 offset:12416
  ds_read_b64_tr_b16 a[234:235], v20 offset:13952
  s_waitcnt lgkmcnt(6)
  v_mfma_f32_32x32x16_bf16 v[224:239], a[244:247], v[36:39], v[224:239]
  v_mfma_f32_32x32x16_bf16 v[240:255], a[244:247], v[52:55], v[240:255]
  ds_read_b64_tr_b16 a[236:237], v21 offset:12416
  ds_read_b64_tr_b16 a[238:239], v21 offset:13952
  s_waitcnt vmcnt(14)
  s_barrier
  s_waitcnt lgkmcnt(6)
  v_mfma_f32_32x32x16_bf16 v[64:79], a[224:227], v[40:43], v[64:79]
  s_mul_i32 s39, s51, 393216
  s_add_u32 s51, s51, 1
  s_cmp_eq_u32 s51, 20
  s_cselect_b32 s51, 2, s51
  s_add_u32 m0, s28, 98304
  s_nop 0
  buffer_load_dwordx4 v2, s[8:11], s39 offen offset:0 lds
  v_mfma_f32_32x32x16_bf16 v[80:95], a[224:227], v[56:59], v[80:95]
  ds_read_b64_tr_b16 a[240:241], v20 offset:12544
  ds_read_b64_tr_b16 a[242:243], v20 offset:14080
  s_waitcnt lgkmcnt(6)
  v_mfma_f32_32x32x16_bf16 v[96:111], a[228:231], v[40:43], v[96:111]
  s_add_u32 m0, s28, 98304
  s_nop 0
  buffer_load_dwordx4 v3, s[8:11], s39 offen offset:1024 lds
  s_waitcnt vmcnt(5)
  ds_read_b128 a[192:195], v16 offset:0
  v_accvgpr_write_b32 a50, 0
  v_mfma_f32_32x32x16_bf16 v[112:127], a[228:231], v[56:59], v[112:127]
  ds_read_b64_tr_b16 a[244:245], v21 offset:12544
  ds_read_b64_tr_b16 a[246:247], v21 offset:14080
  ds_read_b128 a[196:199], v17 offset:0
  s_waitcnt lgkmcnt(8)
  v_mfma_f32_32x32x16_bf16 v[128:143], a[232:235], v[40:43], v[128:143]
  s_add_u32 m0, s28, 98304
  s_nop 0
  buffer_load_dwordx4 v4, s[8:11], s39 offen offset:2048 lds
  ds_read_b128 a[200:203], v18 offset:0
  v_accvgpr_write_b32 a51, 0
  v_mfma_f32_32x32x16_bf16 v[144:159], a[232:235], v[56:59], v[144:159]
  ds_read_b64_tr_b16 a[224:225], v20 offset:18432
  ds_read_b64_tr_b16 a[226:227], v20 offset:19968
  ds_read_b128 a[204:207], v19 offset:0
  s_waitcnt lgkmcnt(10)
  v_mfma_f32_32x32x16_bf16 v[160:175], a[236:239], v[40:43], v[160:175]
  ds_read_b128 a[208:211], v16 offset:4096
  v_accvgpr_write_b32 a52, 0
  v_mfma_f32_32x32x16_bf16 v[176:191], a[236:239], v[56:59], v[176:191]
  ds_read_b64_tr_b16 a[228:229], v21 offset:18432
  ds_read_b64_tr_b16 a[230:231], v21 offset:19968
  ds_read_b128 a[212:215], v17 offset:4096
  s_add_u32 s33, s48, 0
  s_sub_u32 s44, s33, 393216
  s_cmp_ge_u32 s33, 393216
  s_cselect_b32 s33, s44, s33
  s_add_u32 m0, s28, 73728
  s_nop 0
  buffer_load_dwordx4 v13, s[16:19], s33 offen offset:0 nt lds
  s_waitcnt lgkmcnt(12)
  v_mfma_f32_32x32x16_bf16 v[192:207], a[240:243], v[40:43], v[192:207]
  ds_read_b128 a[216:219], v18 offset:4096
  v_accvgpr_write_b32 a53, 0
  v_mfma_f32_32x32x16_bf16 v[208:223], a[240:243], v[56:59], v[208:223]
  ds_read_b64_tr_b16 a[232:233], v20 offset:18560
  ds_read_b64_tr_b16 a[234:235], v20 offset:20096
  ds_read_b128 a[220:223], v19 offset:4096
  s_add_u32 m0, s28, 73728
  s_nop 0
  buffer_load_dwordx4 v14, s[16:19], s33 offen offset:1024 nt lds
  s_waitcnt lgkmcnt(13)
  v_mfma_f32_32x32x16_bf16 v[224:239], a[244:247], v[40:43], v[224:239]
  v_accvgpr_write_b32 a54, 0
  v_mfma_f32_32x32x16_bf16 v[240:255], a[244:247], v[56:59], v[240:255]
  ds_read_b64_tr_b16 a[236:237], v21 offset:18560
  ds_read_b64_tr_b16 a[238:239], v21 offset:20096
  s_add_u32 m0, s28, 73728
  s_nop 0
  buffer_load_dwordx4 v15, s[16:19], s33 offen offset:2048 nt lds
  s_waitcnt lgkmcnt(11)
  v_mfma_f32_32x32x16_bf16 v[64:79], a[224:227], v[44:47], v[64:79]
  v_accvgpr_write_b32 a55, 0
  v_mfma_f32_32x32x16_bf16 v[80:95], a[224:227], v[60:63], v[80:95]
  ds_read_b64_tr_b16 a[240:241], v20 offset:18688
  ds_read_b64_tr_b16 a[242:243], v20 offset:20224
  s_waitcnt lgkmcnt(9)
  v_mfma_f32_32x32x16_bf16 v[96:111], a[228:231], v[44:47], v[96:111]
  s_waitcnt lgkmcnt(4)
  v_accvgpr_write_b32 a56, 0
  v_mfma_f32_32x32x16_bf16 v[112:127], a[228:231], v[60:63], v[112:127]
  ds_read_b64_tr_b16 a[244:245], v21 offset:18688
  ds_read_b64_tr_b16 a[246:247], v21 offset:20224
  s_lshl_b32 s38, s50, 7
  s_add_u32 s50, s50, 1
  s_cmp_eq_u32 s50, 10
  s_cselect_b32 s50, 1, s50
  s_add_u32 m0, s29, 0
  s_nop 0
  buffer_load_dwordx4 v22, s[4:7], s38 offen offset:0 lds
  v_mfma_f32_32x32x16_bf16 v[128:143], a[232:235], v[44:47], v[128:143]
  s_add_u32 m0, s29, 0
  s_nop 0
  buffer_load_dwordx4 v23, s[4:7], s38 offen offset:1024 lds
  v_accvgpr_write_b32 a57, 0
  v_mfma_f32_32x32x16_bf16 v[144:159], a[232:235], v[60:63], v[144:159]
  ds_read_b64_tr_b16 a[224:225], v20 offset:24576
  ds_read_b64_tr_b16 a[226:227], v20 offset:26112
  s_add_u32 m0, s29, 0
  s_nop 0
  buffer_load_dwordx4 v24, s[4:7], s38 offen offset:2048 lds
  s_waitcnt lgkmcnt(6)
  v_mfma_f32_32x32x16_bf16 v[160:175], a[236:239], v[44:47], v[160:175]
  s_add_u32 m0, s29, 0
  s_nop 0
  buffer_load_dwordx4 v25, s[4:7], s38 offen offset:3072 lds
  v_accvgpr_write_b32 a58, 0
  v_mfma_f32_32x32x16_bf16 v[176:191], a[236:239], v[60:63], v[176:191]
  ds_read_b64_tr_b16 a[228:229], v21 offset:24576
  ds_read_b64_tr_b16 a[230:231], v21 offset:26112
  s_add_u32 m0, s29, 4096
  s_nop 0
  buffer_load_dwordx4 v26, s[4:7], s38 offen offset:0 lds
  s_waitcnt lgkmcnt(6)
  v_mfma_f32_32x32x16_bf16 v[192:207], a[240:243], v[44:47], v[192:207]
  s_add_u32 m0, s29, 4096
  s_nop 0
  buffer_load_dwordx4 v27, s[4:7], s38 offen offset:1024 lds
  v_accvgpr_write_b32 a59, 0
  v_mfma_f32_32x32x16_bf16 v[208:223], a[240:243], v[60:63], v[208:223]
  ds_read_b64_tr_b16 a[232:233], v20 offset:24704
  ds_read_b64_tr_b16 a[234:235], v20 offset:26240
  s_add_u32 m0, s29, 4096
  s_nop 0
  buffer_load_dwordx4 v28, s[4:7], s38 offen offset:2048 lds
  s_waitcnt lgkmcnt(6)
  v_mfma_f32_32x32x16_bf16 v[224:239], a[244:247], v[44:47], v[224:239]
  s_add_u32 m0, s29, 4096
  s_nop 0
  buffer_load_dwordx4 v29, s[4:7], s38 offen offset:3072 lds
  v_mfma_f32_32x32x16_bf16 v[240:255], a[244:247], v[60:63], v[240:255]
  ds_read_b64_tr_b16 a[236:237], v21 offset:24704
  ds_read_b64_tr_b16 a[238:239], v21 offset:26240
  s_waitcnt vmcnt(14)
  s_barrier
  s_waitcnt lgkmcnt(6)
  v_mfma_f32_32x32x16_bf16 v[64:79], a[224:227], a[192:195], v[64:79]
  s_mul_i32 s39, s51, 393216
  s_add_u32 s51, s51, 1
  s_cmp_eq_u32 s51, 20
  s_cselect_b32 s51, 2, s51
  s_add_u32 m0, s28, 110592
  s_nop 0
  buffer_load_dwordx4 v2, s[8:11], s39 offen offset:0 lds
  v_mfma_f32_32x32x16_bf16 v[80:95], a[224:227], a[208:211], v[80:95]
  ds_read_b64_tr_b16 a[240:241], v20 offset:24832
  ds_read_b64_tr_b16 a[242:243], v20 offset:26368
  s_waitcnt lgkmcnt(6)
  v_mfma_f32_32x32x16_bf16 v[96:111], a[228:231], a[192:195], v[96:111]
  s_add_u32 m0, s28, 110592
  s_nop 0
  buffer_load_dwordx4 v3, s[8:11], s39 offen offset:1024 lds
  v_accvgpr_write_b32 a60, 0
  v_mfma_f32_32x32x16_bf16 v[112:127], a[228:231], a[208:211], v[112:127]
  ds_read_b64_tr_b16 a[244:245], v21 offset:24832
  ds_read_b64_tr_b16 a[246:247], v21 offset:26368
  s_waitcnt lgkmcnt(6)
  v_mfma_f32_32x32x16_bf16 v[128:143], a[232:235], a[192:195], v[128:143]
  s_add_u32 m0, s28, 110592
  s_nop 0
  buffer_load_dwordx4 v4, s[8:11], s39 offen offset:2048 lds
  v_accvgpr_write_b32 a61, 0
  v_mfma_f32_32x32x16_bf16 v[144:159], a[232:235], a[208:211], v[144:159]
  ds_read_b64_tr_b16 a[224:225], v20 offset:30720
  ds_read_b64_tr_b16 a[226:227], v20 offset:32256
  s_waitcnt lgkmcnt(6)
  v_mfma_f32_32x32x16_bf16 v[160:175], a[236:239], a[192:195], v[160:175]
  v_accvgpr_write_b32 a62, 0
  v_mfma_f32_32x32x16_bf16 v[176:191], a[236:239], a[208:211], v[176:191]
  ds_read_b64_tr_b16 a[228:229], v21 offset:30720
  ds_read_b64_tr_b16 a[230:231], v21 offset:32256
  s_waitcnt lgkmcnt(6)
  v_mfma_f32_32x32x16_bf16 v[192:207], a[240:243], a[192:195], v[192:207]
  v_accvgpr_write_b32 a63, 0
  v_mfma_f32_32x32x16_bf16 v[208:223], a[240:243], a[208:211], v[208:223]
  ds_read_b64_tr_b16 a[232:233], v20 offset:30848
  ds_read_b64_tr_b16 a[234:235], v20 offset:32384
  s_waitcnt lgkmcnt(6)
  v_mfma_f32_32x32x16_bf16 v[224:239], a[244:247], a[192:195], v[224:239]
  v_accvgpr_write_b32 a64, 0
  v_mfma_f32_32x32x16_bf16 v[240:255], a[244:247], a[208:211], v[240:255]
  ds_read_b64_tr_b16 a[236:237], v21 offset:30848
  ds_read_b64_tr_b16 a[238:239], v21 offset:32384
  s_waitcnt lgkmcnt(6)
  v_mfma_f32_32x32x16_bf16 v[64:79], a[224:227], a[196:199], v[64:79]
  v_accvgpr_write_b32 a65, 0
  v_mfma_f32_32x32x16_bf16 v[80:95], a[224:227], a[212:215], v[80:95]
  ds_read_b64_tr_b16 a[240:241], v20 offset:30976
  ds_read_b64_tr_b16 a[242:243], v20 offset:32512
  s_waitcnt lgkmcnt(6)
  v_mfma_f32_32x32x16_bf16 v[96:111], a[228:231], a[196:199], v[96:111]
  v_accvgpr_write_b32 a66, 0
  v_mfma_f32_32x32x16_bf16 v[112:127], a[228:231], a[212:215], v[112:127]
  ds_read_b64_tr_b16 a[244:245], v21 offset:30976
  ds_read_b64_tr_b16 a[246:247], v21 offset:32512
  s_waitcnt lgkmcnt(6)
  v_mfma_f32_32x32x16_bf16 v[128:143], a[232:235], a[196:199], v[128:143]
  v_accvgpr_write_b32 a67, 0
  v_mfma_f32_32x32x16_bf16 v[144:159], a[232:235], a[212:215], v[144:159]
  ds_read_b64_tr_b16 a[224:225], v20 offset:36864
  ds_read_b64_tr_b16 a[226:227], v20 offset:38400
  s_waitcnt lgkmcnt(6)
  v_mfma_f32_32x32x16_bf16 v[160:175], a[236:239], a[196:199], v[160:175]
  v_accvgpr_write_b32 a68, 0
  v_mfma_f32_32x32x16_bf16 v[176:191], a[236:239], a[212:215], v[176:191]
  ds_read_b64_tr_b16 a[228:229], v21 offset:36864
  ds_read_b64_tr_b16 a[230:231], v21 offset:38400
  s_waitcnt lgkmcnt(6)
  v_mfma_f32_32x32x16_bf16 v[192:207], a[240:243], a[196:199], v[192:207]
  v_accvgpr_write_b32 a69, 0
  v_mfma_f32_32x32x16_bf16 v[208:223], a[240:243], a[212:215], v[208:223]
  ds_read_b64_tr_b16 a[232:233], v20 offset:36992
  ds_read_b64_tr_b16 a[234:235], v20 offset:38528
  s_waitcnt lgkmcnt(6)
  v_mfma_f32_32x32x16_bf16 v[224:239], a[244:247], a[196:199], v[224:239]
  v_mfma_f32_32x32x16_bf16 v[240:255], a[244:247], a[212:215], v[240:255]
  ds_read_b64_tr_b16 a[236:237], v21 offset:36992
  ds_read_b64_tr_b16 a[238:239], v21 offset:38528
  s_waitcnt vmcnt(14)
  s_barrier
  s_waitcnt lgkmcnt(6)
  v_mfma_f32_32x32x16_bf16 v[64:79], a[224:227], a[200:203], v[64:79]
  s_mul_i32 s39, s51, 393216
  s_add_u32 s51, s51, 1
  s_cmp_eq_u32 s51, 20
  s_cselect_b32 s51, 2, s51
  s_add_u32 m0, s28, 122880
  s_nop 0
  buffer_load_dwordx4 v2, s[8:11], s39 offen offset:0 lds
  v_mfma_f32_32x32x16_bf16 v[80:95], a[224:227], a[216:219], v[80:95]
  ds_read_b64_tr_b16 a[240:241], v20 offset:37120
  ds_read_b64_tr_b16 a[242:243], v20 offset:38656
  s_waitcnt lgkmcnt(6)
  v_mfma_f32_32x32x16_bf16 v[96:111], a[228:231], a[200:203], v[96:111]
  s_add_u32 m0, s28, 122880
  s_nop 0
  buffer_load_dwordx4 v3, s[8:11], s39 offen offset:1024 lds
  s_waitcnt vmcnt(5)
  ds_read_b128 v[32:35], v16 offset:0
  v_accvgpr_write_b32 a70, 0
  v_mfma_f32_32x32x16_bf16 v[112:127], a[228:231], a[216:219], v[112:127]
  ds_read_b64_tr_b16 a[244:245], v21 offset:37120
  ds_read_b64_tr_b16 a[246:247], v21 offset:38656
  ds_read_b128 v[36:39], v17 offset:0
  s_waitcnt lgkmcnt(8)
  v_mfma_f32_32x32x16_bf16 v[128:143], a[232:235], a[200:203], v[128:143]
  s_add_u32 m0, s28, 122880
  s_nop 0
  buffer_load_dwordx4 v4, s[8:11], s39 offen offset:2048 lds
  ds_read_b128 v[40:43], v18 offset:0
  v_accvgpr_write_b32 a71, 0
  v_mfma_f32_32x32x16_bf16 v[144:159], a[232:235], a[216:219], v[144:159]
  ds_read_b64_tr_b16 a[224:225], v20 offset:43008
  ds_read_b64_tr_b16 a[226:227], v20 offset:44544
  ds_read_b128 v[44:47], v19 offset:0
  s_waitcnt lgkmcnt(10)
  v_mfma_f32_32x32x16_bf16 v[160:175], a[236:239], a[200:203], v[160:175]
  ds_read_b128 v[48:51], v16 offset:4096
  v_accvgpr_write_b32 a72, 0
  v_mfma_f32_32x32x16_bf16 v[176:191], a[236:239], a[216:219], v[176:191]
  ds_read_b64_tr_b16 a[228:229], v21 offset:43008
  ds_read_b64_tr_b16 a[230:231], v21 offset:44544
  ds_read_b128 v[52:55], v17 offset:4096
  s_add_u32 s33, s48, 24576
  s_sub_u32 s44, s33, 393216
  s_cmp_ge_u32 s33, 393216
  s_cselect_b32 s33, s44, s33
  s_add_u32 m0, s28, 24576
  s_nop 0
  buffer_load_dwordx4 v10, s[12:15], s33 offen offset:0 nt lds
  s_waitcnt lgkmcnt(12)
  v_mfma_f32_32x32x16_bf16 v[192:207], a[240:243], a[200:203], v[192:207]
  ds_read_b128 v[56:59], v18 offset:4096
  v_accvgpr_write_b32 a73, 0
  v_mfma_f32_32x32x16_bf16 v[208:223], a[240:243], a[216:219], v[208:223]
  ds_read_b64_tr_b16 a[232:233], v20 offset:43136
  ds_read_b64_tr_b16 a[234:235], v20 offset:44672
  ds_read_b128 v[60:63], v19 offset:4096
  s_add_u32 m0, s28, 24576
  s_nop 0
  buffer_load_dwordx4 v11, s[12:15], s33 offen offset:1024 nt lds
  s_waitcnt lgkmcnt(13)
  v_mfma_f32_32x32x16_bf16 v[224:239], a[244:247], a[200:203], v[224:239]
  v_accvgpr_write_b32 a74, 0
  v_mfma_f32_32x32x16_bf16 v[240:255], a[244:247], a[216:219], v[240:255]
  ds_read_b64_tr_b16 a[236:237], v21 offset:43136
  ds_read_b64_tr_b16 a[238:239], v21 offset:44672
  s_add_u32 m0, s28, 24576
  s_nop 0
  buffer_load_dwordx4 v12, s[12:15], s33 offen offset:2048 nt lds
  s_waitcnt lgkmcnt(11)
  v_mfma_f32_32x32x16_bf16 v[64:79], a[224:227], a[204:207], v[64:79]
  v_accvgpr_write_b32 a75, 0
  v_mfma_f32_32x32x16_bf16 v[80:95], a[224:227], a[220:223], v[80:95]
  ds_read_b64_tr_b16 a[240:241], v20 offset:43264
  ds_read_b64_tr_b16 a[242:243], v20 offset:44800
  s_waitcnt lgkmcnt(9)
  v_mfma_f32_32x32x16_bf16 v[96:111], a[228:231], a[204:207], v[96:111]
  s_waitcnt lgkmcnt(4)
  v_accvgpr_write_b32 a76, 0
  v_mfma_f32_32x32x16_bf16 v[112:127], a[228:231], a[220:223], v[112:127]
  ds_read_b64_tr_b16 a[244:245], v21 offset:43264
  ds_read_b64_tr_b16 a[246:247], v21 offset:44800
  s_lshl_b32 s38, s50, 7
  s_add_u32 s50, s50, 1
  s_cmp_eq_u32 s50, 10
  s_cselect_b32 s50, 1, s50
  s_add_u32 m0, s29, 0
  s_nop 0
  buffer_load_dwordx4 v22, s[4:7], s38 offen offset:0 lds
  v_mfma_f32_32x32x16_bf16 v[128:143], a[232:235], a[204:207], v[128:143]
  s_add_u32 m0, s29, 0
  s_nop 0
  buffer_load_dwordx4 v23, s[4:7], s38 offen offset:1024 lds
  v_accvgpr_write_b32 a77, 0
  v_mfma_f32_32x32x16_bf16 v[144:159], a[232:235], a[220:223], v[144:159]
  ds_read_b64_tr_b16 a[224:225], v20 offset:0
  ds_read_b64_tr_b16 a[226:227], v20 offset:1536
  s_add_u32 m0, s29, 0
  s_nop 0
  buffer_load_dwordx4 v24, s[4:7], s38 offen offset:2048 lds
  s_waitcnt lgkmcnt(6)
  v_mfma_f32_32x32x16_bf16 v[160:175], a[236:239], a[204:207], v[160:175]
  s_add_u32 m0, s29, 0
  s_nop 0
  buffer_load_dwordx4 v25, s[4:7], s38 offen offset:3072 lds
  v_accvgpr_write_b32 a78, 0
  v_mfma_f32_32x32x16_bf16 v[176:191], a[236:239], a[220:223], v[176:191]
  ds_read_b64_tr_b16 a[228:229], v21 offset:0
  ds_read_b64_tr_b16 a[230:231], v21 offset:1536
  s_add_u32 m0, s29, 4096
  s_nop 0
  buffer_load_dwordx4 v26, s[4:7], s38 offen offset:0 lds
  s_waitcnt lgkmcnt(6)
  v_mfma_f32_32x32x16_bf16 v[192:207], a[240:243], a[204:207], v[192:207]
  s_add_u32 m0, s29, 4096
  s_nop 0
  buffer_load_dwordx4 v27, s[4:7], s38 offen offset:1024 lds
  v_accvgpr_write_b32 a79, 0
  v_mfma_f32_32x32x16_bf16 v[208:223], a[240:243], a[220:223], v[208:223]
  ds_read_b64_tr_b16 a[232:233], v20 offset:128
  ds_read_b64_tr_b16 a[234:235], v20 offset:1664
  s_add_u32 m0, s29, 4096
  s_nop 0
  buffer_load_dwordx4 v28, s[4:7], s38 offen offset:2048 lds
  s_waitcnt lgkmcnt(6)
  v_mfma_f32_32x32x16_bf16 v[224:239], a[244:247], a[204:207], v[224:239]
  s_add_u32 m0, s29, 4096
  s_nop 0
  buffer_load_dwordx4 v29, s[4:7], s38 offen offset:3072 lds
  v_mfma_f32_32x32x16_bf16 v[240:255], a[244:247], a[220:223], v[240:255]
  ds_read_b64_tr_b16 a[236:237], v21 offset:128
  ds_read_b64_tr_b16 a[238:239], v21 offset:1664
  s_waitcnt vmcnt(14)
  s_barrier
  s_waitcnt lgkmcnt(6)
  v_mfma_f32_32x32x16_bf16 v[64:79], a[224:227], v[32:35], v[64:79]
  s_mul_i32 s39, s51, 393216
  s_add_u32 s51, s51, 1
  s_cmp_eq_u32 s51, 20
  s_cselect_b32 s51, 2, s51
  s_add_u32 m0, s28, 135168
  s_nop 0
  buffer_load_dwordx4 v2, s[8:11], s39 offen offset:0 lds
  v_mfma_f32_32x32x16_bf16 v[80:95], a[224:227], v[48:51], v[80:95]
  ds_read_b64_tr_b16 a[240:241], v20 offset:256
  ds_read_b64_tr_b16 a[242:243], v20 offset:1792
  s_waitcnt lgkmcnt(6)
  v_mfma_f32_32x32x16_bf16 v[96:111], a[228:231], v[32:35], v[96:111]
  s_add_u32 m0, s28, 135168
  s_nop 0
  buffer_load_dwordx4 v3, s[8:11], s39 offen offset:1024 lds
  v_accvgpr_write_b32 a80, 0
  v_mfma_f32_32x32x16_bf16 v[112:127], a[228:231], v[48:51], v[112:127]
  ds_read_b64_tr_b16 a[244:245], v21 offset:256
  ds_read_b64_tr_b16 a[246:247], v21 offset:1792
  s_waitcnt lgkmcnt(6)
  v_mfma_f32_32x32x16_bf16 v[128:143], a[232:235], v[32:35], v[128:143]
  s_add_u32 m0, s28, 135168
  s_nop 0
  buffer_load_dwordx4 v4, s[8:11], s39 offen offset:2048 lds
  v_accvgpr_write_b32 a81, 0
  v_mfma_f32_32x32x16_bf16 v[144:159], a[232:235], v[48:51], v[144:159]
  ds_read_b64_tr_b16 a[224:225], v20 offset:6144
  ds_read_b64_tr_b16 a[226:227], v20 offset:7680
  s_waitcnt lgkmcnt(6)
  v_mfma_f32_32x32x16_bf16 v[160:175], a[236:239], v[32:35], v[160:175]
  v_accvgpr_write_b32 a82, 0
  v_mfma_f32_32x32x16_bf16 v[176:191], a[236:239], v[48:51], v[176:191]
  ds_read_b64_tr_b16 a[228:229], v21 offset:6144
  ds_read_b64_tr_b16 a[230:231], v21 offset:7680
  s_waitcnt lgkmcnt(6)
  v_mfma_f32_32x32x16_bf16 v[192:207], a[240:243], v[32:35], v[192:207]
  v_accvgpr_write_b32 a83, 0
  v_mfma_f32_32x32x16_bf16 v[208:223], a[240:243], v[48:51], v[208:223]
  ds_read_b64_tr_b16 a[232:233], v20 offset:6272
  ds_read_b64_tr_b16 a[234:235], v20 offset:7808
  s_waitcnt lgkmcnt(6)
  v_mfma_f32_32x32x16_bf16 v[224:239], a[244:247], v[32:35], v[224:239]
  v_accvgpr_write_b32 a84, 0
  v_mfma_f32_32x32x16_bf16 v[240:255], a[244:247], v[48:51], v[240:255]
  ds_read_b64_tr_b16 a[236:237], v21 offset:6272
  ds_read_b64_tr_b16 a[238:239], v21 offset:7808
  s_waitcnt lgkmcnt(6)
  v_mfma_f32_32x32x16_bf16 v[64:79], a[224:227], v[36:39], v[64:79]
  v_accvgpr_write_b32 a85, 0
  v_mfma_f32_32x32x16_bf16 v[80:95], a[224:227], v[52:55], v[80:95]
  ds_read_b64_tr_b16 a[240:241], v20 offset:6400
  ds_read_b64_tr_b16 a[242:243], v20 offset:7936
  s_waitcnt lgkmcnt(6)
  v_mfma_f32_32x32x16_bf16 v[96:111], a[228:231], v[36:39], v[96:111]
  v_accvgpr_write_b32 a86, 0
  v_mfma_f32_32x32x16_bf16 v[112:127], a[228:231], v[52:55], v[112:127]
  ds_read_b64_tr_b16 a[244:245], v21 offset:6400
  ds_read_b64_tr_b16 a[246:247], v21 offset:7936
  s_waitcnt lgkmcnt(6)
  v_mfma_f32_32x32x16_bf16 v[128:143], a[232:235], v[36:39], v[128:143]
  v_accvgpr_write_b32 a87, 0
  v_mfma_f32_32x32x16_bf16 v[144:159], a[232:235], v[52:55], v[144:159]
  ds_read_b64_tr_b16 a[224:225], v20 offset:12288
  ds_read_b64_tr_b16 a[226:227], v20 offset:13824
  s_waitcnt lgkmcnt(6)
  v_mfma_f32_32x32x16_bf16 v[160:175], a[236:239], v[36:39], v[160:175]
  v_accvgpr_write_b32 a88, 0
  v_mfma_f32_32x32x16_bf16 v[176:191], a[236:239], v[52:55], v[176:191]
  ds_read_b64_tr_b16 a[228:229], v21 offset:12288
  ds_read_b64_tr_b16 a[230:231], v21 offset:13824
  s_waitcnt lgkmcnt(6)
  v_mfma_f32_32x32x16_bf16 v[192:207], a[240:243], v[36:39], v[192:207]
  v_accvgpr_write_b32 a89, 0
  v_mfma_f32_32x32x16_bf16 v[208:223], a[240:243], v[52:55], v[208:223]
  ds_read_b64_tr_b16 a[232:233], v20 offset:12416
  ds_read_b64_tr_b16 a[234:235], v20 offset:13952
  s_waitcnt lgkmcnt(6)
  v_mfma_f32_32x32x16_bf16 v[224:239], a[244:247], v[36:39], v[224:239]
  v_mfma_f32_32x32x16_bf16 v[240:255], a[244:247], v[52:55], v[240:255]
  ds_read_b64_tr_b16 a[236:237], v21 offset:12416
  ds_read_b64_tr_b16 a[238:239], v21 offset:13952
  s_waitcnt vmcnt(14)
  s_barrier
  s_waitcnt lgkmcnt(6)
  v_mfma_f32_32x32x16_bf16 v[64:79], a[224:227], v[40:43], v[64:79]
  s_mul_i32 s39, s51, 393216
  s_add_u32 s51, s51, 1
  s_cmp_eq_u32 s51, 20
  s_cselect_b32 s51, 2, s51
  s_add_u32 m0, s28, 98304
  s_nop 0
  buffer_load_dwordx4 v2, s[8:11], s39 offen offset:0 lds
  v_mfma_f32_32x32x16_bf16 v[80:95], a[224:227], v[56:59], v[80:95]
  ds_read_b64_tr_b16 a[240:241], v20 offset:12544
  ds_read_b64_tr_b16 a[242:243], v20 offset:14080
  s_waitcnt lgkmcnt(6)
  v_mfma_f32_32x32x16_bf16 v[96:111], a[228:231], v[40:43], v[96:111]
  s_add_u32 m0, s28, 98304
  s_nop 0
  buffer_load_dwordx4 v3, s[8:11], s39 offen offset:1024 lds
  s_waitcnt vmcnt(5)
  ds_read_b128 a[192:195], v16 offset:0
  v_accvgpr_write_b32 a90, 0
  v_mfma_f32_32x32x16_bf16 v[112:127], a[228:231], v[56:59], v[112:127]
  ds_read_b64_tr_b16 a[244:245], v21 offset:12544
  ds_read_b64_tr_b16 a[246:247], v21 offset:14080
  ds_read_b128 a[196:199], v17 offset:0
  s_waitcnt lgkmcnt(8)
  v_mfma_f32_32x32x16_bf16 v[128:143], a[232:235], v[40:43], v[128:143]
  s_add_u32 m0, s28, 98304
  s_nop 0
  buffer_load_dwordx4 v4, s[8:11], s39 offen offset:2048 lds
  ds_read_b128 a[200:203], v18 offset:0
  v_accvgpr_write_b32 a91, 0
  v_mfma_f32_32x32x16_bf16 v[144:159], a[232:235], v[56:59], v[144:159]
  ds_read_b64_tr_b16 a[224:225], v20 offset:18432
  ds_read_b64_tr_b16 a[226:227], v20 offset:19968
  ds_read_b128 a[204:207], v19 offset:0
  s_waitcnt lgkmcnt(10)
  v_mfma_f32_32x32x16_bf16 v[160:175], a[236:239], v[40:43], v[160:175]
  ds_read_b128 a[208:211], v16 offset:4096
  v_accvgpr_write_b32 a92, 0
  v_mfma_f32_32x32x16_bf16 v[176:191], a[236:239], v[56:59], v[176:191]
  ds_read_b64_tr_b16 a[228:229], v21 offset:18432
  ds_read_b64_tr_b16 a[230:231], v21 offset:19968
  ds_read_b128 a[212:215], v17 offset:4096
  s_add_u32 s33, s48, 36864
  s_sub_u32 s44, s33, 393216
  s_cmp_ge_u32 s33, 393216
  s_cselect_b32 s33, s44, s33
  s_add_u32 m0, s28, 36864
  s_nop 0
  buffer_load_dwordx4 v10, s[12:15], s33 offen offset:0 nt lds
  s_waitcnt lgkmcnt(12)
  v_mfma_f32_32x32x16_bf16 v[192:207], a[240:243], v[40:43], v[192:207]
  ds_read_b128 a[216:219], v18 offset:4096
  v_accvgpr_write_b32 a93, 0
  v_mfma_f32_32x32x16_bf16 v[208:223], a[240:243], v[56:59], v[208:223]
  ds_read_b64_tr_b16 a[232:233], v20 offset:18560
  ds_read_b64_tr_b16 a[234:235], v20 offset:20096
  ds_read_b128 a[220:223], v19 offset:4096
  s_add_u32 m0, s28, 36864
  s_nop 0
  buffer_load_dwordx4 v11, s[12:15], s33 offen offset:1024 nt lds
  s_waitcnt lgkmcnt(13)
  v_mfma_f32_32x32x16_bf16 v[224:239], a[244:247], v[40:43], v[224:239]
  v_accvgpr_write_b32 a94, 0
  v_mfma_f32_32x32x16_bf16 v[240:255], a[244:247], v[56:59], v[240:255]
  ds_read_b64_tr_b16 a[236:237], v21 offset:18560
  ds_read_b64_tr_b16 a[238:239], v21 offset:20096
  s_add_u32 m0, s28, 36864
  s_nop 0
  buffer_load_dwordx4 v12, s[12:15], s33 offen offset:2048 nt lds
  s_waitcnt lgkmcnt(11)
  v_mfma_f32_32x32x16_bf16 v[64:79], a[224:227], v[44:47], v[64:79]
  v_accvgpr_write_b32 a95, 0
  v_mfma_f32_32x32x16_bf16 v[80:95], a[224:227], v[60:63], v[80:95]
  ds_read_b64_tr_b16 a[240:241], v20 offset:18688
  ds_read_b64_tr_b16 a[242:243], v20 offset:20224
  s_waitcnt lgkmcnt(9)
  v_mfma_f32_32x32x16_bf16 v[96:111], a[228:231], v[44:47], v[96:111]
  s_waitcnt lgkmcnt(4)
  v_accvgpr_write_b32 a96, 0
  v_mfma_f32_32x32x16_bf16 v[112:127], a[228:231], v[60:63], v[112:127]
  ds_read_b64_tr_b16 a[244:245], v21 offset:18688
  ds_read_b64_tr_b16 a[246:247], v21 offset:20224
  s_lshl_b32 s38, s50, 7
  s_add_u32 s50, s50, 1
  s_cmp_eq_u32 s50, 10
  s_cselect_b32 s50, 1, s50
  s_add_u32 m0, s29, 0
  s_nop 0
  buffer_load_dwordx4 v22, s[4:7], s38 offen offset:0 lds
  v_mfma_f32_32x32x16_bf16 v[128:143], a[232:235], v[44:47], v[128:143]
  s_add_u32 m0, s29, 0
  s_nop 0
  buffer_load_dwordx4 v23, s[4:7], s38 offen offset:1024 lds
  v_accvgpr_write_b32 a97, 0
  v_mfma_f32_32x32x16_bf16 v[144:159], a[232:235], v[60:63], v[144:159]
  ds_read_b64_tr_b16 a[224:225], v20 offset:24576
  ds_read_b64_tr_b16 a[226:227], v20 offset:26112
  s_add_u32 m0, s29, 0
  s_nop 0
  buffer_load_dwordx4 v24, s[4:7], s38 offen offset:2048 lds
  s_waitcnt lgkmcnt(6)
  v_mfma_f32_32x32x16_bf16 v[160:175], a[236:239], v[44:47], v[160:175]
  s_add_u32 m0, s29, 0
  s_nop 0
  buffer_load_dwordx4 v25, s[4:7], s38 offen offset:3072 lds
  v_accvgpr_write_b32 a98, 0
  v_mfma_f32_32x32x16_bf16 v[176:191], a[236:239], v[60:63], v[176:191]
  ds_read_b64_tr_b16 a[228:229], v21 offset:24576
  ds_read_b64_tr_b16 a[230:231], v21 offset:26112
  s_add_u32 m0, s29, 4096
  s_nop 0
  buffer_load_dwordx4 v26, s[4:7], s38 offen offset:0 lds
  s_waitcnt lgkmcnt(6)
  v_mfma_f32_32x32x16_bf16 v[192:207], a[240:243], v[44:47], v[192:207]
  s_add_u32 m0, s29, 4096
  s_nop 0
  buffer_load_dwordx4 v27, s[4:7], s38 offen offset:1024 lds
  v_accvgpr_write_b32 a99, 0
  v_mfma_f32_32x32x16_bf16 v[208:223], a[240:243], v[60:63], v[208:223]
  ds_read_b64_tr_b16 a[232:233], v20 offset:24704
  ds_read_b64_tr_b16 a[234:235], v20 offset:26240
  s_add_u32 m0, s29, 4096
  s_nop 0
  buffer_load_dwordx4 v28, s[4:7], s38 offen offset:2048 lds
  s_waitcnt lgkmcnt(6)
  v_mfma_f32_32x32x16_bf16 v[224:239], a[244:247], v[44:47], v[224:239]
  s_add_u32 m0, s29, 4096
  s_nop 0
  buffer_load_dwordx4 v29, s[4:7], s38 offen offset:3072 lds
  v_mfma_f32_32x32x16_bf16 v[240:255], a[244:247], v[60:63], v[240:255]
  ds_read_b64_tr_b16 a[236:237], v21 offset:24704
  ds_read_b64_tr_b16 a[238:239], v21 offset:26240
  s_waitcnt vmcnt(14)
  s_barrier
  s_waitcnt lgkmcnt(6)
  v_mfma_f32_32x32x16_bf16 v[64:79], a[224:227], a[192:195], v[64:79]
  s_mul_i32 s39, s51, 393216
  s_add_u32 s51, s51, 1
  s_cmp_eq_u32 s51, 20
  s_cselect_b32 s51, 2, s51
  s_add_u32 m0, s28, 110592
  s_nop 0
  buffer_load_dwordx4 v2, s[8:11], s39 offen offset:0 lds
  v_mfma_f32_32x32x16_bf16 v[80:95], a[224:227], a[208:211], v[80:95]
  ds_read_b64_tr_b16 a[240:241], v20 offset:24832
  ds_read_b64_tr_b16 a[242:243], v20 offset:26368
  s_waitcnt lgkmcnt(6)
  v_mfma_f32_32x32x16_bf16 v[96:111], a[228:231], a[192:195], v[96:111]
  s_add_u32 m0, s28, 110592
  s_nop 0
  buffer_load_dwordx4 v3, s[8:11], s39 offen offset:1024 lds
  v_accvgpr_write_b32 a100, 0
  v_mfma_f32_32x32x16_bf16 v[112:127], a[228:231], a[208:211], v[112:127]
  ds_read_b64_tr_b16 a[244:245], v21 offset:24832
  ds_read_b64_tr_b16 a[246:247], v21 offset:26368
  s_waitcnt lgkmcnt(6)
  v_mfma_f32_32x32x16_bf16 v[128:143], a[232:235], a[192:195], v[128:143]
  s_add_u32 m0, s28, 110592
  s_nop 0
  buffer_load_dwordx4 v4, s[8:11], s39 offen offset:2048 lds
  v_accvgpr_write_b32 a101, 0
  v_mfma_f32_32x32x16_bf16 v[144:159], a[232:235], a[208:211], v[144:159]
  ds_read_b64_tr_b16 a[224:225], v20 offset:30720
  ds_read_b64_tr_b16 a[226:227], v20 offset:32256
  s_waitcnt lgkmcnt(6)
  v_mfma_f32_32x32x16_bf16 v[160:175], a[236:239], a[192:195], v[160:175]
  v_accvgpr_write_b32 a102, 0
  v_mfma_f32_32x32x16_bf16 v[176:191], a[236:239], a[208:211], v[176:191]
  ds_read_b64_tr_b16 a[228:229], v21 offset:30720
  ds_read_b64_tr_b16 a[230:231], v21 offset:32256
  s_waitcnt lgkmcnt(6)
  v_mfma_f32_32x32x16_bf16 v[192:207], a[240:243], a[192:195], v[192:207]
  v_accvgpr_write_b32 a103, 0
  v_mfma_f32_32x32x16_bf16 v[208:223], a[240:243], a[208:211], v[208:223]
  ds_read_b64_tr_b16 a[232:233], v20 offset:30848
  ds_read_b64_tr_b16 a[234:235], v20 offset:32384
  s_waitcnt lgkmcnt(6)
  v_mfma_f32_32x32x16_bf16 v[224:239], a[244:247], a[192:195], v[224:239]
  v_accvgpr_write_b32 a104, 0
  v_mfma_f32_32x32x16_bf16 v[240:255], a[244:247], a[208:211], v[240:255]
  ds_read_b64_tr_b16 a[236:237], v21 offset:30848
  ds_read_b64_tr_b16 a[238:239], v21 offset:32384
  s_waitcnt lgkmcnt(6)
  v_mfma_f32_32x32x16_bf16 v[64:79], a[224:227], a[196:199], v[64:79]
  v_accvgpr_write_b32 a105, 0
  v_mfma_f32_32x32x16_bf16 v[80:95], a[224:227], a[212:215], v[80:95]
  ds_read_b64_tr_b16 a[240:241], v20 offset:30976
  ds_read_b64_tr_b16 a[242:243], v20 offset:32512
  s_waitcnt lgkmcnt(6)
  v_mfma_f32_32x32x16_bf16 v[96:111], a[228:231], a[196:199], v[96:111]
  v_accvgpr_write_b32 a106, 0
  v_mfma_f32_32x32x16_bf16 v[112:127], a[228:231], a[212:215], v[112:127]
  ds_read_b64_tr_b16 a[244:245], v21 offset:30976
  ds_read_b64_tr_b16 a[246:247], v21 offset:32512
  s_waitcnt lgkmcnt(6)
  v_mfma_f32_32x32x16_bf16 v[128:143], a[232:235], a[196:199], v[128:143]
  v_accvgpr_write_b32 a107, 0
  v_mfma_f32_32x32x16_bf16 v[144:159], a[232:235], a[212:215], v[144:159]
  ds_read_b64_tr_b16 a[224:225], v20 offset:36864
  ds_read_b64_tr_b16 a[226:227], v20 offset:38400
  s_waitcnt lgkmcnt(6)
  v_mfma_f32_32x32x16_bf16 v[160:175], a[236:239], a[196:199], v[160:175]
  v_accvgpr_write_b32 a108, 0
  v_mfma_f32_32x32x16_bf16 v[176:191], a[236:239], a[212:215], v[176:191]
  ds_read_b64_tr_b16 a[228:229], v21 offset:36864
  ds_read_b64_tr_b16 a[230:231], v21 offset:38400
  s_waitcnt lgkmcnt(6)
  v_mfma_f32_32x32x16_bf16 v[192:207], a[240:243], a[196:199], v[192:207]
  v_accvgpr_write_b32 a109, 0
  v_mfma_f32_32x32x16_bf16 v[208:223], a[240:243], a[212:215], v[208:223]
  ds_read_b64_tr_b16 a[232:233], v20 offset:36992
  ds_read_b64_tr_b16 a[234:235], v20 offset:38528
  s_waitcnt lgkmcnt(6)
  v_mfma_f32_32x32x16_bf16 v[224:239], a[244:247], a[196:199], v[224:239]
  v_mfma_f32_32x32x16_bf16 v[240:255], a[244:247], a[212:215], v[240:255]
  ds_read_b64_tr_b16 a[236:237], v21 offset:36992
  ds_read_b64_tr_b16 a[238:239], v21 offset:38528
  s_waitcnt vmcnt(14)
  s_barrier
  s_waitcnt lgkmcnt(6)
  v_mfma_f32_32x32x16_bf16 v[64:79], a[224:227], a[200:203], v[64:79]
  s_mul_i32 s39, s51, 393216
  s_add_u32 s51, s51, 1
  s_cmp_eq_u32 s51, 20
  s_cselect_b32 s51, 2, s51
  s_add_u32 m0, s28, 122880
  s_nop 0
  buffer_load_dwordx4 v2, s[8:11], s39 offen offset:0 lds
  v_mfma_f32_32x32x16_bf16 v[80:95], a[224:227], a[216:219], v[80:95]
  ds_read_b64_tr_b16 a[240:241], v20 offset:37120
  ds_read_b64_tr_b16 a[242:243], v20 offset:38656
  s_waitcnt lgkmcnt(6)
  v_mfma_f32_32x32x16_bf16 v[96:111], a[228:231], a[200:203], v[96:111]
  s_add_u32 m0, s28, 122880
  s_nop 0
  buffer_load_dwordx4 v3, s[8:11], s39 offen offset:1024 lds
  s_waitcnt vmcnt(5)
  ds_read_b128 v[32:35], v16 offset:0
  v_accvgpr_write_b32 a110, 0
  v_mfma_f32_32x32x16_bf16 v[112:127], a[228:231], a[216:219], v[112:127]
  ds_read_b64_tr_b16 a[244:245], v21 offset:37120
  ds_read_b64_tr_b16 a[246:247], v21 offset:38656
  ds_read_b128 v[36:39], v17 offset:0
  s_waitcnt lgkmcnt(8)
  v_mfma_f32_32x32x16_bf16 v[128:143], a[232:235], a[200:203], v[128:143]
  s_add_u32 m0, s28, 122880
  s_nop 0
  buffer_load_dwordx4 v4, s[8:11], s39 offen offset:2048 lds
  ds_read_b128 v[40:43], v18 offset:0
  v_accvgpr_write_b32 a111, 0
  v_mfma_f32_32x32x16_bf16 v[144:159], a[232:235], a[216:219], v[144:159]
  ds_read_b64_tr_b16 a[224:225], v20 offset:43008
  ds_read_b64_tr_b16 a[226:227], v20 offset:44544
  ds_read_b128 v[44:47], v19 offset:0
  s_waitcnt lgkmcnt(10)
  v_mfma_f32_32x32x16_bf16 v[160:175], a[236:239], a[200:203], v[160:175]
  ds_read_b128 v[48:51], v16 offset:4096
  v_accvgpr_write_b32 a112, 0
  v_mfma_f32_32x32x16_bf16 v[176:191], a[236:239], a[216:219], v[176:191]
  ds_read_b64_tr_b16 a[228:229], v21 offset:43008
  ds_read_b64_tr_b16 a[230:231], v21 offset:44544
  ds_read_b128 v[52:55], v17 offset:4096
  s_add_u32 s33, s48, 12288
  s_sub_u32 s44, s33, 393216
  s_cmp_ge_u32 s33, 393216
  s_cselect_b32 s33, s44, s33
  s_add_u32 m0, s28, 86016
  s_nop 0
  buffer_load_dwordx4 v13, s[16:19], s33 offen offset:0 nt lds
  s_waitcnt lgkmcnt(12)
  v_mfma_f32_32x32x16_bf16 v[192:207], a[240:243], a[200:203], v[192:207]
  ds_read_b128 v[56:59], v18 offset:4096
  v_accvgpr_write_b32 a113, 0
  v_mfma_f32_32x32x16_bf16 v[208:223], a[240:243], a[216:219], v[208:223]
  ds_read_b64_tr_b16 a[232:233], v20 offset:43136
  ds_read_b64_tr_b16 a[234:235], v20 offset:44672
  ds_read_b128 v[60:63], v19 offset:4096
  s_add_u32 m0, s28, 86016
  s_nop 0
  buffer_load_dwordx4 v14, s[16:19], s33 offen offset:1024 nt lds
  s_waitcnt lgkmcnt(13)
  v_mfma_f32_32x32x16_bf16 v[224:239], a[244:247], a[200:203], v[224:239]
  v_accvgpr_write_b32 a114, 0
  v_mfma_f32_32x32x16_bf16 v[240:255], a[244:247], a[216:219], v[240:255]
  ds_read_b64_tr_b16 a[236:237], v21 offset:43136
  ds_read_b64_tr_b16 a[238:239], v21 offset:44672
  s_add_u32 m0, s28, 86016
  s_nop 0
  buffer_load_dwordx4 v15, s[16:19], s33 offen offset:2048 nt lds
  s_waitcnt lgkmcnt(11)
  v_mfma_f32_32x32x16_bf16 v[64:79], a[224:227], a[204:207], v[64:79]
  v_accvgpr_write_b32 a115, 0
  v_mfma_f32_32x32x16_bf16 v[80:95], a[224:227], a[220:223], v[80:95]
  ds_read_b64_tr_b16 a[240:241], v20 offset:43264
  ds_read_b64_tr_b16 a[242:243], v20 offset:44800
  s_waitcnt lgkmcnt(9)
  v_mfma_f32_32x32x16_bf16 v[96:111], a[228:231], a[204:207], v[96:111]
  s_waitcnt lgkmcnt(4)
  v_accvgpr_write_b32 a116, 0
  v_mfma_f32_32x32x16_bf16 v[112:127], a[228:231], a[220:223], v[112:127]
  ds_read_b64_tr_b16 a[244:245], v21 offset:43264
  ds_read_b64_tr_b16 a[246:247], v21 offset:44800
  s_lshl_b32 s38, s50, 7
  s_add_u32 s50, s50, 1
  s_cmp_eq_u32 s50, 10
  s_cselect_b32 s50, 1, s50
  s_add_u32 m0, s29, 0
  s_nop 0
  buffer_load_dwordx4 v22, s[4:7], s38 offen offset:0 lds
  v_mfma_f32_32x32x16_bf16 v[128:143], a[232:235], a[204:207], v[128:143]
  s_add_u32 m0, s29, 0
  s_nop 0
  buffer_load_dwordx4 v23, s[4:7], s38 offen offset:1024 lds
  v_accvgpr_write_b32 a117, 0
  v_mfma_f32_32x32x16_bf16 v[144:159], a[232:235], a[220:223], v[144:159]
  ds_read_b64_tr_b16 a[224:225], v20 offset:0
  ds_read_b64_tr_b16 a[226:227], v20 offset:1536
  s_add_u32 m0, s29, 0
  s_nop 0
  buffer_load_dwordx4 v24, s[4:7], s38 offen offset:2048 lds
  s_waitcnt lgkmcnt(6)
  v_mfma_f32_32x32x16_bf16 v[160:175], a[236:239], a[204:207], v[160:175]
  s_add_u32 m0, s29, 0
  s_nop 0
  buffer_load_dwordx4 v25, s[4:7], s38 offen offset:3072 lds
  v_accvgpr_write_b32 a118, 0
  v_mfma_f32_32x32x16_bf16 v[176:191], a[236:239], a[220:223], v[176:191]
  ds_read_b64_tr_b16 a[228:229], v21 offset:0
  ds_read_b64_tr_b16 a[230:231], v21 offset:1536
  s_add_u32 m0, s29, 4096
  s_nop 0
  buffer_load_dwordx4 v26, s[4:7], s38 offen offset:0 lds
  s_waitcnt lgkmcnt(6)
  v_mfma_f32_32x32x16_bf16 v[192:207], a[240:243], a[204:207], v[192:207]
  s_add_u32 m0, s29, 4096
  s_nop 0
  buffer_load_dwordx4 v27, s[4:7], s38 offen offset:1024 lds
  v_accvgpr_write_b32 a119, 0
  v_mfma_f32_32x32x16_bf16 v[208:223], a[240:243], a[220:223], v[208:223]
  ds_read_b64_tr_b16 a[232:233], v20 offset:128
  ds_read_b64_tr_b16 a[234:235], v20 offset:1664
  s_add_u32 m0, s29, 4096
  s_nop 0
  buffer_load_dwordx4 v28, s[4:7], s38 offen offset:2048 lds
  s_waitcnt lgkmcnt(6)
  v_mfma_f32_32x32x16_bf16 v[224:239], a[244:247], a[204:207], v[224:239]
  s_add_u32 m0, s29, 4096
  s_nop 0
  buffer_load_dwordx4 v29, s[4:7], s38 offen offset:3072 lds
  v_mfma_f32_32x32x16_bf16 v[240:255], a[244:247], a[220:223], v[240:255]
  ds_read_b64_tr_b16 a[236:237], v21 offset:128
  ds_read_b64_tr_b16 a[238:239], v21 offset:1664
  s_waitcnt vmcnt(14)
  s_barrier
  s_waitcnt lgkmcnt(6)
  v_mfma_f32_32x32x16_bf16 v[64:79], a[224:227], v[32:35], v[64:79]
  s_mul_i32 s39, s51, 393216
  s_add_u32 s51, s51, 1
  s_cmp_eq_u32 s51, 20
  s_cselect_b32 s51, 2, s51
  s_add_u32 m0, s28, 135168
  s_nop 0
  buffer_load_dwordx4 v2, s[8:11], s39 offen offset:0 lds
  v_mfma_f32_32x32x16_bf16 v[80:95], a[224:227], v[48:51], v[80:95]
  ds_read_b64_tr_b16 a[240:241], v20 offset:256
  ds_read_b64_tr_b16 a[242:243], v20 offset:1792
  s_waitcnt lgkmcnt(6)
  v_mfma_f32_32x32x16_bf16 v[96:111], a[228:231], v[32:35], v[96:111]
  s_add_u32 m0, s28, 135168
  s_nop 0
  buffer_load_dwordx4 v3, s[8:11], s39 offen offset:1024 lds
  v_accvgpr_write_b32 a120, 0
  v_mfma_f32_32x32x16_bf16 v[112:127], a[228:231], v[48:51], v[112:127]
  ds_read_b64_tr_b16 a[244:245], v21 offset:256
  ds_read_b64_tr_b16 a[246:247], v21 offset:1792
  s_waitcnt lgkmcnt(6)
  v_mfma_f32_32x32x16_bf16 v[128:143], a[232:235], v[32:35], v[128:143]
  s_add_u32 m0, s28, 135168
  s_nop 0
  buffer_load_dwordx4 v4, s[8:11], s39 offen offset:2048 lds
  v_accvgpr_write_b32 a121, 0
  v_mfma_f32_32x32x16_bf16 v[144:159], a[232:235], v[48:51], v[144:159]
  ds_read_b64_tr_b16 a[224:225], v20 offset:6144
  ds_read_b64_tr_b16 a[226:227], v20 offset:7680
  s_waitcnt lgkmcnt(6)
  v_mfma_f32_32x32x16_bf16 v[160:175], a[236:239], v[32:35], v[160:175]
  v_accvgpr_write_b32 a122, 0
  v_mfma_f32_32x32x16_bf16 v[176:191], a[236:239], v[48:51], v[176:191]
  ds_read_b64_tr_b16 a[228:229], v21 offset:6144
  ds_read_b64_tr_b16 a[230:231], v21 offset:7680
  s_waitcnt lgkmcnt(6)
  v_mfma_f32_32x32x16_bf16 v[192:207], a[240:243], v[32:35], v[192:207]
  v_accvgpr_write_b32 a123, 0
  v_mfma_f32_32x32x16_bf16 v[208:223], a[240:243], v[48:51], v[208:223]
  ds_read_b64_tr_b16 a[232:233], v20 offset:6272
  ds_read_b64_tr_b16 a[234:235], v20 offset:7808
  s_waitcnt lgkmcnt(6)
  v_mfma_f32_32x32x16_bf16 v[224:239], a[244:247], v[32:35], v[224:239]
  v_accvgpr_write_b32 a124, 0
  v_mfma_f32_32x32x16_bf16 v[240:255], a[244:247], v[48:51], v[240:255]
  ds_read_b64_tr_b16 a[236:237], v21 offset:6272
  ds_read_b64_tr_b16 a[238:239], v21 offset:7808
  s_waitcnt lgkmcnt(6)
  v_mfma_f32_32x32x16_bf16 v[64:79], a[224:227], v[36:39], v[64:79]
  v_accvgpr_write_b32 a125, 0
  v_mfma_f32_32x32x16_bf16 v[80:95], a[224:227], v[52:55], v[80:95]
  ds_read_b64_tr_b16 a[240:241], v20 offset:6400
  ds_read_b64_tr_b16 a[242:243], v20 offset:7936
  s_waitcnt lgkmcnt(6)
  v_mfma_f32_32x32x16_bf16 v[96:111], a[228:231], v[36:39], v[96:111]
  v_accvgpr_write_b32 a126, 0
  v_mfma_f32_32x32x16_bf16 v[112:127], a[228:231], v[52:55], v[112:127]
  ds_read_b64_tr_b16 a[244:245], v21 offset:6400
  ds_read_b64_tr_b16 a[246:247], v21 offset:7936
  s_waitcnt lgkmcnt(6)
  v_mfma_f32_32x32x16_bf16 v[128:143], a[232:235], v[36:39], v[128:143]
  v_accvgpr_write_b32 a127, 0
  v_mfma_f32_32x32x16_bf16 v[144:159], a[232:235], v[52:55], v[144:159]
  ds_read_b64_tr_b16 a[224:225], v20 offset:12288
  ds_read_b64_tr_b16 a[226:227], v20 offset:13824
  s_waitcnt lgkmcnt(6)
  v_mfma_f32_32x32x16_bf16 v[160:175], a[236:239], v[36:39], v[160:175]
  v_accvgpr_write_b32 a128, 0
  v_mfma_f32_32x32x16_bf16 v[176:191], a[236:239], v[52:55], v[176:191]
  ds_read_b64_tr_b16 a[228:229], v21 offset:12288
  ds_read_b64_tr_b16 a[230:231], v21 offset:13824
  s_waitcnt lgkmcnt(6)
  v_mfma_f32_32x32x16_bf16 v[192:207], a[240:243], v[36:39], v[192:207]
  v_accvgpr_write_b32 a129, 0
  v_mfma_f32_32x32x16_bf16 v[208:223], a[240:243], v[52:55], v[208:223]
  ds_read_b64_tr_b16 a[232:233], v20 offset:12416
  ds_read_b64_tr_b16 a[234:235], v20 offset:13952
  s_waitcnt lgkmcnt(6)
  v_mfma_f32_32x32x16_bf16 v[224:239], a[244:247], v[36:39], v[224:239]
  v_mfma_f32_32x32x16_bf16 v[240:255], a[244:247], v[52:55], v[240:255]
  ds_read_b64_tr_b16 a[236:237], v21 offset:12416
  ds_read_b64_tr_b16 a[238:239], v21 offset:13952
  s_waitcnt vmcnt(14)
  s_barrier
  s_waitcnt lgkmcnt(6)
  v_mfma_f32_32x32x16_bf16 v[64:79], a[224:227], v[40:43], v[64:79]
  s_mul_i32 s39, s51, 393216
  s_add_u32 s51, s51, 1
  s_cmp_eq_u32 s51, 20
  s_cselect_b32 s51, 2, s51
  s_add_u32 m0, s28, 98304
  s_nop 0
  buffer_load_dwordx4 v2, s[8:11], s39 offen offset:0 lds
  v_mfma_f32_32x32x16_bf16 v[80:95], a[224:227], v[56:59], v[80:95]
  ds_read_b64_tr_b16 a[240:241], v20 offset:12544
  ds_read_b64_tr_b16 a[242:243], v20 offset:14080
  s_waitcnt lgkmcnt(6)
  v_mfma_f32_32x32x16_bf16 v[96:111], a[228:231], v[40:43], v[96:111]
  s_add_u32 m0, s28, 98304
  s_nop 0
  buffer_load_dwordx4 v3, s[8:11], s39 offen offset:1024 lds
  s_waitcnt vmcnt(5)
  ds_read_b128 a[192:195], v16 offset:0
  v_accvgpr_write_b32 a130, 0
  v_mfma_f32_32x32x16_bf16 v[112:127], a[228:231], v[56:59], v[112:127]
  ds_read_b64_tr_b16 a[244:245], v21 offset:12544
  ds_read_b64_tr_b16 a[246:247], v21 offset:14080
  ds_read_b128 a[196:199], v17 offset:0
  s_waitcnt lgkmcnt(8)
  v_mfma_f32_32x32x16_bf16 v[128:143], a[232:235], v[40:43], v[128:143]
  s_add_u32 m0, s28, 98304
  s_nop 0
  buffer_load_dwordx4 v4, s[8:11], s39 offen offset:2048 lds
  ds_read_b128 a[200:203], v18 offset:0
  v_accvgpr_write_b32 a131, 0
  v_mfma_f32_32x32x16_bf16 v[144:159], a[232:235], v[56:59], v[144:159]
  ds_read_b64_tr_b16 a[224:225], v20 offset:18432
  ds_read_b64_tr_b16 a[226:227], v20 offset:19968
  ds_read_b128 a[204:207], v19 offset:0
  s_waitcnt lgkmcnt(10)
  v_mfma_f32_32x32x16_bf16 v[160:175], a[236:239], v[40:43], v[160:175]
  ds_read_b128 a[208:211], v16 offset:4096
  v_accvgpr_write_b32 a132, 0
  v_mfma_f32_32x32x16_bf16 v[176:191], a[236:239], v[56:59], v[176:191]
  ds_read_b64_tr_b16 a[228:229], v21 offset:18432
  ds_read_b64_tr_b16 a[230:231], v21 offset:19968
  ds_read_b128 a[212:215], v17 offset:4096
  s_waitcnt lgkmcnt(12)
  v_mfma_f32_32x32x16_bf16 v[192:207], a[240:243], v[40:43], v[192:207]
  ds_read_b128 a[216:219], v18 offset:4096
  v_accvgpr_write_b32 a133, 0
  v_mfma_f32_32x32x16_bf16 v[208:223], a[240:243], v[56:59], v[208:223]
  ds_read_b64_tr_b16 a[232:233], v20 offset:18560
  ds_read_b64_tr_b16 a[234:235], v20 offset:20096
  ds_read_b128 a[220:223], v19 offset:4096
  s_waitcnt lgkmcnt(13)
  v_mfma_f32_32x32x16_bf16 v[224:239], a[244:247], v[40:43], v[224:239]
  v_accvgpr_write_b32 a134, 0
  v_mfma_f32_32x32x16_bf16 v[240:255], a[244:247], v[56:59], v[240:255]
  ds_read_b64_tr_b16 a[236:237], v21 offset:18560
  ds_read_b64_tr_b16 a[238:239], v21 offset:20096
  s_waitcnt lgkmcnt(11)
  v_mfma_f32_32x32x16_bf16 v[64:79], a[224:227], v[44:47], v[64:79]
  v_accvgpr_write_b32 a135, 0
  v_mfma_f32_32x32x16_bf16 v[80:95], a[224:227], v[60:63], v[80:95]
  ds_read_b64_tr_b16 a[240:241], v20 offset:18688
  ds_read_b64_tr_b16 a[242:243], v20 offset:20224
  s_waitcnt lgkmcnt(9)
  v_mfma_f32_32x32x16_bf16 v[96:111], a[228:231], v[44:47], v[96:111]
  s_waitcnt lgkmcnt(4)
  v_accvgpr_write_b32 a136, 0
  v_mfma_f32_32x32x16_bf16 v[112:127], a[228:231], v[60:63], v[112:127]
  ds_read_b64_tr_b16 a[244:245], v21 offset:18688
  ds_read_b64_tr_b16 a[246:247], v21 offset:20224
  s_lshl_b32 s38, s50, 7
  s_add_u32 s50, s50, 1
  s_cmp_eq_u32 s50, 10
  s_cselect_b32 s50, 1, s50
  s_add_u32 m0, s29, 0
  s_nop 0
  buffer_load_dwordx4 v22, s[4:7], s38 offen offset:0 lds
  v_mfma_f32_32x32x16_bf16 v[128:143], a[232:235], v[44:47], v[128:143]
  s_add_u32 m0, s29, 0
  s_nop 0
  buffer_load_dwordx4 v23, s[4:7], s38 offen offset:1024 lds
  v_accvgpr_write_b32 a137, 0
  v_mfma_f32_32x32x16_bf16 v[144:159], a[232:235], v[60:63], v[144:159]
  ds_read_b64_tr_b16 a[224:225], v20 offset:24576
  ds_read_b64_tr_b16 a[226:227], v20 offset:26112
  s_add_u32 m0, s29, 0
  s_nop 0
  buffer_load_dwordx4 v24, s[4:7], s38 offen offset:2048 lds
  s_waitcnt lgkmcnt(6)
  v_mfma_f32_32x32x16_bf16 v[160:175], a[236:239], v[44:47], v[160:175]
  s_add_u32 m0, s29, 0
  s_nop 0
  buffer_load_dwordx4 v25, s[4:7], s38 offen offset:3072 lds
  v_accvgpr_write_b32 a138, 0
  v_mfma_f32_32x32x16_bf16 v[176:191], a[236:239], v[60:63], v[176:191]
  ds_read_b64_tr_b16 a[228:229], v21 offset:24576
  ds_read_b64_tr_b16 a[230:231], v21 offset:26112
  s_add_u32 m0, s29, 4096
  s_nop 0
  buffer_load_dwordx4 v26, s[4:7], s38 offen offset:0 lds
  s_waitcnt lgkmcnt(6)
  v_mfma_f32_32x32x16_bf16 v[192:207], a[240:243], v[44:47], v[192:207]
  s_add_u32 m0, s29, 4096
  s_nop 0
  buffer_load_dwordx4 v27, s[4:7], s38 offen offset:1024 lds
  v_accvgpr_write_b32 a139, 0
  v_mfma_f32_32x32x16_bf16 v[208:223], a[240:243], v[60:63], v[208:223]
  ds_read_b64_tr_b16 a[232:233], v20 offset:24704
  ds_read_b64_tr_b16 a[234:235], v20 offset:26240
  s_add_u32 m0, s29, 4096
  s_nop 0
  buffer_load_dwordx4 v28, s[4:7], s38 offen offset:2048 lds
  s_waitcnt lgkmcnt(6)
  v_mfma_f32_32x32x16_bf16 v[224:239], a[244:247], v[44:47], v[224:239]
  s_add_u32 m0, s29, 4096
  s_nop 0
  buffer_load_dwordx4 v29, s[4:7], s38 offen offset:3072 lds
  v_mfma_f32_32x32x16_bf16 v[240:255], a[244:247], v[60:63], v[240:255]
  ds_read_b64_tr_b16 a[236:237], v21 offset:24704
  ds_read_b64_tr_b16 a[238:239], v21 offset:26240
  s_waitcnt vmcnt(11)
  s_barrier
  s_waitcnt lgkmcnt(6)
  v_mfma_f32_32x32x16_bf16 v[64:79], a[224:227], a[192:195], v[64:79]
  s_mul_i32 s39, s51, 393216
  s_add_u32 s51, s51, 1
  s_cmp_eq_u32 s51, 20
  s_cselect_b32 s51, 2, s51
  s_add_u32 m0, s28, 110592
  s_nop 0
  buffer_load_dwordx4 v2, s[8:11], s39 offen offset:0 lds
  v_mfma_f32_32x32x16_bf16 v[80:95], a[224:227], a[208:211], v[80:95]
  ds_read_b64_tr_b16 a[240:241], v20 offset:24832
  ds_read_b64_tr_b16 a[242:243], v20 offset:26368
  s_waitcnt lgkmcnt(6)
  v_mfma_f32_32x32x16_bf16 v[96:111], a[228:231], a[192:195], v[96:111]
  s_add_u32 m0, s28, 110592
  s_nop 0
  buffer_load_dwordx4 v3, s[8:11], s39 offen offset:1024 lds
  v_accvgpr_write_b32 a140, 0
  v_mfma_f32_32x32x16_bf16 v[112:127], a[228:231], a[208:211], v[112:127]
  ds_read_b64_tr_b16 a[244:245], v21 offset:24832
  ds_read_b64_tr_b16 a[246:247], v21 offset:26368
  s_waitcnt lgkmcnt(6)
  v_mfma_f32_32x32x16_bf16 v[128:143], a[232:235], a[192:195], v[128:143]
  s_add_u32 m0, s28, 110592
  s_nop 0
  buffer_load_dwordx4 v4, s[8:11], s39 offen offset:2048 lds
  v_accvgpr_write_b32 a141, 0
  v_mfma_f32_32x32x16_bf16 v[144:159], a[232:235], a[208:211], v[144:159]
  ds_read_b64_tr_b16 a[224:225], v20 offset:30720
  ds_read_b64_tr_b16 a[226:227], v20 offset:32256
  s_waitcnt lgkmcnt(6)
  v_mfma_f32_32x32x16_bf16 v[160:175], a[236:239], a[192:195], v[160:175]
  v_accvgpr_write_b32 a142, 0
  v_mfma_f32_32x32x16_bf16 v[176:191], a[236:239], a[208:211], v[176:191]
  ds_read_b64_tr_b16 a[228:229], v21 offset:30720
  ds_read_b64_tr_b16 a[230:231], v21 offset:32256
  s_waitcnt lgkmcnt(6)
  v_mfma_f32_32x32x16_bf16 v[192:207], a[240:243], a[192:195], v[192:207]
  v_accvgpr_write_b32 a143, 0
  v_mfma_f32_32x32x16_bf16 v[208:223], a[240:243], a[208:211], v[208:223]
  ds_read_b64_tr_b16 a[232:233], v20 offset:30848
  ds_read_b64_tr_b16 a[234:235], v20 offset:32384
  s_waitcnt lgkmcnt(6)
  v_mfma_f32_32x32x16_bf16 v[224:239], a[244:247], a[192:195], v[224:239]
  v_accvgpr_write_b32 a144, 0
  v_mfma_f32_32x32x16_bf16 v[240:255], a[244:247], a[208:211], v[240:255]
  ds_read_b64_tr_b16 a[236:237], v21 offset:30848
  ds_read_b64_tr_b16 a[238:239], v21 offset:32384
  s_waitcnt lgkmcnt(6)
  v_mfma_f32_32x32x16_bf16 v[64:79], a[224:227], a[196:199], v[64:79]
  v_accvgpr_write_b32 a145, 0
  v_mfma_f32_32x32x16_bf16 v[80:95], a[224:227], a[212:215], v[80:95]
  ds_read_b64_tr_b16 a[240:241], v20 offset:30976
  ds_read_b64_tr_b16 a[242:243], v20 offset:32512
  s_waitcnt lgkmcnt(6)
  v_mfma_f32_32x32x16_bf16 v[96:111], a[228:231], a[196:199], v[96:111]
  v_accvgpr_write_b32 a146, 0
  v_mfma_f32_32x32x16_bf16 v[112:127], a[228:231], a[212:215], v[112:127]
  ds_read_b64_tr_b16 a[244:245], v21 offset:30976
  ds_read_b64_tr_b16 a[246:247], v21 offset:32512
  s_waitcnt lgkmcnt(6)
  v_mfma_f32_32x32x16_bf16 v[128:143], a[232:235], a[196:199], v[128:143]
  v_accvgpr_write_b32 a147, 0
  v_mfma_f32_32x32x16_bf16 v[144:159], a[232:235], a[212:215], v[144:159]
  ds_read_b64_tr_b16 a[224:225], v20 offset:36864
  ds_read_b64_tr_b16 a[226:227], v20 offset:38400
  s_waitcnt lgkmcnt(6)
  v_mfma_f32_32x32x16_bf16 v[160:175], a[236:239], a[196:199], v[160:175]
  v_accvgpr_write_b32 a148, 0
  v_mfma_f32_32x32x16_bf16 v[176:191], a[236:239], a[212:215], v[176:191]
  ds_read_b64_tr_b16 a[228:229], v21 offset:36864
  ds_read_b64_tr_b16 a[230:231], v21 offset:38400
  s_waitcnt lgkmcnt(6)
  v_mfma_f32_32x32x16_bf16 v[192:207], a[240:243], a[196:199], v[192:207]
  v_accvgpr_write_b32 a149, 0
  v_mfma_f32_32x32x16_bf16 v[208:223], a[240:243], a[212:215], v[208:223]
  ds_read_b64_tr_b16 a[232:233], v20 offset:36992
  ds_read_b64_tr_b16 a[234:235], v20 offset:38528
  s_waitcnt lgkmcnt(6)
  v_mfma_f32_32x32x16_bf16 v[224:239], a[244:247], a[196:199], v[224:239]
  v_mfma_f32_32x32x16_bf16 v[240:255], a[244:247], a[212:215], v[240:255]
  ds_read_b64_tr_b16 a[236:237], v21 offset:36992
  ds_read_b64_tr_b16 a[238:239], v21 offset:38528
  s_waitcnt vmcnt(11)
  s_barrier
  s_waitcnt lgkmcnt(6)
  v_mfma_f32_32x32x16_bf16 v[64:79], a[224:227], a[200:203], v[64:79]
  s_mul_i32 s39, s51, 393216
  s_add_u32 s51, s51, 1
  s_cmp_eq_u32 s51, 20
  s_cselect_b32 s51, 2, s51
  s_add_u32 m0, s28, 122880
  s_nop 0
  buffer_load_dwordx4 v2, s[8:11], s39 offen offset:0 lds
  v_mfma_f32_32x32x16_bf16 v[80:95], a[224:227], a[216:219], v[80:95]
  ds_read_b64_tr_b16 a[240:241], v20 offset:37120
  ds_read_b64_tr_b16 a[242:243], v20 offset:38656
  s_waitcnt lgkmcnt(6)
  v_mfma_f32_32x32x16_bf16 v[96:111], a[228:231], a[200:203], v[96:111]
  s_add_u32 m0, s28, 122880
  s_nop 0
  buffer_load_dwordx4 v3, s[8:11], s39 offen offset:1024 lds
  s_waitcnt vmcnt(5)
  ds_read_b128 v[32:35], v16 offset:0
  v_accvgpr_write_b32 a150, 0
  v_mfma_f32_32x32x16_bf16 v[112:127], a[228:231], a[216:219], v[112:127]
  ds_read_b64_tr_b16 a[244:245], v21 offset:37120
  ds_read_b64_tr_b16 a[246:247], v21 offset:38656
  ds_read_b128 v[36:39], v17 offset:0
  s_waitcnt lgkmcnt(8)
  v_mfma_f32_32x32x16_bf16 v[128:143], a[232:235], a[200:203], v[128:143]
  s_add_u32 m0, s28, 122880
  s_nop 0
  buffer_load_dwordx4 v4, s[8:11], s39 offen offset:2048 lds
  ds_read_b128 v[40:43], v18 offset:0
  v_accvgpr_write_b32 a151, 0
  v_mfma_f32_32x32x16_bf16 v[144:159], a[232:235], a[216:219], v[144:159]
  ds_read_b64_tr_b16 a[224:225], v20 offset:43008
  ds_read_b64_tr_b16 a[226:227], v20 offset:44544
  ds_read_b128 v[44:47], v19 offset:0
  s_waitcnt lgkmcnt(10)
  v_mfma_f32_32x32x16_bf16 v[160:175], a[236:239], a[200:203], v[160:175]
  ds_read_b128 v[48:51], v16 offset:4096
  v_accvgpr_write_b32 a152, 0
  v_mfma_f32_32x32x16_bf16 v[176:191], a[236:239], a[216:219], v[176:191]
  ds_read_b64_tr_b16 a[228:229], v21 offset:43008
  ds_read_b64_tr_b16 a[230:231], v21 offset:44544
  ds_read_b128 v[52:55], v17 offset:4096
  s_waitcnt lgkmcnt(12)
  v_mfma_f32_32x32x16_bf16 v[192:207], a[240:243], a[200:203], v[192:207]
  ds_read_b128 v[56:59], v18 offset:4096
  v_accvgpr_write_b32 a153, 0
  v_mfma_f32_32x32x16_bf16 v[208:223], a[240:243], a[216:219], v[208:223]
  ds_read_b64_tr_b16 a[232:233], v20 offset:43136
  ds_read_b64_tr_b16 a[234:235], v20 offset:44672
  ds_read_b128 v[60:63], v19 offset:4096
  s_waitcnt lgkmcnt(13)
  v_mfma_f32_32x32x16_bf16 v[224:239], a[244:247], a[200:203], v[224:239]
  v_accvgpr_write_b32 a154, 0
  v_mfma_f32_32x32x16_bf16 v[240:255], a[244:247], a[216:219], v[240:255]
  ds_read_b64_tr_b16 a[236:237], v21 offset:43136
  ds_read_b64_tr_b16 a[238:239], v21 offset:44672
  s_waitcnt lgkmcnt(11)
  v_mfma_f32_32x32x16_bf16 v[64:79], a[224:227], a[204:207], v[64:79]
  v_accvgpr_write_b32 a155, 0
  v_mfma_f32_32x32x16_bf16 v[80:95], a[224:227], a[220:223], v[80:95]
  ds_read_b64_tr_b16 a[240:241], v20 offset:43264
  ds_read_b64_tr_b16 a[242:243], v20 offset:44800
  s_waitcnt lgkmcnt(9)
  v_mfma_f32_32x32x16_bf16 v[96:111], a[228:231], a[204:207], v[96:111]
  s_waitcnt lgkmcnt(4)
  v_accvgpr_write_b32 a156, 0
  v_mfma_f32_32x32x16_bf16 v[112:127], a[228:231], a[220:223], v[112:127]
  ds_read_b64_tr_b16 a[244:245], v21 offset:43264
  ds_read_b64_tr_b16 a[246:247], v21 offset:44800
  s_lshl_b32 s38, s50, 7
  s_add_u32 s50, s50, 1
  s_cmp_eq_u32 s50, 10
  s_cselect_b32 s50, 1, s50
  s_add_u32 m0, s29, 0
  s_nop 0
  buffer_load_dwordx4 v22, s[4:7], s38 offen offset:0 lds
  v_mfma_f32_32x32x16_bf16 v[128:143], a[232:235], a[204:207], v[128:143]
  s_add_u32 m0, s29, 0
  s_nop 0
  buffer_load_dwordx4 v23, s[4:7], s38 offen offset:1024 lds
  v_accvgpr_write_b32 a157, 0
  v_mfma_f32_32x32x16_bf16 v[144:159], a[232:235], a[220:223], v[144:159]
  ds_read_b64_tr_b16 a[224:225], v20 offset:0
  ds_read_b64_tr_b16 a[226:227], v20 offset:1536
  s_add_u32 m0, s29, 0
  s_nop 0
  buffer_load_dwordx4 v24, s[4:7], s38 offen offset:2048 lds
  s_waitcnt lgkmcnt(6)
  v_mfma_f32_32x32x16_bf16 v[160:175], a[236:239], a[204:207], v[160:175]
  s_add_u32 m0, s29, 0
  s_nop 0
  buffer_load_dwordx4 v25, s[4:7], s38 offen offset:3072 lds
  v_accvgpr_write_b32 a158, 0
  v_mfma_f32_32x32x16_bf16 v[176:191], a[236:239], a[220:223], v[176:191]
  ds_read_b64_tr_b16 a[228:229], v21 offset:0
  ds_read_b64_tr_b16 a[230:231], v21 offset:1536
  s_add_u32 m0, s29, 4096
  s_nop 0
  buffer_load_dwordx4 v26, s[4:7], s38 offen offset:0 lds
  s_waitcnt lgkmcnt(6)
  v_mfma_f32_32x32x16_bf16 v[192:207], a[240:243], a[204:207], v[192:207]
  s_add_u32 m0, s29, 4096
  s_nop 0
  buffer_load_dwordx4 v27, s[4:7], s38 offen offset:1024 lds
  v_accvgpr_write_b32 a159, 0
  v_mfma_f32_32x32x16_bf16 v[208:223], a[240:243], a[220:223], v[208:223]
  ds_read_b64_tr_b16 a[232:233], v20 offset:128
  ds_read_b64_tr_b16 a[234:235], v20 offset:1664
  s_add_u32 m0, s29, 4096
  s_nop 0
  buffer_load_dwordx4 v28, s[4:7], s38 offen offset:2048 lds
  s_waitcnt lgkmcnt(6)
  v_mfma_f32_32x32x16_bf16 v[224:239], a[244:247], a[204:207], v[224:239]
  s_add_u32 m0, s29, 4096
  s_nop 0
  buffer_load_dwordx4 v29, s[4:7], s38 offen offset:3072 lds
  v_mfma_f32_32x32x16_bf16 v[240:255], a[244:247], a[220:223], v[240:255]
  ds_read_b64_tr_b16 a[236:237], v21 offset:128
  ds_read_b64_tr_b16 a[238:239], v21 offset:1664
  s_waitcnt vmcnt(11)
  s_barrier
  s_waitcnt lgkmcnt(6)
  v_mfma_f32_32x32x16_bf16 v[64:79], a[224:227], v[32:35], v[64:79]
  s_mul_i32 s39, s51, 393216
  s_add_u32 s51, s51, 1
  s_cmp_eq_u32 s51, 20
  s_cselect_b32 s51, 2, s51
  s_add_u32 m0, s28, 135168
  s_nop 0
  buffer_load_dwordx4 v2, s[8:11], s39 offen offset:0 lds
  v_mfma_f32_32x32x16_bf16 v[80:95], a[224:227], v[48:51], v[80:95]
  ds_read_b64_tr_b16 a[240:241], v20 offset:256
  ds_read_b64_tr_b16 a[242:243], v20 offset:1792
  s_waitcnt lgkmcnt(6)
  v_mfma_f32_32x32x16_bf16 v[96:111], a[228:231], v[32:35], v[96:111]
  s_add_u32 m0, s28, 135168
  s_nop 0
  buffer_load_dwordx4 v3, s[8:11], s39 offen offset:1024 lds
  v_accvgpr_write_b32 a160, 0
  v_mfma_f32_32x32x16_bf16 v[112:127], a[228:231], v[48:51], v[112:127]
  ds_read_b64_tr_b16 a[244:245], v21 offset:256
  ds_read_b64_tr_b16 a[246:247], v21 offset:1792
  s_waitcnt lgkmcnt(6)
  v_mfma_f32_32x32x16_bf16 v[128:143], a[232:235], v[32:35], v[128:143]
  s_add_u32 m0, s28, 135168
  s_nop 0
  buffer_load_dwordx4 v4, s[8:11], s39 offen offset:2048 lds
  v_accvgpr_write_b32 a161, 0
  v_mfma_f32_32x32x16_bf16 v[144:159], a[232:235], v[48:51], v[144:159]
  ds_read_b64_tr_b16 a[224:225], v20 offset:6144
  ds_read_b64_tr_b16 a[226:227], v20 offset:7680
  s_waitcnt lgkmcnt(6)
  v_mfma_f32_32x32x16_bf16 v[160:175], a[236:239], v[32:35], v[160:175]
  v_accvgpr_write_b32 a162, 0
  v_mfma_f32_32x32x16_bf16 v[176:191], a[236:239], v[48:51], v[176:191]
  ds_read_b64_tr_b16 a[228:229], v21 offset:6144
  ds_read_b64_tr_b16 a[230:231], v21 offset:7680
  s_waitcnt lgkmcnt(6)
  v_mfma_f32_32x32x16_bf16 v[192:207], a[240:243], v[32:35], v[192:207]
  v_accvgpr_write_b32 a163, 0
  v_mfma_f32_32x32x16_bf16 v[208:223], a[240:243], v[48:51], v[208:223]
  ds_read_b64_tr_b16 a[232:233], v20 offset:6272
  ds_read_b64_tr_b16 a[234:235], v20 offset:7808
  s_waitcnt lgkmcnt(6)
  v_mfma_f32_32x32x16_bf16 v[224:239], a[244:247], v[32:35], v[224:239]
  v_accvgpr_write_b32 a164, 0
  v_mfma_f32_32x32x16_bf16 v[240:255], a[244:247], v[48:51], v[240:255]
  ds_read_b64_tr_b16 a[236:237], v21 offset:6272
  ds_read_b64_tr_b16 a[238:239], v21 offset:7808
  s_waitcnt lgkmcnt(6)
  v_mfma_f32_32x32x16_bf16 v[64:79], a[224:227], v[36:39], v[64:79]
  v_accvgpr_write_b32 a165, 0
  v_mfma_f32_32x32x16_bf16 v[80:95], a[224:227], v[52:55], v[80:95]
  ds_read_b64_tr_b16 a[240:241], v20 offset:6400
  ds_read_b64_tr_b16 a[242:243], v20 offset:7936
  s_waitcnt lgkmcnt(6)
  v_mfma_f32_32x32x16_bf16 v[96:111], a[228:231], v[36:39], v[96:111]
  v_accvgpr_write_b32 a166, 0
  v_mfma_f32_32x32x16_bf16 v[112:127], a[228:231], v[52:55], v[112:127]
  ds_read_b64_tr_b16 a[244:245], v21 offset:6400
  ds_read_b64_tr_b16 a[246:247], v21 offset:7936
  s_waitcnt lgkmcnt(6)
  v_mfma_f32_32x32x16_bf16 v[128:143], a[232:235], v[36:39], v[128:143]
  v_accvgpr_write_b32 a167, 0
  v_mfma_f32_32x32x16_bf16 v[144:159], a[232:235], v[52:55], v[144:159]
  ds_read_b64_tr_b16 a[224:225], v20 offset:12288
  ds_read_b64_tr_b16 a[226:227], v20 offset:13824
  s_waitcnt lgkmcnt(6)
  v_mfma_f32_32x32x16_bf16 v[160:175], a[236:239], v[36:39], v[160:175]
  v_accvgpr_write_b32 a168, 0
  v_mfma_f32_32x32x16_bf16 v[176:191], a[236:239], v[52:55], v[176:191]
  ds_read_b64_tr_b16 a[228:229], v21 offset:12288
  ds_read_b64_tr_b16 a[230:231], v21 offset:13824
  s_waitcnt lgkmcnt(6)
  v_mfma_f32_32x32x16_bf16 v[192:207], a[240:243], v[36:39], v[192:207]
  v_accvgpr_write_b32 a169, 0
  v_mfma_f32_32x32x16_bf16 v[208:223], a[240:243], v[52:55], v[208:223]
  ds_read_b64_tr_b16 a[232:233], v20 offset:12416
  ds_read_b64_tr_b16 a[234:235], v20 offset:13952
  s_waitcnt lgkmcnt(6)
  v_mfma_f32_32x32x16_bf16 v[224:239], a[244:247], v[36:39], v[224:239]
  v_mfma_f32_32x32x16_bf16 v[240:255], a[244:247], v[52:55], v[240:255]
  ds_read_b64_tr_b16 a[236:237], v21 offset:12416
  ds_read_b64_tr_b16 a[238:239], v21 offset:13952
  s_waitcnt vmcnt(11)
  s_barrier
  s_waitcnt lgkmcnt(6)
  v_mfma_f32_32x32x16_bf16 v[64:79], a[224:227], v[40:43], v[64:79]
  v_mfma_f32_32x32x16_bf16 v[80:95], a[224:227], v[56:59], v[80:95]
  ds_read_b64_tr_b16 a[240:241], v20 offset:12544
  ds_read_b64_tr_b16 a[242:243], v20 offset:14080
  s_waitcnt lgkmcnt(6)
  v_mfma_f32_32x32x16_bf16 v[96:111], a[228:231], v[40:43], v[96:111]
  s_waitcnt vmcnt(3)
  ds_read_b128 a[192:195], v16 offset:0
  v_accvgpr_write_b32 a170, 0
  v_mfma_f32_32x32x16_bf16 v[112:127], a[228:231], v[56:59], v[112:127]
  ds_read_b64_tr_b16 a[244:245], v21 offset:12544
  ds_read_b64_tr_b16 a[246:247], v21 offset:14080
  ds_read_b128 a[196:199], v17 offset:0
  s_waitcnt lgkmcnt(8)
  v_mfma_f32_32x32x16_bf16 v[128:143], a[232:235], v[40:43], v[128:143]
  ds_read_b128 a[200:203], v18 offset:0
  s_add_u32 s33, s48, 24576
  s_sub_u32 s44, s33, 393216
  s_cmp_ge_u32 s33, 393216
  s_cselect_b32 s33, s44, s33
  s_add_u32 m0, s28, 98304
  s_nop 0
  buffer_load_dwordx4 v13, s[16:19], s33 offen offset:0 nt lds
  s_add_u32 m0, s28, 98304
  s_nop 0
  buffer_load_dwordx4 v14, s[16:19], s33 offen offset:1024 nt lds
  s_add_u32 m0, s28, 98304
  s_nop 0
  buffer_load_dwordx4 v15, s[16:19], s33 offen offset:2048 nt lds
  v_accvgpr_write_b32 a171, 0
  v_mfma_f32_32x32x16_bf16 v[144:159], a[232:235], v[56:59], v[144:159]
  ds_read_b64_tr_b16 a[224:225], v20 offset:18432
  ds_read_b64_tr_b16 a[226:227], v20 offset:19968
  ds_read_b128 a[204:207], v19 offset:0
  s_waitcnt lgkmcnt(10)
  v_mfma_f32_32x32x16_bf16 v[160:175], a[236:239], v[40:43], v[160:175]
  ds_read_b128 a[208:211], v16 offset:4096
  v_accvgpr_write_b32 a172, 0
  v_mfma_f32_32x32x16_bf16 v[176:191], a[236:239], v[56:59], v[176:191]
  ds_read_b64_tr_b16 a[228:229], v21 offset:18432
  ds_read_b64_tr_b16 a[230:231], v21 offset:19968
  ds_read_b128 a[212:215], v17 offset:4096
  s_waitcnt lgkmcnt(12)
  v_mfma_f32_32x32x16_bf16 v[192:207], a[240:243], v[40:43], v[192:207]
  ds_read_b128 a[216:219], v18 offset:4096
  v_accvgpr_write_b32 a173, 0
  v_mfma_f32_32x32x16_bf16 v[208:223], a[240:243], v[56:59], v[208:223]
  ds_read_b64_tr_b16 a[232:233], v20 offset:18560
  ds_read_b64_tr_b16 a[234:235], v20 offset:20096
  ds_read_b128 a[220:223], v19 offset:4096
  s_waitcnt lgkmcnt(13)
  v_mfma_f32_32x32x16_bf16 v[224:239], a[244:247], v[40:43], v[224:239]
  v_accvgpr_write_b32 a174, 0
  v_mfma_f32_32x32x16_bf16 v[240:255], a[244:247], v[56:59], v[240:255]
  ds_read_b64_tr_b16 a[236:237], v21 offset:18560
  ds_read_b64_tr_b16 a[238:239], v21 offset:20096
  s_waitcnt lgkmcnt(11)
  v_mfma_f32_32x32x16_bf16 v[64:79], a[224:227], v[44:47], v[64:79]
  v_accvgpr_write_b32 a175, 0
  v_mfma_f32_32x32x16_bf16 v[80:95], a[224:227], v[60:63], v[80:95]
  ds_read_b64_tr_b16 a[240:241], v20 offset:18688
  ds_read_b64_tr_b16 a[242:243], v20 offset:20224
  s_waitcnt lgkmcnt(9)
  v_mfma_f32_32x32x16_bf16 v[96:111], a[228:231], v[44:47], v[96:111]
  v_accvgpr_write_b32 a176, 0
  v_mfma_f32_32x32x16_bf16 v[112:127], a[228:231], v[60:63], v[112:127]
  ds_read_b64_tr_b16 a[244:245], v21 offset:18688
  ds_read_b64_tr_b16 a[246:247], v21 offset:20224
  s_waitcnt lgkmcnt(7)
  v_mfma_f32_32x32x16_bf16 v[128:143], a[232:235], v[44:47], v[128:143]
  v_accvgpr_write_b32 a177, 0
  v_mfma_f32_32x32x16_bf16 v[144:159], a[232:235], v[60:63], v[144:159]
  ds_read_b64_tr_b16 a[224:225], v20 offset:24576
  ds_read_b64_tr_b16 a[226:227], v20 offset:26112
  s_waitcnt lgkmcnt(6)
  v_mfma_f32_32x32x16_bf16 v[160:175], a[236:239], v[44:47], v[160:175]
  v_accvgpr_write_b32 a178, 0
  v_mfma_f32_32x32x16_bf16 v[176:191], a[236:239], v[60:63], v[176:191]
  ds_read_b64_tr_b16 a[228:229], v21 offset:24576
  ds_read_b64_tr_b16 a[230:231], v21 offset:26112
  s_waitcnt lgkmcnt(6)
  v_mfma_f32_32x32x16_bf16 v[192:207], a[240:243], v[44:47], v[192:207]
  v_accvgpr_write_b32 a179, 0
  v_mfma_f32_32x32x16_bf16 v[208:223], a[240:243], v[60:63], v[208:223]
  ds_read_b64_tr_b16 a[232:233], v20 offset:24704
  ds_read_b64_tr_b16 a[234:235], v20 offset:26240
  s_waitcnt lgkmcnt(6)
  v_mfma_f32_32x32x16_bf16 v[224:239], a[244:247], v[44:47], v[224:239]
  v_mfma_f32_32x32x16_bf16 v[240:255], a[244:247], v[60:63], v[240:255]
  ds_read_b64_tr_b16 a[236:237], v21 offset:24704
  ds_read_b64_tr_b16 a[238:239], v21 offset:26240
  s_waitcnt vmcnt(3)
  s_barrier
  s_waitcnt lgkmcnt(6)
  v_mfma_f32_32x32x16_bf16 v[64:79], a[224:227], a[192:195], v[64:79]
  v_mfma_f32_32x32x16_bf16 v[80:95], a[224:227], a[208:211], v[80:95]
  ds_read_b64_tr_b16 a[240:241], v20 offset:24832
  ds_read_b64_tr_b16 a[242:243], v20 offset:26368
  s_waitcnt lgkmcnt(6)
  v_mfma_f32_32x32x16_bf16 v[96:111], a[228:231], a[192:195], v[96:111]
  s_add_u32 s33, s48, 49152
  s_sub_u32 s44, s33, 393216
  s_cmp_ge_u32 s33, 393216
  s_cselect_b32 s33, s44, s33
  s_add_u32 m0, s28, 49152
  s_nop 0
  buffer_load_dwordx4 v10, s[12:15], s33 offen offset:0 nt lds
  s_add_u32 m0, s28, 49152
  s_nop 0
  buffer_load_dwordx4 v11, s[12:15], s33 offen offset:1024 nt lds
  s_add_u32 m0, s28, 49152
  s_nop 0
  buffer_load_dwordx4 v12, s[12:15], s33 offen offset:2048 nt lds
  v_accvgpr_write_b32 a180, 0
  v_mfma_f32_32x32x16_bf16 v[112:127], a[228:231], a[208:211], v[112:127]
  ds_read_b64_tr_b16 a[244:245], v21 offset:24832
  ds_read_b64_tr_b16 a[246:247], v21 offset:26368
  s_waitcnt lgkmcnt(6)
  v_mfma_f32_32x32x16_bf16 v[128:143], a[232:235], a[192:195], v[128:143]
  v_accvgpr_write_b32 a181, 0
  v_mfma_f32_32x32x16_bf16 v[144:159], a[232:235], a[208:211], v[144:159]
  ds_read_b64_tr_b16 a[224:225], v20 offset:30720
  ds_read_b64_tr_b16 a[226:227], v20 offset:32256
  s_waitcnt lgkmcnt(6)
  v_mfma_f32_32x32x16_bf16 v[160:175], a[236:239], a[192:195], v[160:175]
  v_accvgpr_write_b32 a182, 0
  v_mfma_f32_32x32x16_bf16 v[176:191], a[236:239], a[208:211], v[176:191]
  ds_read_b64_tr_b16 a[228:229], v21 offset:30720
  ds_read_b64_tr_b16 a[230:231], v21 offset:32256
  s_waitcnt lgkmcnt(6)
  v_mfma_f32_32x32x16_bf16 v[192:207], a[240:243], a[192:195], v[192:207]
  s_add_u32 s33, s48, 36864
  s_sub_u32 s44, s33, 393216
  s_cmp_ge_u32 s33, 393216
  s_cselect_b32 s33, s44, s33
  s_add_u32 m0, s28, 110592
  s_nop 0
  buffer_load_dwordx4 v13, s[16:19], s33 offen offset:0 nt lds
  s_add_u32 m0, s28, 110592
  s_nop 0
  buffer_load_dwordx4 v14, s[16:19], s33 offen offset:1024 nt lds
  s_add_u32 m0, s28, 110592
  s_nop 0
  buffer_load_dwordx4 v15, s[16:19], s33 offen offset:2048 nt lds
  v_accvgpr_write_b32 a183, 0
  v_mfma_f32_32x32x16_bf16 v[208:223], a[240:243], a[208:211], v[208:223]
  ds_read_b64_tr_b16 a[232:233], v20 offset:30848
  ds_read_b64_tr_b16 a[234:235], v20 offset:32384
  s_waitcnt lgkmcnt(6)
  v_mfma_f32_32x32x16_bf16 v[224:239], a[244:247], a[192:195], v[224:239]
  v_accvgpr_write_b32 a184, 0
  v_mfma_f32_32x32x16_bf16 v[240:255], a[244:247], a[208:211], v[240:255]
  ds_read_b64_tr_b16 a[236:237], v21 offset:30848
  ds_read_b64_tr_b16 a[238:239], v21 offset:32384
  s_waitcnt lgkmcnt(6)
  v_mfma_f32_32x32x16_bf16 v[64:79], a[224:227], a[196:199], v[64:79]
  v_accvgpr_write_b32 a185, 0
  v_mfma_f32_32x32x16_bf16 v[80:95], a[224:227], a[212:215], v[80:95]
  ds_read_b64_tr_b16 a[240:241], v20 offset:30976
  ds_read_b64_tr_b16 a[242:243], v20 offset:32512
  s_waitcnt lgkmcnt(6)
  v_mfma_f32_32x32x16_bf16 v[96:111], a[228:231], a[196:199], v[96:111]
  s_add_u32 s33, s48, 61440
  s_sub_u32 s44, s33, 393216
  s_cmp_ge_u32 s33, 393216
  s_cselect_b32 s33, s44, s33
  s_add_u32 m0, s28, 61440
  s_nop 0
  buffer_load_dwordx4 v10, s[12:15], s33 offen offset:0 nt lds
  s_add_u32 m0, s28, 61440
  s_nop 0
  buffer_load_dwordx4 v11, s[12:15], s33 offen offset:1024 nt lds
  s_add_u32 m0, s28, 61440
  s_nop 0
  buffer_load_dwordx4 v12, s[12:15], s33 offen offset:2048 nt lds
  v_accvgpr_write_b32 a186, 0
  v_mfma_f32_32x32x16_bf16 v[112:127], a[228:231], a[212:215], v[112:127]
  ds_read_b64_tr_b16 a[244:245], v21 offset:30976
  ds_read_b64_tr_b16 a[246:247], v21 offset:32512
  s_waitcnt lgkmcnt(6)
  v_mfma_f32_32x32x16_bf16 v[128:143], a[232:235], a[196:199], v[128:143]
  v_accvgpr_write_b32 a187, 0
  v_mfma_f32_32x32x16_bf16 v[144:159], a[232:235], a[212:215], v[144:159]
  ds_read_b64_tr_b16 a[224:225], v20 offset:36864
  ds_read_b64_tr_b16 a[226:227], v20 offset:38400
  s_waitcnt lgkmcnt(6)
  v_mfma_f32_32x32x16_bf16 v[160:175], a[236:239], a[196:199], v[160:175]
  v_accvgpr_write_b32 a188, 0
  v_mfma_f32_32x32x16_bf16 v[176:191], a[236:239], a[212:215], v[176:191]
  ds_read_b64_tr_b16 a[228:229], v21 offset:36864
  ds_read_b64_tr_b16 a[230:231], v21 offset:38400
  s_waitcnt lgkmcnt(6)
  v_mfma_f32_32x32x16_bf16 v[192:207], a[240:243], a[196:199], v[192:207]
  v_accvgpr_write_b32 a189, 0
  v_mfma_f32_32x32x16_bf16 v[208:223], a[240:243], a[212:215], v[208:223]
  ds_read_b64_tr_b16 a[232:233], v20 offset:36992
  ds_read_b64_tr_b16 a[234:235], v20 offset:38528
  s_waitcnt lgkmcnt(6)
  v_mfma_f32_32x32x16_bf16 v[224:239], a[244:247], a[196:199], v[224:239]
  v_mfma_f32_32x32x16_bf16 v[240:255], a[244:247], a[212:215], v[240:255]
  ds_read_b64_tr_b16 a[236:237], v21 offset:36992
  ds_read_b64_tr_b16 a[238:239], v21 offset:38528
  s_barrier
  s_waitcnt lgkmcnt(6)
  v_mfma_f32_32x32x16_bf16 v[64:79], a[224:227], a[200:203], v[64:79]
  v_mfma_f32_32x32x16_bf16 v[80:95], a[224:227], a[216:219], v[80:95]
  ds_read_b64_tr_b16 a[240:241], v20 offset:37120
  ds_read_b64_tr_b16 a[242:243], v20 offset:38656
  s_waitcnt lgkmcnt(6)
  v_mfma_f32_32x32x16_bf16 v[96:111], a[228:231], a[200:203], v[96:111]
  s_add_u32 s33, s48, 49152
  s_sub_u32 s44, s33, 393216
  s_cmp_ge_u32 s33, 393216
  s_cselect_b32 s33, s44, s33
  s_add_u32 m0, s28, 122880
  s_nop 0
  buffer_load_dwordx4 v13, s[16:19], s33 offen offset:0 nt lds
  s_add_u32 m0, s28, 122880
  s_nop 0
  buffer_load_dwordx4 v14, s[16:19], s33 offen offset:1024 nt lds
  s_add_u32 m0, s28, 122880
  s_nop 0
  buffer_load_dwordx4 v15, s[16:19], s33 offen offset:2048 nt lds
  v_accvgpr_write_b32 a190, 0
  v_mfma_f32_32x32x16_bf16 v[112:127], a[228:231], a[216:219], v[112:127]
  ds_read_b64_tr_b16 a[244:245], v21 offset:37120
  ds_read_b64_tr_b16 a[246:247], v21 offset:38656
  s_waitcnt lgkmcnt(6)
  v_mfma_f32_32x32x16_bf16 v[128:143], a[232:235], a[200:203], v[128:143]
  v_accvgpr_write_b32 a191, 0
  v_mfma_f32_32x32x16_bf16 v[144:159], a[232:235], a[216:219], v[144:159]
  ds_read_b64_tr_b16 a[224:225], v20 offset:43008
  ds_read_b64_tr_b16 a[226:227], v20 offset:44544
  s_waitcnt lgkmcnt(6)
  v_mfma_f32_32x32x16_bf16 v[160:175], a[236:239], a[200:203], v[160:175]
  v_mfma_f32_32x32x16_bf16 v[176:191], a[236:239], a[216:219], v[176:191]
  ds_read_b64_tr_b16 a[228:229], v21 offset:43008
  ds_read_b64_tr_b16 a[230:231], v21 offset:44544
  s_waitcnt lgkmcnt(6)
  v_mfma_f32_32x32x16_bf16 v[192:207], a[240:243], a[200:203], v[192:207]
  v_mfma_f32_32x32x16_bf16 v[208:223], a[240:243], a[216:219], v[208:223]
  ds_read_b64_tr_b16 a[232:233], v20 offset:43136
  ds_read_b64_tr_b16 a[234:235], v20 offset:44672
  s_waitcnt lgkmcnt(6)
  v_mfma_f32_32x32x16_bf16 v[224:239], a[244:247], a[200:203], v[224:239]
  v_mfma_f32_32x32x16_bf16 v[240:255], a[244:247], a[216:219], v[240:255]
  ds_read_b64_tr_b16 a[236:237], v21 offset:43136
  ds_read_b64_tr_b16 a[238:239], v21 offset:44672
  s_waitcnt lgkmcnt(6)
  v_mfma_f32_32x32x16_bf16 v[64:79], a[224:227], a[204:207], v[64:79]
  v_mfma_f32_32x32x16_bf16 v[80:95], a[224:227], a[220:223], v[80:95]
  ds_read_b64_tr_b16 a[240:241], v20 offset:43264
  ds_read_b64_tr_b16 a[242:243], v20 offset:44800
  s_waitcnt lgkmcnt(6)
  v_mfma_f32_32x32x16_bf16 v[96:111], a[228:231], a[204:207], v[96:111]
  v_mfma_f32_32x32x16_bf16 v[112:127], a[228:231], a[220:223], v[112:127]
  ds_read_b64_tr_b16 a[244:245], v21 offset:43264
  ds_read_b64_tr_b16 a[246:247], v21 offset:44800
  s_waitcnt lgkmcnt(6)
  v_mfma_f32_32x32x16_bf16 v[128:143], a[232:235], a[204:207], v[128:143]
  v_mfma_f32_32x32x16_bf16 v[144:159], a[232:235], a[220:223], v[144:159]
  s_waitcnt lgkmcnt(4)
  v_mfma_f32_32x32x16_bf16 v[160:175], a[236:239], a[204:207], v[160:175]
  v_mfma_f32_32x32x16_bf16 v[176:191], a[236:239], a[220:223], v[176:191]
  s_waitcnt lgkmcnt(2)
  v_mfma_f32_32x32x16_bf16 v[192:207], a[240:243], a[204:207], v[192:207]
  v_mfma_f32_32x32x16_bf16 v[208:223], a[240:243], a[220:223], v[208:223]
  s_waitcnt lgkmcnt(0)
  v_mfma_f32_32x32x16_bf16 v[224:239], a[244:247], a[204:207], v[224:239]
  v_mfma_f32_32x32x16_bf16 v[240:255], a[244:247], a[220:223], v[240:255]
  s_nop 11
  v_pk_mul_f32 v[254:255], v[254:255], s[34:35]
  v_cvt_pk_bf16_f32 v255, v254, v255
  v_pk_mul_f32 v[252:253], v[252:253], s[34:35]
  v_cvt_pk_bf16_f32 v254, v252, v253
  v_pk_mul_f32 v[250:251], v[250:251], s[34:35]
  v_cvt_pk_bf16_f32 v253, v250, v251
  v_pk_mul_f32 v[248:249], v[248:249], s[34:35]
  v_cvt_pk_bf16_f32 v252, v248, v249
  v_pk_mul_f32 v[246:247], v[246:247], s[34:35]
  v_cvt_pk_bf16_f32 v251, v246, v247
  v_pk_mul_f32 v[244:245], v[244:245], s[34:35]
  v_cvt_pk_bf16_f32 v250, v244, v245
  v_pk_mul_f32 v[242:243], v[242:243], s[34:35]
  v_cvt_pk_bf16_f32 v249, v242, v243
  v_pk_mul_f32 v[240:241], v[240:241], s[34:35]
  v_cvt_pk_bf16_f32 v248, v240, v241
  v_pk_mul_f32 v[238:239], v[238:239], s[34:35]
  v_cvt_pk_bf16_f32 v247, v238, v239
  v_pk_mul_f32 v[236:237], v[236:237], s[34:35]
  v_cvt_pk_bf16_f32 v246, v236, v237
  v_pk_mul_f32 v[234:235], v[234:235], s[34:35]
  v_cvt_pk_bf16_f32 v245, v234, v235
  v_pk_mul_f32 v[232:233], v[232:233], s[34:35]
  v_cvt_pk_bf16_f32 v244, v232, v233
  v_pk_mul_f32 v[230:231], v[230:231], s[34:35]
  v_cvt_pk_bf16_f32 v243, v230, v231
  v_pk_mul_f32 v[228:229], v[228:229], s[34:35]
  v_cvt_pk_bf16_f32 v242, v228, v229
  v_pk_mul_f32 v[226:227], v[226:227], s[34:35]
  v_cvt_pk_bf16_f32 v241, v226, v227
  v_pk_mul_f32 v[224:225], v[224:225], s[34:35]
  v_cvt_pk_bf16_f32 v240, v224, v225
  v_pk_mul_f32 v[222:223], v[222:223], s[34:35]
  v_cvt_pk_bf16_f32 v239, v222, v223
  v_pk_mul_f32 v[220:221], v[220:221], s[34:35]
  v_cvt_pk_bf16_f32 v238, v220, v221
  v_pk_mul_f32 v[218:219], v[218:219], s[34:35]
  v_cvt_pk_bf16_f32 v237, v218, v219
  v_pk_mul_f32 v[216:217], v[216:217], s[34:35]
  v_cvt_pk_bf16_f32 v236, v216, v217
  v_pk_mul_f32 v[214:215], v[214:215], s[34:35]
  v_cvt_pk_bf16_f32 v235, v214, v215
  v_pk_mul_f32 v[212:213], v[212:213], s[34:35]
  v_cvt_pk_bf16_f32 v234, v212, v213
  v_pk_mul_f32 v[210:211], v[210:211], s[34:35]
  v_cvt_pk_bf16_f32 v233, v210, v211
  v_pk_mul_f32 v[208:209], v[208:209], s[34:35]
  v_cvt_pk_bf16_f32 v232, v208, v209
  v_pk_mul_f32 v[206:207], v[206:207], s[34:35]
  v_cvt_pk_bf16_f32 v231, v206, v207
  v_pk_mul_f32 v[204:205], v[204:205], s[34:35]
  v_cvt_pk_bf16_f32 v230, v204, v205
  v_pk_mul_f32 v[202:203], v[202:203], s[34:35]
  v_cvt_pk_bf16_f32 v229, v202, v203
  v_pk_mul_f32 v[200:201], v[200:201], s[34:35]
  v_cvt_pk_bf16_f32 v228, v200, v201
  v_pk_mul_f32 v[198:199], v[198:199], s[34:35]
  v_cvt_pk_bf16_f32 v227, v198, v199
  v_pk_mul_f32 v[196:197], v[196:197], s[34:35]
  v_cvt_pk_bf16_f32 v226, v196, v197
  v_pk_mul_f32 v[194:195], v[194:195], s[34:35]
  v_cvt_pk_bf16_f32 v225, v194, v195
  v_pk_mul_f32 v[192:193], v[192:193], s[34:35]
  v_cvt_pk_bf16_f32 v224, v192, v193
  v_pk_mul_f32 v[190:191], v[190:191], s[34:35]
  v_cvt_pk_bf16_f32 v223, v190, v191
  v_pk_mul_f32 v[188:189], v[188:189], s[34:35]
  v_cvt_pk_bf16_f32 v222, v188, v189
  v_pk_mul_f32 v[186:187], v[186:187], s[34:35]
  v_cvt_pk_bf16_f32 v221, v186, v187
  v_pk_mul_f32 v[184:185], v[184:185], s[34:35]
  v_cvt_pk_bf16_f32 v220, v184, v185
  v_pk_mul_f32 v[182:183], v[182:183], s[34:35]
  v_cvt_pk_bf16_f32 v219, v182, v183
  v_pk_mul_f32 v[180:181], v[180:181], s[34:35]
  v_cvt_pk_bf16_f32 v218, v180, v181
  v_pk_mul_f32 v[178:179], v[178:179], s[34:35]
  v_cvt_pk_bf16_f32 v217, v178, v179
  v_pk_mul_f32 v[176:177], v[176:177], s[34:35]
  v_cvt_pk_bf16_f32 v216, v176, v177
  v_pk_mul_f32 v[174:175], v[174:175], s[34:35]
  v_cvt_pk_bf16_f32 v215, v174, v175
  v_pk_mul_f32 v[172:173], v[172:173], s[34:35]
  v_cvt_pk_bf16_f32 v214, v172, v173
  v_pk_mul_f32 v[170:171], v[170:171], s[34:35]
  v_cvt_pk_bf16_f32 v213, v170, v171
  v_pk_mul_f32 v[168:169], v[168:169], s[34:35]
  v_cvt_pk_bf16_f32 v212, v168, v169
  v_pk_mul_f32 v[166:167], v[166:167], s[34:35]
  v_cvt_pk_bf16_f32 v211, v166, v167
  v_pk_mul_f32 v[164:165], v[164:165], s[34:35]
  v_cvt_pk_bf16_f32 v210, v164, v165
  v_pk_mul_f32 v[162:163], v[162:163], s[34:35]
  v_cvt_pk_bf16_f32 v209, v162, v163
  v_pk_mul_f32 v[160:161], v[160:161], s[34:35]
  v_cvt_pk_bf16_f32 v208, v160, v161
  v_pk_mul_f32 v[158:159], v[158:159], s[34:35]
  v_cvt_pk_bf16_f32 v207, v158, v159
  v_pk_mul_f32 v[156:157], v[156:157], s[34:35]
  v_cvt_pk_bf16_f32 v206, v156, v157
  v_pk_mul_f32 v[154:155], v[154:155], s[34:35]
  v_cvt_pk_bf16_f32 v205, v154, v155
  v_pk_mul_f32 v[152:153], v[152:153], s[34:35]
  v_cvt_pk_bf16_f32 v204, v152, v153
  v_pk_mul_f32 v[150:151], v[150:151], s[34:35]
  v_cvt_pk_bf16_f32 v203, v150, v151
  v_pk_mul_f32 v[148:149], v[148:149], s[34:35]
  v_cvt_pk_bf16_f32 v202, v148, v149
  v_pk_mul_f32 v[146:147], v[146:147], s[34:35]
  v_cvt_pk_bf16_f32 v201, v146, v147
  v_pk_mul_f32 v[144:145], v[144:145], s[34:35]
  v_cvt_pk_bf16_f32 v200, v144, v145
  v_pk_mul_f32 v[142:143], v[142:143], s[34:35]
  v_cvt_pk_bf16_f32 v199, v142, v143
  v_pk_mul_f32 v[140:141], v[140:141], s[34:35]
  v_cvt_pk_bf16_f32 v198, v140, v141
  v_pk_mul_f32 v[138:139], v[138:139], s[34:35]
  v_cvt_pk_bf16_f32 v197, v138, v139
  v_pk_mul_f32 v[136:137], v[136:137], s[34:35]
  v_cvt_pk_bf16_f32 v196, v136, v137
  v_pk_mul_f32 v[134:135], v[134:135], s[34:35]
  v_cvt_pk_bf16_f32 v195, v134, v135
  v_pk_mul_f32 v[132:133], v[132:133], s[34:35]
  v_cvt_pk_bf16_f32 v194, v132, v133
  v_pk_mul_f32 v[130:131], v[130:131], s[34:35]
  v_cvt_pk_bf16_f32 v193, v130, v131
  v_pk_mul_f32 v[128:129], v[128:129], s[34:35]
  v_cvt_pk_bf16_f32 v192, v128, v129
  v_pk_mul_f32 v[126:127], v[126:127], s[34:35]
  v_cvt_pk_bf16_f32 v191, v126, v127
  v_pk_mul_f32 v[124:125], v[124:125], s[34:35]
  v_cvt_pk_bf16_f32 v190, v124, v125
  v_pk_mul_f32 v[122:123], v[122:123], s[34:35]
  v_cvt_pk_bf16_f32 v189, v122, v123
  v_pk_mul_f32 v[120:121], v[120:121], s[34:35]
  v_cvt_pk_bf16_f32 v188, v120, v121
  v_pk_mul_f32 v[118:119], v[118:119], s[34:35]
  v_cvt_pk_bf16_f32 v187, v118, v119
  v_pk_mul_f32 v[116:117], v[116:117], s[34:35]
  v_cvt_pk_bf16_f32 v186, v116, v117
  v_pk_mul_f32 v[114:115], v[114:115], s[34:35]
  v_cvt_pk_bf16_f32 v185, v114, v115
  v_pk_mul_f32 v[112:113], v[112:113], s[34:35]
  v_cvt_pk_bf16_f32 v184, v112, v113
  v_pk_mul_f32 v[110:111], v[110:111], s[34:35]
  v_cvt_pk_bf16_f32 v183, v110, v111
  v_pk_mul_f32 v[108:109], v[108:109], s[34:35]
  v_cvt_pk_bf16_f32 v182, v108, v109
  v_pk_mul_f32 v[106:107], v[106:107], s[34:35]
  v_cvt_pk_bf16_f32 v181, v106, v107
  v_pk_mul_f32 v[104:105], v[104:105], s[34:35]
  v_cvt_pk_bf16_f32 v180, v104, v105
  v_pk_mul_f32 v[102:103], v[102:103], s[34:35]
  v_cvt_pk_bf16_f32 v179, v102, v103
  v_pk_mul_f32 v[100:101], v[100:101], s[34:35]
  v_cvt_pk_bf16_f32 v178, v100, v101
  v_pk_mul_f32 v[98:99], v[98:99], s[34:35]
  v_cvt_pk_bf16_f32 v177, v98, v99
  v_pk_mul_f32 v[96:97], v[96:97], s[34:35]
  v_cvt_pk_bf16_f32 v176, v96, v97
  v_pk_mul_f32 v[94:95], v[94:95], s[34:35]
  v_cvt_pk_bf16_f32 v175, v94, v95
  v_pk_mul_f32 v[92:93], v[92:93], s[34:35]
  v_cvt_pk_bf16_f32 v174, v92, v93
  v_pk_mul_f32 v[90:91], v[90:91], s[34:35]
  v_cvt_pk_bf16_f32 v173, v90, v91
  v_pk_mul_f32 v[88:89], v[88:89], s[34:35]
  v_cvt_pk_bf16_f32 v172, v88, v89
  v_pk_mul_f32 v[86:87], v[86:87], s[34:35]
  v_cvt_pk_bf16_f32 v171, v86, v87
  v_pk_mul_f32 v[84:85], v[84:85], s[34:35]
  v_cvt_pk_bf16_f32 v170, v84, v85
  v_pk_mul_f32 v[82:83], v[82:83], s[34:35]
  v_cvt_pk_bf16_f32 v169, v82, v83
  v_pk_mul_f32 v[80:81], v[80:81], s[34:35]
  v_cvt_pk_bf16_f32 v168, v80, v81
  v_pk_mul_f32 v[78:79], v[78:79], s[34:35]
  v_cvt_pk_bf16_f32 v167, v78, v79
  v_pk_mul_f32 v[76:77], v[76:77], s[34:35]
  v_cvt_pk_bf16_f32 v166, v76, v77
  v_pk_mul_f32 v[74:75], v[74:75], s[34:35]
  v_cvt_pk_bf16_f32 v165, v74, v75
  v_pk_mul_f32 v[72:73], v[72:73], s[34:35]
  v_cvt_pk_bf16_f32 v164, v72, v73
  v_pk_mul_f32 v[70:71], v[70:71], s[34:35]
  v_cvt_pk_bf16_f32 v163, v70, v71
  v_pk_mul_f32 v[68:69], v[68:69], s[34:35]
  v_cvt_pk_bf16_f32 v162, v68, v69
  v_pk_mul_f32 v[66:67], v[66:67], s[34:35]
  v_cvt_pk_bf16_f32 v161, v66, v67
  v_pk_mul_f32 v[64:65], v[64:65], s[34:35]
  v_cvt_pk_bf16_f32 v160, v64, v65
  v_and_b32 v64, 31, v1
  v_lshrrev_b32 v65, 5, v1
  v_bfe_u32 v66, v64, 1, 3
  v_xor_b32 v65, v65, v66
  v_lshlrev_b32 v65, 4, v65
  v_mul_u32_u24 v64, 384, v64
  v_xor_b32 v66, 0, v65
  v_add_u32 v2, v64, v66
  v_xor_b32 v66, 32, v65
  v_add_u32 v3, v64, v66
  v_xor_b32 v66, 64, v65
  v_add_u32 v4, v64, v66
  v_xor_b32 v66, 96, v65
  v_add_u32 v5, v64, v66
  v_bfe_u32 v64, v1, 4, 1
  v_lshrrev_b32 v65, 5, v1
  v_bfe_u32 v66, v1, 2, 2
  v_and_b32 v67, 3, v1
  v_lshrrev_b32 v68, 1, v66
  v_mul_u32_u24 v69, 4, v65
  v_add_u32 v69, v69, v66
  v_mul_u32_u24 v69, 384, v69
  v_lshlrev_b32 v70, 5, v64
  v_add_u32 v69, v69, v70
  v_lshlrev_b32 v70, 3, v67
  v_add_u32 v69, v69, v70
  v_add_u32 v69, 73728, v69
  v_lshlrev_b32 v70, 6, v68
  v_add_u32 v6, v69, v70
  v_sub_u32 v7, v69, v70
  v_add_u32 v7, 64, v7
  v_add_u32 v8, 36864, v6
  v_add_u32 v9, 36864, v7
  v_mov_b32 v32, 0
  v_mov_b32 v33, 0
  v_mov_b32 v34, 0
  v_mov_b32 v35, 0
  v_mov_b32 v36, 0
  v_mov_b32 v37, 0
  v_mov_b32 v38, 0
  v_mov_b32 v39, 0
  v_mov_b32 v40, 0
  v_mov_b32 v41, 0
  v_mov_b32 v42, 0
  v_mov_b32 v43, 0
  v_mov_b32 v44, 0
  v_mov_b32 v45, 0
  v_mov_b32 v46, 0
  v_mov_b32 v47, 0
  v_mov_b32 v48, 0
  v_mov_b32 v49, 0
  v_mov_b32 v50, 0
  v_mov_b32 v51, 0
  v_mov_b32 v52, 0
  v_mov_b32 v53, 0
  v_mov_b32 v54, 0
  v_mov_b32 v55, 0
  v_mov_b32 v56, 0
  v_mov_b32 v57, 0
  v_mov_b32 v58, 0
  v_mov_b32 v59, 0
  v_mov_b32 v60, 0
  v_mov_b32 v61, 0
  v_mov_b32 v62, 0
  v_mov_b32 v63, 0
  s_mov_b32 s30, 61440
  s_barrier
  ds_read_b128 a[192:195], v2 offset:0
  ds_read_b128 a[196:199], v3 offset:0
  ds_read_b128 a[200:203], v4 offset:0
  ds_read_b128 a[204:207], v5 offset:0
  s_waitcnt lgkmcnt(3)
  v_mfma_f32_32x32x16_bf16 v[64:79], a[192:195], v[160:163], v[32:47]
  v_mfma_f32_32x32x16_bf16 v[80:95], a[192:195], v[168:171], v[48:63]
  ds_read_b128 a[192:195], v2 offset:128
  s_waitcnt lgkmcnt(3)
  v_mfma_f32_32x32x16_bf16 v[64:79], a[196:199], v[164:167], v[64:79]
  v_mfma_f32_32x32x16_bf16 v[80:95], a[196:199], v[172:175], v[80:95]
  ds_read_b128 a[196:199], v3 offset:128
  s_waitcnt lgkmcnt(3)
  v_mfma_f32_32x32x16_bf16 v[64:79], a[200:203], v[176:179], v[64:79]
  v_mfma_f32_32x32x16_bf16 v[80:95], a[200:203], v[184:187], v[80:95]
  ds_read_b128 a[200:203], v4 offset:128
  s_waitcnt lgkmcnt(3)
  v_mfma_f32_32x32x16_bf16 v[64:79], a[204:207], v[180:183], v[64:79]
  v_mfma_f32_32x32x16_bf16 v[80:95], a[204:207], v[188:191], v[80:95]
  ds_read_b128 a[204:207], v5 offset:128
  s_waitcnt lgkmcnt(3)
  v_mfma_f32_32x32x16_bf16 v[64:79], a[192:195], v[192:195], v[64:79]
  v_mfma_f32_32x32x16_bf16 v[80:95], a[192:195], v[200:203], v[80:95]
  ds_read_b128 a[192:195], v2 offset:256
  s_waitcnt lgkmcnt(3)
  v_mfma_f32_32x32x16_bf16 v[64:79], a[196:199], v[196:199], v[64:79]
  v_mfma_f32_32x32x16_bf16 v[80:95], a[196:199], v[204:207], v[80:95]
  ds_read_b128 a[196:199], v3 offset:256
  s_waitcnt lgkmcnt(3)
  v_mfma_f32_32x32x16_bf16 v[64:79], a[200:203], v[208:211], v[64:79]
  v_mfma_f32_32x32x16_bf16 v[80:95], a[200:203], v[216:219], v[80:95]
  ds_read_b128 a[200:203], v4 offset:256
  s_waitcnt lgkmcnt(3)
  v_mfma_f32_32x32x16_bf16 v[64:79], a[204:207], v[212:215], v[64:79]
  v_mfma_f32_32x32x16_bf16 v[80:95], a[204:207], v[220:223], v[80:95]
  ds_read_b128 a[204:207], v5 offset:256
  s_waitcnt lgkmcnt(3)
  v_mfma_f32_32x32x16_bf16 v[64:79], a[192:195], v[224:227], v[64:79]
  v_mfma_f32_32x32x16_bf16 v[80:95], a[192:195], v[232:235], v[80:95]
  s_waitcnt lgkmcnt(2)
  v_mfma_f32_32x32x16_bf16 v[64:79], a[196:199], v[228:231], v[64:79]
  v_mfma_f32_32x32x16_bf16 v[80:95], a[196:199], v[236:239], v[80:95]
  s_waitcnt lgkmcnt(1)
  v_mfma_f32_32x32x16_bf16 v[64:79], a[200:203], v[240:243], v[64:79]
  v_mfma_f32_32x32x16_bf16 v[80:95], a[200:203], v[248:251], v[80:95]
  s_waitcnt lgkmcnt(0)
  v_mfma_f32_32x32x16_bf16 v[64:79], a[204:207], v[244:247], v[64:79]
  v_mfma_f32_32x32x16_bf16 v[80:95], a[204:207], v[252:255], v[80:95]
  s_nop 10
  v_max3_f32 v21, v64, v65, v66
  v_max3_f32 v21, v21, v67, v68
  v_max3_f32 v21, v21, v69, v70
  v_max3_f32 v21, v21, v71, v72
  v_max3_f32 v21, v21, v73, v74
  v_max3_f32 v21, v21, v75, v76
  v_max3_f32 v21, v21, v77, v78
  v_max_f32 v21, v21, v79
  v_mov_b32 v22, v21
  s_nop 1
  v_permlane32_swap_b32 v21, v22
  v_max_f32 v23, v21, v22
  v_sub_f32 v64, v64, v23
  v_sub_f32 v65, v65, v23
  v_sub_f32 v66, v66, v23
  v_sub_f32 v67, v67, v23
  v_sub_f32 v68, v68, v23
  v_sub_f32 v69, v69, v23
  v_sub_f32 v70, v70, v23
  v_sub_f32 v71, v71, v23
  v_sub_f32 v72, v72, v23
  v_sub_f32 v73, v73, v23
  v_sub_f32 v74, v74, v23
  v_sub_f32 v75, v75, v23
  v_sub_f32 v76, v76, v23
  v_sub_f32 v77, v77, v23
  v_sub_f32 v78, v78, v23
  v_sub_f32 v79, v79, v23
  v_sub_f32 v32, 0, v23
  v_sub_f32 v33, 0, v23
  v_sub_f32 v34, 0, v23
  v_sub_f32 v35, 0, v23
  v_sub_f32 v36, 0, v23
  v_sub_f32 v37, 0, v23
  v_sub_f32 v38, 0, v23
  v_sub_f32 v39, 0, v23
  v_sub_f32 v40, 0, v23
  v_sub_f32 v41, 0, v23
  v_sub_f32 v42, 0, v23
  v_sub_f32 v43, 0, v23
  v_sub_f32 v44, 0, v23
  v_sub_f32 v45, 0, v23
  v_sub_f32 v46, 0, v23
  v_sub_f32 v47, 0, v23
  v_mov_b32 v16, 0
  v_max3_f32 v21, v80, v81, v82
  v_max3_f32 v21, v21, v83, v84
  v_max3_f32 v21, v21, v85, v86
  v_max3_f32 v21, v21, v87, v88
  v_max3_f32 v21, v21, v89, v90
  v_max3_f32 v21, v21, v91, v92
  v_max3_f32 v21, v21, v93, v94
  v_max_f32 v21, v21, v95
  v_mov_b32 v22, v21
  s_nop 1
  v_permlane32_swap_b32 v21, v22
  v_max_f32 v23, v21, v22
  v_sub_f32 v80, v80, v23
  v_sub_f32 v81, v81, v23
  v_sub_f32 v82, v82, v23
  v_sub_f32 v83, v83, v23
  v_sub_f32 v84, v84, v23
  v_sub_f32 v85, v85, v23
  v_sub_f32 v86, v86, v23
  v_sub_f32 v87, v87, v23
  v_sub_f32 v88, v88, v23
  v_sub_f32 v89, v89, v23
  v_sub_f32 v90, v90, v23
  v_sub_f32 v91, v91, v23
  v_sub_f32 v92, v92, v23
  v_sub_f32 v93, v93, v23
  v_sub_f32 v94, v94, v23
  v_sub_f32 v95, v95, v23
  v_sub_f32 v48, 0, v23
  v_sub_f32 v49, 0, v23
  v_sub_f32 v50, 0, v23
  v_sub_f32 v51, 0, v23
  v_sub_f32 v52, 0, v23
  v_sub_f32 v53, 0, v23
  v_sub_f32 v54, 0, v23
  v_sub_f32 v55, 0, v23
  v_sub_f32 v56, 0, v23
  v_sub_f32 v57, 0, v23
  v_sub_f32 v58, 0, v23
  v_sub_f32 v59, 0, v23
  v_sub_f32 v60, 0, v23
  v_sub_f32 v61, 0, v23
  v_sub_f32 v62, 0, v23
  v_sub_f32 v63, 0, v23
  v_mov_b32 v17, 0
  v_exp_f32 v64, v64
  v_exp_f32 v65, v65
  v_exp_f32 v66, v66
  v_add_f32 v16, v16, v64
  v_add_f32 v16, v16, v65
  v_cvt_pk_bf16_f32 v64, v64, v65
  v_exp_f32 v67, v67
  v_add_f32 v16, v16, v66
  v_exp_f32 v68, v68
  v_add_f32 v16, v16, v67
  v_cvt_pk_bf16_f32 v65, v66, v67
  v_exp_f32 v69, v69
  v_add_f32 v16, v16, v68
  v_exp_f32 v70, v70
  v_add_f32 v16, v16, v69
  v_cvt_pk_bf16_f32 v66, v68, v69
  v_exp_f32 v71, v71
  v_add_f32 v16, v16, v70
  v_add_f32 v16, v16, v71
  v_cvt_pk_bf16_f32 v67, v70, v71
  v_exp_f32 v80, v80
  v_exp_f32 v81, v81
  v_exp_f32 v82, v82
  v_add_f32 v17, v17, v80
  v_add_f32 v17, v17, v81
  v_cvt_pk_bf16_f32 v80, v80, v81
  v_exp_f32 v83, v83
  v_add_f32 v17, v17, v82
  v_exp_f32 v84, v84
  v_add_f32 v17, v17, v83
  v_cvt_pk_bf16_f32 v81, v82, v83
  v_exp_f32 v85, v85
  v_add_f32 v17, v17, v84
  v_exp_f32 v86, v86
  v_add_f32 v17, v17, v85
  v_cvt_pk_bf16_f32 v82, v84, v85
  v_exp_f32 v87, v87
  v_add_f32 v17, v17, v86
  v_add_f32 v17, v17, v87
  v_cvt_pk_bf16_f32 v83, v86, v87
  ds_read_b128 a[192:195], v2 offset:12288
  ds_read_b128 a[196:199], v3 offset:12288
  ds_read_b128 a[200:203], v4 offset:12288
  s_nop 15
  s_mov_b32 s31, 0
L_loop:
  s_waitcnt vmcnt(21)
  s_barrier
  s_waitcnt lgkmcnt(2)
  v_mfma_f32_32x32x16_bf16 v[96:111], a[192:195], v[160:163], v[32:47]
  ds_read_b128 a[204:207], v5 offset:12288
  s_add_u32 s45, s30, 12288
  s_add_u32 s46, s48, s45
  s_sub_u32 s44, s46, 393216
  s_cmp_ge_u32 s46, 393216
  s_cselect_b32 s46, s44, s46
  s_cmp_ge_u32 s45, 393216
  s_cselect_b32 s46, s45, s46
  v_exp_f32 v72, v72
  v_mfma_f32_32x32x16_bf16 v[112:127], a[192:195], v[168:171], v[48:63]
  s_add_u32 m0, s28, 0
  s_nop 0
  buffer_load_dwordx4 v10, s[12:15], s46 offen offset:0 nt lds
  v_exp_f32 v73, v73
  s_waitcnt lgkmcnt(2)
  v_mfma_f32_32x32x16_bf16 v[96:111], a[196:199], v[164:167], v[96:111]
  ds_read_b128 a[192:195], v2 offset:12416
  v_exp_f32 v74, v74
  v_add_f32 v16, v16, v72
  v_mfma_f32_32x32x16_bf16 v[112:127], a[196:199], v[172:175], v[112:127]
  buffer_load_dwordx4 v11, s[12:15], s46 offen offset:1024 nt lds
  v_add_f32 v16, v16, v73
  v_cvt_pk_bf16_f32 v72, v72, v73
  s_waitcnt lgkmcnt(2)
  v_mfma_f32_32x32x16_bf16 v[96:111], a[200:203], v[176:179], v[96:111]
  ds_read_b128 a[196:199], v3 offset:12416
  v_exp_f32 v75, v75
  v_add_f32 v16, v16, v74
  v_mfma_f32_32x32x16_bf16 v[112:127], a[200:203], v[184:187], v[112:127]
  buffer_load_dwordx4 v12, s[12:15], s46 offen offset:2048 nt lds
  v_exp_f32 v76, v76
  s_waitcnt lgkmcnt(2)
  v_mfma_f32_32x32x16_bf16 v[96:111], a[204:207], v[180:183], v[96:111]
  ds_read_b128 a[200:203], v4 offset:12416
  s_add_u32 s47, s48, s30
  s_sub_u32 s44, s47, 393216
  s_cmp_ge_u32 s47, 393216
  s_cselect_b32 s47, s44, s47
  s_cmp_ge_u32 s30, 393216
  s_cselect_b32 s47, s30, s47
  v_add_f32 v16, v16, v75
  v_cvt_pk_bf16_f32 v73, v74, v75
  v_mfma_f32_32x32x16_bf16 v[112:127], a[204:207], v[188:191], v[112:127]
  s_add_u32 m0, s28, 135168
  s_nop 0
  buffer_load_dwordx4 v13, s[16:19], s47 offen offset:0 nt lds
  v_exp_f32 v77, v77
  v_add_f32 v16, v16, v76
  s_waitcnt lgkmcnt(2)
  v_mfma_f32_32x32x16_bf16 v[96:111], a[192:195], v[192:195], v[96:111]
  ds_read_b128 a[204:207], v5 offset:12416
  v_exp_f32 v78, v78
  v_mfma_f32_32x32x16_bf16 v[112:127], a[192:195], v[200:203], v[112:127]
  buffer_load_dwordx4 v14, s[16:19], s47 offen offset:1024 nt lds
  v_add_f32 v16, v16, v77
  v_cvt_pk_bf16_f32 v74, v76, v77
  s_waitcnt lgkmcnt(2)
  v_mfma_f32_32x32x16_bf16 v[96:111], a[196:199], v[196:199], v[96:111]
  ds_read_b128 a[192:195], v2 offset:12544
  v_exp_f32 v79, v79
  v_add_f32 v16, v16, v78
  v_mfma_f32_32x32x16_bf16 v[112:127], a[196:199], v[204:207], v[112:127]
  buffer_load_dwordx4 v15, s[16:19], s47 offen offset:2048 nt lds
  s_add_u32 s30, s30, 12288
  v_add_f32 v16, v16, v79
  v_cvt_pk_bf16_f32 v75, v78, v79
  s_waitcnt lgkmcnt(2)
  v_mfma_f32_32x32x16_bf16 v[96:111], a[200:203], v[208:211], v[96:111]
  ds_read_b128 a[196:199], v3 offset:12544
  v_exp_f32 v88, v88
  v_mfma_f32_32x32x16_bf16 v[112:127], a[200:203], v[216:219], v[112:127]
  v_exp_f32 v89, v89
  s_waitcnt lgkmcnt(2)
  v_mfma_f32_32x32x16_bf16 v[96:111], a[204:207], v[212:215], v[96:111]
  ds_read_b128 a[200:203], v4 offset:12544
  v_exp_f32 v90, v90
  v_add_f32 v17, v17, v88
  v_mfma_f32_32x32x16_bf16 v[112:127], a[204:207], v[220:223], v[112:127]
  v_add_f32 v17, v17, v89
  v_cvt_pk_bf16_f32 v88, v88, v89
  s_waitcnt lgkmcnt(2)
  v_mfma_f32_32x32x16_bf16 v[96:111], a[192:195], v[224:227], v[96:111]
  ds_read_b128 a[204:207], v5 offset:12544
  v_exp_f32 v91, v91
  v_add_f32 v17, v17, v90
  v_mfma_f32_32x32x16_bf16 v[112:127], a[192:195], v[232:235], v[112:127]
  v_exp_f32 v92, v92
  s_waitcnt lgkmcnt(2)
  v_mfma_f32_32x32x16_bf16 v[96:111], a[196:199], v[228:231], v[96:111]
  ds_read_b64_tr_b16 a[208:209], v6 offset:0
  v_add_f32 v17, v17, v91
  v_cvt_pk_bf16_f32 v89, v90, v91
  v_mfma_f32_32x32x16_bf16 v[112:127], a[196:199], v[236:239], v[112:127]
  ds_read_b64_tr_b16 a[210:211], v6 offset:3072
  v_exp_f32 v93, v93
  v_add_f32 v17, v17, v92
  s_waitcnt lgkmcnt(3)
  v_mfma_f32_32x32x16_bf16 v[96:111], a[200:203], v[240:243], v[96:111]
  ds_read_b64_tr_b16 a[212:213], v7 offset:0
  v_exp_f32 v94, v94
  v_mfma_f32_32x32x16_bf16 v[112:127], a[200:203], v[248:251], v[112:127]
  ds_read_b64_tr_b16 a[214:215], v7 offset:3072
  v_add_f32 v17, v17, v93
  v_cvt_pk_bf16_f32 v90, v92, v93
  s_waitcnt lgkmcnt(4)
  v_mfma_f32_32x32x16_bf16 v[96:111], a[204:207], v[244:247], v[96:111]
  ds_read_b64_tr_b16 a[216:217], v6 offset:128
  v_exp_f32 v95, v95
  v_add_f32 v17, v17, v94
  v_mfma_f32_32x32x16_bf16 v[112:127], a[204:207], v[252:255], v[112:127]
  ds_read_b64_tr_b16 a[218:219], v6 offset:3200
  v_add_f32 v17, v17, v95
  v_cvt_pk_bf16_f32 v91, v94, v95
  s_waitcnt lgkmcnt(4)
  v_mfma_f32_32x32x16_bf16 a[0:15], a[208:211], v[64:67], a[0:15]
  ds_read_b64_tr_b16 a[220:221], v7 offset:128
  v_mfma_f32_32x32x16_bf16 a[16:31], a[208:211], v[80:83], a[16:31]
  ds_read_b64_tr_b16 a[222:223], v7 offset:3200
  s_waitcnt lgkmcnt(4)
  v_mfma_f32_32x32x16_bf16 a[32:47], a[212:215], v[64:67], a[32:47]
  ds_read_b64_tr_b16 a[208:209], v6 offset:256
  v_mfma_f32_32x32x16_bf16 a[48:63], a[212:215], v[80:83], a[48:63]
  ds_read_b64_tr_b16 a[210:211], v6 offset:3328
  v_max3_f32 v18, v96, v97, v98
  v_max3_f32 v18, v18, v99, v100
  v_max3_f32 v18, v18, v101, v102
  s_waitcnt lgkmcnt(4)
  v_mfma_f32_32x32x16_bf16 a[64:79], a[216:219], v[64:67], a[64:79]
  ds_read_b64_tr_b16 a[212:213], v7 offset:256
  v_max3_f32 v18, v18, v103, v104
  v_max3_f32 v18, v18, v105, v106
  v_max3_f32 v18, v18, v107, v108
  v_mfma_f32_32x32x16_bf16 a[80:95], a[216:219], v[80:83], a[80:95]
  ds_read_b64_tr_b16 a[214:215], v7 offset:3328
  v_max3_f32 v18, v18, v109, v110
  v_max3_f32 v18, v18, v111, v112
  v_max3_f32 v18, v18, v113, v114
  v_max3_f32 v18, v18, v115, v116
  s_waitcnt lgkmcnt(4)
  v_mfma_f32_32x32x16_bf16 a[96:111], a[220:223], v[64:67], a[96:111]
  ds_read_b64_tr_b16 a[216:217], v6 offset:6144
  v_max3_f32 v18, v18, v117, v118
  v_max3_f32 v18, v18, v119, v120
  v_max3_f32 v18, v18, v121, v122
  v_mfma_f32_32x32x16_bf16 a[112:127], a[220:223], v[80:83], a[112:127]
  ds_read_b64_tr_b16 a[218:219], v6 offset:9216
  v_max3_f32 v18, v18, v123, v124
  v_max3_f32 v18, v18, v125, v126
  v_max_f32 v18, v18, v127
  v_cmp_lt_f32 vcc, 0x41000000, v18
  s_cbranch_vccz L_ok1_l0
  s_call_b64 s[36:37], L_rare1_1
L_ok1_l0:
  s_waitcnt lgkmcnt(4)
  v_mfma_f32_32x32x16_bf16 a[128:143], a[208:211], v[64:67], a[128:143]
  ds_read_b64_tr_b16 a[220:221], v7 offset:6144
  v_exp_f32 v96, v96
  v_exp_f32 v97, v97
  v_mfma_f32_32x32x16_bf16 a[144:159], a[208:211], v[80:83], a[144:159]
  ds_read_b64_tr_b16 a[222:223], v7 offset:9216
  v_exp_f32 v98, v98
  v_add_f32 v16, v16, v96
  s_waitcnt lgkmcnt(4)
  v_mfma_f32_32x32x16_bf16 a[160:175], a[212:215], v[64:67], a[160:175]
  ds_read_b64_tr_b16 a[208:209], v6 offset:6272
  v_add_f32 v16, v16, v97
  v_cvt_pk_bf16_f32 v96, v96, v97
  v_exp_f32 v99, v99
  v_mfma_f32_32x32x16_bf16 a[176:191], a[212:215], v[80:83], a[176:191]
  ds_read_b64_tr_b16 a[210:211], v6 offset:9344
  v_add_f32 v16, v16, v98
  v_exp_f32 v100, v100
  s_waitcnt lgkmcnt(4)
  v_mfma_f32_32x32x16_bf16 a[0:15], a[216:219], v[72:75], a[0:15]
  ds_read_b64_tr_b16 a[212:213], v7 offset:6272
  v_add_f32 v16, v16, v99
  v_cvt_pk_bf16_f32 v97, v98, v99
  v_exp_f32 v101, v101
  v_mfma_f32_32x32x16_bf16 a[16:31], a[216:219], v[88:91], a[16:31]
  ds_read_b64_tr_b16 a[214:215], v7 offset:9344
  v_add_f32 v16, v16, v100
  v_exp_f32 v102, v102
  s_waitcnt lgkmcnt(4)
  v_mfma_f32_32x32x16_bf16 a[32:47], a[220:223], v[72:75], a[32:47]
  ds_read_b64_tr_b16 a[216:217], v6 offset:6400
  v_add_f32 v16, v16, v101
  v_cvt_pk_bf16_f32 v98, v100, v101
  v_exp_f32 v103, v103
  v_mfma_f32_32x32x16_bf16 a[48:63], a[220:223], v[88:91], a[48:63]
  ds_read_b64_tr_b16 a[218:219], v6 offset:9472
  v_add_f32 v16, v16, v102
  v_add_f32 v16, v16, v103
  v_cvt_pk_bf16_f32 v99, v102, v103
  s_waitcnt lgkmcnt(4)
  v_mfma_f32_32x32x16_bf16 a[64:79], a[208:211], v[72:75], a[64:79]
  ds_read_b64_tr_b16 a[220:221], v7 offset:6400
  v_exp_f32 v112, v112
  v_exp_f32 v113, v113
  v_mfma_f32_32x32x16_bf16 a[80:95], a[208:211], v[88:91], a[80:95]
  ds_read_b64_tr_b16 a[222:223], v7 offset:9472
  v_exp_f32 v114, v114
  v_add_f32 v17, v17, v112
  s_waitcnt lgkmcnt(4)
  v_mfma_f32_32x32x16_bf16 a[96:111], a[212:215], v[72:75], a[96:111]
  ds_read_b128 a[192:195], v2 offset:24576
  v_add_f32 v17, v17, v113
  v_cvt_pk_bf16_f32 v112, v112, v113
  v_exp_f32 v115, v115
  v_mfma_f32_32x32x16_bf16 a[112:127], a[212:215], v[88:91], a[112:127]
  v_add_f32 v17, v17, v114
  v_exp_f32 v116, v116
  s_waitcnt lgkmcnt(3)
  v_mfma_f32_32x32x16_bf16 a[128:143], a[216:219], v[72:75], a[128:143]
  ds_read_b128 a[196:199], v3 offset:24576
  v_add_f32 v17, v17, v115
  v_cvt_pk_bf16_f32 v113, v114, v115
  v_exp_f32 v117, v117
  v_mfma_f32_32x32x16_bf16 a[144:159], a[216:219], v[88:91], a[144:159]
  v_add_f32 v17, v17, v116
  v_exp_f32 v118, v118
  s_waitcnt lgkmcnt(2)
  v_mfma_f32_32x32x16_bf16 a[160:175], a[220:223], v[72:75], a[160:175]
  ds_read_b128 a[200:203], v4 offset:24576
  v_add_f32 v17, v17, v117
  v_cvt_pk_bf16_f32 v114, v116, v117
  v_exp_f32 v119, v119
  v_mfma_f32_32x32x16_bf16 a[176:191], a[220:223], v[88:91], a[176:191]
  v_add_f32 v17, v17, v118
  v_add_f32 v17, v17, v119
  v_cvt_pk_bf16_f32 v115, v118, v119
  s_cmp_eq_u32 s32, 0
  s_cbranch_scc1 L_ok2_l0
  s_call_b64 s[36:37], L_rare2
L_ok2_l0:
  s_waitcnt vmcnt(21)
  s_barrier
  s_waitcnt lgkmcnt(2)
  v_mfma_f32_32x32x16_bf16 v[64:79], a[192:195], v[160:163], v[32:47]
  ds_read_b128 a[204:207], v5 offset:24576
  s_add_u32 s45, s30, 12288
  s_add_u32 s46, s48, s45
  s_sub_u32 s44, s46, 393216
  s_cmp_ge_u32 s46, 393216
  s_cselect_b32 s46, s44, s46
  s_cmp_ge_u32 s45, 393216
  s_cselect_b32 s46, s45, s46
  v_exp_f32 v104, v104
  v_mfma_f32_32x32x16_bf16 v[80:95], a[192:195], v[168:171], v[48:63]
  s_add_u32 m0, s28, 12288
  s_nop 0
  buffer_load_dwordx4 v10, s[12:15], s46 offen offset:0 nt lds
  v_exp_f32 v105, v105
  s_waitcnt lgkmcnt(2)
  v_mfma_f32_32x32x16_bf16 v[64:79], a[196:199], v[164:167], v[64:79]
  ds_read_b128 a[192:195], v2 offset:24704
  v_exp_f32 v106, v106
  v_add_f32 v16, v16, v104
  v_mfma_f32_32x32x16_bf16 v[80:95], a[196:199], v[172:175], v[80:95]
  buffer_load_dwordx4 v11, s[12:15], s46 offen offset:1024 nt lds
  v_add_f32 v16, v16, v105
  v_cvt_pk_bf16_f32 v104, v104, v105
  s_waitcnt lgkmcnt(2)
  v_mfma_f32_32x32x16_bf16 v[64:79], a[200:203], v[176:179], v[64:79]
  ds_read_b128 a[196:199], v3 offset:24704
  v_exp_f32 v107, v107
  v_add_f32 v16, v16, v106
  v_mfma_f32_32x32x16_bf16 v[80:95], a[200:203], v[184:187], v[80:95]
  buffer_load_dwordx4 v12, s[12:15], s46 offen offset:2048 nt lds
  v_exp_f32 v108, v108
  s_waitcnt lgkmcnt(2)
  v_mfma_f32_32x32x16_bf16 v[64:79], a[204:207], v[180:183], v[64:79]
  ds_read_b128 a[200:203], v4 offset:24704
  s_add_u32 s47, s48, s30
  s_sub_u32 s44, s47, 393216
  s_cmp_ge_u32 s47, 393216
  s_cselect_b32 s47, s44, s47
  s_cmp_ge_u32 s30, 393216
  s_cselect_b32 s47, s30, s47
  v_add_f32 v16, v16, v107
  v_cvt_pk_bf16_f32 v105, v106, v107
  v_mfma_f32_32x32x16_bf16 v[80:95], a[204:207], v[188:191], v[80:95]
  s_add_u32 m0, s28, 73728
  s_nop 0
  buffer_load_dwordx4 v13, s[16:19], s47 offen offset:0 nt lds
  v_exp_f32 v109, v109
  v_add_f32 v16, v16, v108
  s_waitcnt lgkmcnt(2)
  v_mfma_f32_32x32x16_bf16 v[64:79], a[192:195], v[192:195], v[64:79]
  ds_read_b128 a[204:207], v5 offset:24704
  v_exp_f32 v110, v110
  v_mfma_f32_32x32x16_bf16 v[80:95], a[192:195], v[200:203], v[80:95]
  buffer_load_dwordx4 v14, s[16:19], s47 offen offset:1024 nt lds
  v_add_f32 v16, v16, v109
  v_cvt_pk_bf16_f32 v106, v108, v109
  s_waitcnt lgkmcnt(2)
  v_mfma_f32_32x32x16_bf16 v[64:79], a[196:199], v[196:199], v[64:79]
  ds_read_b128 a[192:195], v2 offset:24832
  v_exp_f32 v111, v111
  v_add_f32 v16, v16, v110
  v_mfma_f32_32x32x16_bf16 v[80:95], a[196:199], v[204:207], v[80:95]
  buffer_load_dwordx4 v15, s[16:19], s47 offen offset:2048 nt lds
  s_add_u32 s30, s30, 12288
  v_add_f32 v16, v16, v111
  v_cvt_pk_bf16_f32 v107, v110, v111
  s_waitcnt lgkmcnt(2)
  v_mfma_f32_32x32x16_bf16 v[64:79], a[200:203], v[208:211], v[64:79]
  ds_read_b128 a[196:199], v3 offset:24832
  v_exp_f32 v120, v120
  v_mfma_f32_32x32x16_bf16 v[80:95], a[200:203], v[216:219], v[80:95]
  v_exp_f32 v121, v121
  s_waitcnt lgkmcnt(2)
  v_mfma_f32_32x32x16_bf16 v[64:79], a[204:207], v[212:215], v[64:79]
  ds_read_b128 a[200:203], v4 offset:24832
  v_exp_f32 v122, v122
  v_add_f32 v17, v17, v120
  v_mfma_f32_32x32x16_bf16 v[80:95], a[204:207], v[220:223], v[80:95]
  v_add_f32 v17, v17, v121
  v_cvt_pk_bf16_f32 v120, v120, v121
  s_waitcnt lgkmcnt(2)
  v_mfma_f32_32x32x16_bf16 v[64:79], a[192:195], v[224:227], v[64:79]
  ds_read_b128 a[204:207], v5 offset:24832
  v_exp_f32 v123, v123
  v_add_f32 v17, v17, v122
  v_mfma_f32_32x32x16_bf16 v[80:95], a[192:195], v[232:235], v[80:95]
  v_exp_f32 v124, v124
  s_waitcnt lgkmcnt(2)
  v_mfma_f32_32x32x16_bf16 v[64:79], a[196:199], v[228:231], v[64:79]
  ds_read_b64_tr_b16 a[208:209], v6 offset:12288
  v_add_f32 v17, v17, v123
  v_cvt_pk_bf16_f32 v121, v122, v123
  v_mfma_f32_32x32x16_bf16 v[80:95], a[196:199], v[236:239], v[80:95]
  ds_read_b64_tr_b16 a[210:211], v6 offset:15360
  v_exp_f32 v125, v125
  v_add_f32 v17, v17, v124
  s_waitcnt lgkmcnt(3)
  v_mfma_f32_32x32x16_bf16 v[64:79], a[200:203], v[240:243], v[64:79]
  ds_read_b64_tr_b16 a[212:213], v7 offset:12288
  v_exp_f32 v126, v126
  v_mfma_f32_32x32x16_bf16 v[80:95], a[200:203], v[248:251], v[80:95]
  ds_read_b64_tr_b16 a[214:215], v7 offset:15360
  v_add_f32 v17, v17, v125
  v_cvt_pk_bf16_f32 v122, v124, v125
  s_waitcnt lgkmcnt(4)
  v_mfma_f32_32x32x16_bf16 v[64:79], a[204:207], v[244:247], v[64:79]
  ds_read_b64_tr_b16 a[216:217], v6 offset:12416
  v_exp_f32 v127, v127
  v_add_f32 v17, v17, v126
  v_mfma_f32_32x32x16_bf16 v[80:95], a[204:207], v[252:255], v[80:95]
  ds_read_b64_tr_b16 a[218:219], v6 offset:15488
  v_add_f32 v17, v17, v127
  v_cvt_pk_bf16_f32 v123, v126, v127
  s_waitcnt lgkmcnt(4)
  v_mfma_f32_32x32x16_bf16 a[0:15], a[208:211], v[96:99], a[0:15]
  ds_read_b64_tr_b16 a[220:221], v7 offset:12416
  v_mfma_f32_32x32x16_bf16 a[16:31], a[208:211], v[112:115], a[16:31]
  ds_read_b64_tr_b16 a[222:223], v7 offset:15488
  s_waitcnt lgkmcnt(4)
  v_mfma_f32_32x32x16_bf16 a[32:47], a[212:215], v[96:99], a[32:47]
  ds_read_b64_tr_b16 a[208:209], v6 offset:12544
  v_mfma_f32_32x32x16_bf16 a[48:63], a[212:215], v[112:115], a[48:63]
  ds_read_b64_tr_b16 a[210:211], v6 offset:15616
  v_max3_f32 v18, v64, v65, v66
  v_max3_f32 v18, v18, v67, v68
  v_max3_f32 v18, v18, v69, v70
  s_waitcnt lgkmcnt(4)
  v_mfma_f32_32x32x16_bf16 a[64:79], a[216:219], v[96:99], a[64:79]
  ds_read_b64_tr_b16 a[212:213], v7 offset:12544
  v_max3_f32 v18, v18, v71, v72
  v_max3_f32 v18, v18, v73, v74
  v_max3_f32 v18, v18, v75, v76
  v_mfma_f32_32x32x16_bf16 a[80:95], a[216:219], v[112:115], a[80:95]
  ds_read_b64_tr_b16 a[214:215], v7 offset:15616
  v_max3_f32 v18, v18, v77, v78
  v_max3_f32 v18, v18, v79, v80
  v_max3_f32 v18, v18, v81, v82
  v_max3_f32 v18, v18, v83, v84
  s_waitcnt lgkmcnt(4)
  v_mfma_f32_32x32x16_bf16 a[96:111], a[220:223], v[96:99], a[96:111]
  ds_read_b64_tr_b16 a[216:217], v6 offset:18432
  v_max3_f32 v18, v18, v85, v86
  v_max3_f32 v18, v18, v87, v88
  v_max3_f32 v18, v18, v89, v90
  v_mfma_f32_32x32x16_bf16 a[112:127], a[220:223], v[112:115], a[112:127]
  ds_read_b64_tr_b16 a[218:219], v6 offset:21504
  v_max3_f32 v18, v18, v91, v92
  v_max3_f32 v18, v18, v93, v94
  v_max_f32 v18, v18, v95
  v_cmp_lt_f32 vcc, 0x41000000, v18
  s_cbranch_vccz L_ok1_l1
  s_call_b64 s[36:37], L_rare1_0
L_ok1_l1:
  s_waitcnt lgkmcnt(4)
  v_mfma_f32_32x32x16_bf16 a[128:143], a[208:211], v[96:99], a[128:143]
  ds_read_b64_tr_b16 a[220:221], v7 offset:18432
  v_exp_f32 v64, v64
  v_exp_f32 v65, v65
  v_mfma_f32_32x32x16_bf16 a[144:159], a[208:211], v[112:115], a[144:159]
  ds_read_b64_tr_b16 a[222:223], v7 offset:21504
  v_exp_f32 v66, v66
  v_add_f32 v16, v16, v64
  s_waitcnt lgkmcnt(4)
  v_mfma_f32_32x32x16_bf16 a[160:175], a[212:215], v[96:99], a[160:175]
  ds_read_b64_tr_b16 a[208:209], v6 offset:18560
  v_add_f32 v16, v16, v65
  v_cvt_pk_bf16_f32 v64, v64, v65
  v_exp_f32 v67, v67
  v_mfma_f32_32x32x16_bf16 a[176:191], a[212:215], v[112:115], a[176:191]
  ds_read_b64_tr_b16 a[210:211], v6 offset:21632
  v_add_f32 v16, v16, v66
  v_exp_f32 v68, v68
  s_waitcnt lgkmcnt(4)
  v_mfma_f32_32x32x16_bf16 a[0:15], a[216:219], v[104:107], a[0:15]
  ds_read_b64_tr_b16 a[212:213], v7 offset:18560
  v_add_f32 v16, v16, v67
  v_cvt_pk_bf16_f32 v65, v66, v67
  v_exp_f32 v69, v69
  v_mfma_f32_32x32x16_bf16 a[16:31], a[216:219], v[120:123], a[16:31]
  ds_read_b64_tr_b16 a[214:215], v7 offset:21632
  v_add_f32 v16, v16, v68
  v_exp_f32 v70, v70
  s_waitcnt lgkmcnt(4)
  v_mfma_f32_32x32x16_bf16 a[32:47], a[220:223], v[104:107], a[32:47]
  ds_read_b64_tr_b16 a[216:217], v6 offset:18688
  v_add_f32 v16, v16, v69
  v_cvt_pk_bf16_f32 v66, v68, v69
  v_exp_f32 v71, v71
  v_mfma_f32_32x32x16_bf16 a[48:63], a[220:223], v[120:123], a[48:63]
  ds_read_b64_tr_b16 a[218:219], v6 offset:21760
  v_add_f32 v16, v16, v70
  v_add_f32 v16, v16, v71
  v_cvt_pk_bf16_f32 v67, v70, v71
  s_waitcnt lgkmcnt(4)
  v_mfma_f32_32x32x16_bf16 a[64:79], a[208:211], v[104:107], a[64:79]
  ds_read_b64_tr_b16 a[220:221], v7 offset:18688
  v_exp_f32 v80, v80
  v_exp_f32 v81, v81
  v_mfma_f32_32x32x16_bf16 a[80:95], a[208:211], v[120:123], a[80:95]
  ds_read_b64_tr_b16 a[222:223], v7 offset:21760
  v_exp_f32 v82, v82
  v_add_f32 v17, v17, v80
  s_waitcnt lgkmcnt(4)
  v_mfma_f32_32x32x16_bf16 a[96:111], a[212:215], v[104:107], a[96:111]
  ds_read_b128 a[192:195], v2 offset:36864
  v_add_f32 v17, v17, v81
  v_cvt_pk_bf16_f32 v80, v80, v81
  v_exp_f32 v83, v83
  v_mfma_f32_32x32x16_bf16 a[112:127], a[212:215], v[120:123], a[112:127]
  v_add_f32 v17, v17, v82
  v_exp_f32 v84, v84
  s_waitcnt lgkmcnt(3)
  v_mfma_f32_32x32x16_bf16 a[128:143], a[216:219], v[104:107], a[128:143]
  ds_read_b128 a[196:199], v3 offset:36864
  v_add_f32 v17, v17, v83
  v_cvt_pk_bf16_f32 v81, v82, v83
  v_exp_f32 v85, v85
  v_mfma_f32_32x32x16_bf16 a[144:159], a[216:219], v[120:123], a[144:159]
  v_add_f32 v17, v17, v84
  v_exp_f32 v86, v86
  s_waitcnt lgkmcnt(2)
  v_mfma_f32_32x32x16_bf16 a[160:175], a[220:223], v[104:107], a[160:175]
  ds_read_b128 a[200:203], v4 offset:36864
  v_add_f32 v17, v17, v85
  v_cvt_pk_bf16_f32 v82, v84, v85
  v_exp_f32 v87, v87
  v_mfma_f32_32x32x16_bf16 a[176:191], a[220:223], v[120:123], a[176:191]
  v_add_f32 v17, v17, v86
  v_add_f32 v17, v17, v87
  v_cvt_pk_bf16_f32 v83, v86, v87
  s_cmp_eq_u32 s32, 0
  s_cbranch_scc1 L_ok2_l1
  s_call_b64 s[36:37], L_rare2
L_ok2_l1:
  s_waitcnt vmcnt(21)
  s_barrier
  s_waitcnt lgkmcnt(2)
  v_mfma_f32_32x32x16_bf16 v[96:111], a[192:195], v[160:163], v[32:47]
  ds_read_b128 a[204:207], v5 offset:36864
  s_add_u32 s45, s30, 12288
  s_add_u32 s46, s48, s45
  s_sub_u32 s44, s46, 393216
  s_cmp_ge_u32 s46, 393216
  s_cselect_b32 s46, s44, s46
  s_cmp_ge_u32 s45, 393216
  s_cselect_b32 s46, s45, s46
  v_exp_f32 v72, v72
  v_mfma_f32_32x32x16_bf16 v[112:127], a[192:195], v[168:171], v[48:63]
  s_add_u32 m0, s28, 24576
  s_nop 0
  buffer_load_dwordx4 v10, s[12:15], s46 offen offset:0 nt lds
  v_exp_f32 v73, v73
  s_waitcnt lgkmcnt(2)
  v_mfma_f32_32x32x16_bf16 v[96:111], a[196:199], v[164:167], v[96:111]
  ds_read_b128 a[192:195], v2 offset:36992
  v_exp_f32 v74, v74
  v_add_f32 v16, v16, v72
  v_mfma_f32_32x32x16_bf16 v[112:127], a[196:199], v[172:175], v[112:127]
  buffer_load_dwordx4 v11, s[12:15], s46 offen offset:1024 nt lds
  v_add_f32 v16, v16, v73
  v_cvt_pk_bf16_f32 v72, v72, v73
  s_waitcnt lgkmcnt(2)
  v_mfma_f32_32x32x16_bf16 v[96:111], a[200:203], v[176:179], v[96:111]
  ds_read_b128 a[196:199], v3 offset:36992
  v_exp_f32 v75, v75
  v_add_f32 v16, v16, v74
  v_mfma_f32_32x32x16_bf16 v[112:127], a[200:203], v[184:187], v[112:127]
  buffer_load_dwordx4 v12, s[12:15], s46 offen offset:2048 nt lds
  v_exp_f32 v76, v76
  s_waitcnt lgkmcnt(2)
  v_mfma_f32_32x32x16_bf16 v[96:111], a[204:207], v[180:183], v[96:111]
  ds_read_b128 a[200:203], v4 offset:36992
  s_add_u32 s47, s48, s30
  s_sub_u32 s44, s47, 393216
  s_cmp_ge_u32 s47, 393216
  s_cselect_b32 s47, s44, s47
  s_cmp_ge_u32 s30, 393216
  s_cselect_b32 s47, s30, s47
  v_add_f32 v16, v16, v75
  v_cvt_pk_bf16_f32 v73, v74, v75
  v_mfma_f32_32x32x16_bf16 v[112:127], a[204:207], v[188:191], v[112:127]
  s_add_u32 m0, s28, 86016
  s_nop 0
  buffer_load_dwordx4 v13, s[16:19], s47 offen offset:0 nt lds
  v_exp_f32 v77, v77
  v_add_f32 v16, v16, v76
  s_waitcnt lgkmcnt(2)
  v_mfma_f32_32x32x16_bf16 v[96:111], a[192:195], v[192:195], v[96:111]
  ds_read_b128 a[204:207], v5 offset:36992
  v_exp_f32 v78, v78
  v_mfma_f32_32x32x16_bf16 v[112:127], a[192:195], v[200:203], v[112:127]
  buffer_load_dwordx4 v14, s[16:19], s47 offen offset:1024 nt lds
  v_add_f32 v16, v16, v77
  v_cvt_pk_bf16_f32 v74, v76, v77
  s_waitcnt lgkmcnt(2)
  v_mfma_f32_32x32x16_bf16 v[96:111], a[196:199], v[196:199], v[96:111]
  ds_read_b128 a[192:195], v2 offset:37120
  v_exp_f32 v79, v79
  v_add_f32 v16, v16, v78
  v_mfma_f32_32x32x16_bf16 v[112:127], a[196:199], v[204:207], v[112:127]
  buffer_load_dwordx4 v15, s[16:19], s47 offen offset:2048 nt lds
  s_add_u32 s30, s30, 12288
  v_add_f32 v16, v16, v79
  v_cvt_pk_bf16_f32 v75, v78, v79
  s_waitcnt lgkmcnt(2)
  v_mfma_f32_32x32x16_bf16 v[96:111], a[200:203], v[208:211], v[96:111]
  ds_read_b128 a[196:199], v3 offset:37120
  v_exp_f32 v88, v88
  v_mfma_f32_32x32x16_bf16 v[112:127], a[200:203], v[216:219], v[112:127]
  v_exp_f32 v89, v89
  s_waitcnt lgkmcnt(2)
  v_mfma_f32_32x32x16_bf16 v[96:111], a[204:207], v[212:215], v[96:111]
  ds_read_b128 a[200:203], v4 offset:37120
  v_exp_f32 v90, v90
  v_add_f32 v17, v17, v88
  v_mfma_f32_32x32x16_bf16 v[112:127], a[204:207], v[220:223], v[112:127]
  v_add_f32 v17, v17, v89
  v_cvt_pk_bf16_f32 v88, v88, v89
  s_waitcnt lgkmcnt(2)
  v_mfma_f32_32x32x16_bf16 v[96:111], a[192:195], v[224:227], v[96:111]
  ds_read_b128 a[204:207], v5 offset:37120
  v_exp_f32 v91, v91
  v_add_f32 v17, v17, v90
  v_mfma_f32_32x32x16_bf16 v[112:127], a[192:195], v[232:235], v[112:127]
  v_exp_f32 v92, v92
  s_waitcnt lgkmcnt(2)
  v_mfma_f32_32x32x16_bf16 v[96:111], a[196:199], v[228:231], v[96:111]
  ds_read_b64_tr_b16 a[208:209], v6 offset:24576
  v_add_f32 v17, v17, v91
  v_cvt_pk_bf16_f32 v89, v90, v91
  v_mfma_f32_32x32x16_bf16 v[112:127], a[196:199], v[236:239], v[112:127]
  ds_read_b64_tr_b16 a[210:211], v6 offset:27648
  v_exp_f32 v93, v93
  v_add_f32 v17, v17, v92
  s_waitcnt lgkmcnt(3)
  v_mfma_f32_32x32x16_bf16 v[96:111], a[200:203], v[240:243], v[96:111]
  ds_read_b64_tr_b16 a[212:213], v7 offset:24576
  v_exp_f32 v94, v94
  v_mfma_f32_32x32x16_bf16 v[112:127], a[200:203], v[248:251], v[112:127]
  ds_read_b64_tr_b16 a[214:215], v7 offset:27648
  v_add_f32 v17, v17, v93
  v_cvt_pk_bf16_f32 v90, v92, v93
  s_waitcnt lgkmcnt(4)
  v_mfma_f32_32x32x16_bf16 v[96:111], a[204:207], v[244:247], v[96:111]
  ds_read_b64_tr_b16 a[216:217], v6 offset:24704
  v_exp_f32 v95, v95
  v_add_f32 v17, v17, v94
  v_mfma_f32_32x32x16_bf16 v[112:127], a[204:207], v[252:255], v[112:127]
  ds_read_b64_tr_b16 a[218:219], v6 offset:27776
  v_add_f32 v17, v17, v95
  v_cvt_pk_bf16_f32 v91, v94, v95
  s_waitcnt lgkmcnt(4)
  v_mfma_f32_32x32x16_bf16 a[0:15], a[208:211], v[64:67], a[0:15]
  ds_read_b64_tr_b16 a[220:221], v7 offset:24704
  v_mfma_f32_32x32x16_bf16 a[16:31], a[208:211], v[80:83], a[16:31]
  ds_read_b64_tr_b16 a[222:223], v7 offset:27776
  s_waitcnt lgkmcnt(4)
  v_mfma_f32_32x32x16_bf16 a[32:47], a[212:215], v[64:67], a[32:47]
  ds_read_b64_tr_b16 a[208:209], v6 offset:24832
  v_mfma_f32_32x32x16_bf16 a[48:63], a[212:215], v[80:83], a[48:63]
  ds_read_b64_tr_b16 a[210:211], v6 offset:27904
  v_max3_f32 v18, v96, v97, v98
  v_max3_f32 v18, v18, v99, v100
  v_max3_f32 v18, v18, v101, v102
  s_waitcnt lgkmcnt(4)
  v_mfma_f32_32x32x16_bf16 a[64:79], a[216:219], v[64:67], a[64:79]
  ds_read_b64_tr_b16 a[212:213], v7 offset:24832
  v_max3_f32 v18, v18, v103, v104
  v_max3_f32 v18, v18, v105, v106
  v_max3_f32 v18, v18, v107, v108
  v_mfma_f32_32x32x16_bf16 a[80:95], a[216:219], v[80:83], a[80:95]
  ds_read_b64_tr_b16 a[214:215], v7 offset:27904
  v_max3_f32 v18, v18, v109, v110
  v_max3_f32 v18, v18, v111, v112
  v_max3_f32 v18, v18, v113, v114
  v_max3_f32 v18, v18, v115, v116
  s_waitcnt lgkmcnt(4)
  v_mfma_f32_32x32x16_bf16 a[96:111], a[220:223], v[64:67], a[96:111]
  ds_read_b64_tr_b16 a[216:217], v6 offset:30720
  v_max3_f32 v18, v18, v117, v118
  v_max3_f32 v18, v18, v119, v120
  v_max3_f32 v18, v18, v121, v122
  v_mfma_f32_32x32x16_bf16 a[112:127], a[220:223], v[80:83], a[112:127]
  ds_read_b64_tr_b16 a[218:219], v6 offset:33792
  v_max3_f32 v18, v18, v123, v124
  v_max3_f32 v18, v18, v125, v126
  v_max_f32 v18, v18, v127
  v_cmp_lt_f32 vcc, 0x41000000, v18
  s_cbranch_vccz L_ok1_l2
  s_call_b64 s[36:37], L_rare1_1
L_ok1_l2:
  s_waitcnt lgkmcnt(4)
  v_mfma_f32_32x32x16_bf16 a[128:143], a[208:211], v[64:67], a[128:143]
  ds_read_b64_tr_b16 a[220:221], v7 offset:30720
  v_exp_f32 v96, v96
  v_exp_f32 v97, v97
  v_mfma_f32_32x32x16_bf16 a[144:159], a[208:211], v[80:83], a[144:159]
  ds_read_b64_tr_b16 a[222:223], v7 offset:33792
  v_exp_f32 v98, v98
  v_add_f32 v16, v16, v96
  s_waitcnt lgkmcnt(4)
  v_mfma_f32_32x32x16_bf16 a[160:175], a[212:215], v[64:67], a[160:175]
  ds_read_b64_tr_b16 a[208:209], v6 offset:30848
  v_add_f32 v16, v16, v97
  v_cvt_pk_bf16_f32 v96, v96, v97
  v_exp_f32 v99, v99
  v_mfma_f32_32x32x16_bf16 a[176:191], a[212:215], v[80:83], a[176:191]
  ds_read_b64_tr_b16 a[210:211], v6 offset:33920
  v_add_f32 v16, v16, v98
  v_exp_f32 v100, v100
  s_waitcnt lgkmcnt(4)
  v_mfma_f32_32x32x16_bf16 a[0:15], a[216:219], v[72:75], a[0:15]
  ds_read_b64_tr_b16 a[212:213], v7 offset:30848
  v_add_f32 v16, v16, v99
  v_cvt_pk_bf16_f32 v97, v98, v99
  v_exp_f32 v101, v101
  v_mfma_f32_32x32x16_bf16 a[16:31], a[216:219], v[88:91], a[16:31]
  ds_read_b64_tr_b16 a[214:215], v7 offset:33920
  v_add_f32 v16, v16, v100
  v_exp_f32 v102, v102
  s_waitcnt lgkmcnt(4)
  v_mfma_f32_32x32x16_bf16 a[32:47], a[220:223], v[72:75], a[32:47]
  ds_read_b64_tr_b16 a[216:217], v6 offset:30976
  v_add_f32 v16, v16, v101
  v_cvt_pk_bf16_f32 v98, v100, v101
  v_exp_f32 v103, v103
  v_mfma_f32_32x32x16_bf16 a[48:63], a[220:223], v[88:91], a[48:63]
  ds_read_b64_tr_b16 a[218:219], v6 offset:34048
  v_add_f32 v16, v16, v102
  v_add_f32 v16, v16, v103
  v_cvt_pk_bf16_f32 v99, v102, v103
  s_waitcnt lgkmcnt(4)
  v_mfma_f32_32x32x16_bf16 a[64:79], a[208:211], v[72:75], a[64:79]
  ds_read_b64_tr_b16 a[220:221], v7 offset:30976
  v_exp_f32 v112, v112
  v_exp_f32 v113, v113
  v_mfma_f32_32x32x16_bf16 a[80:95], a[208:211], v[88:91], a[80:95]
  ds_read_b64_tr_b16 a[222:223], v7 offset:34048
  v_exp_f32 v114, v114
  v_add_f32 v17, v17, v112
  s_waitcnt lgkmcnt(4)
  v_mfma_f32_32x32x16_bf16 a[96:111], a[212:215], v[72:75], a[96:111]
  ds_read_b128 a[192:195], v2 offset:49152
  v_add_f32 v17, v17, v113
  v_cvt_pk_bf16_f32 v112, v112, v113
  v_exp_f32 v115, v115
  v_mfma_f32_32x32x16_bf16 a[112:127], a[212:215], v[88:91], a[112:127]
  v_add_f32 v17, v17, v114
  v_exp_f32 v116, v116
  s_waitcnt lgkmcnt(3)
  v_mfma_f32_32x32x16_bf16 a[128:143], a[216:219], v[72:75], a[128:143]
  ds_read_b128 a[196:199], v3 offset:49152
  v_add_f32 v17, v17, v115
  v_cvt_pk_bf16_f32 v113, v114, v115
  v_exp_f32 v117, v117
  v_mfma_f32_32x32x16_bf16 a[144:159], a[216:219], v[88:91], a[144:159]
  v_add_f32 v17, v17, v116
  v_exp_f32 v118, v118
  s_waitcnt lgkmcnt(2)
  v_mfma_f32_32x32x16_bf16 a[160:175], a[220:223], v[72:75], a[160:175]
  ds_read_b128 a[200:203], v4 offset:49152
  v_add_f32 v17, v17, v117
  v_cvt_pk_bf16_f32 v114, v116, v117
  v_exp_f32 v119, v119
  v_mfma_f32_32x32x16_bf16 a[176:191], a[220:223], v[88:91], a[176:191]
  v_add_f32 v17, v17, v118
  v_add_f32 v17, v17, v119
  v_cvt_pk_bf16_f32 v115, v118, v119
  s_cmp_eq_u32 s32, 0
  s_cbranch_scc1 L_ok2_l2
  s_call_b64 s[36:37], L_rare2
L_ok2_l2:
  s_waitcnt vmcnt(21)
  s_barrier
  s_waitcnt lgkmcnt(2)
  v_mfma_f32_32x32x16_bf16 v[64:79], a[192:195], v[160:163], v[32:47]
  ds_read_b128 a[204:207], v5 offset:49152
  s_add_u32 s45, s30, 12288
  s_add_u32 s46, s48, s45
  s_sub_u32 s44, s46, 393216
  s_cmp_ge_u32 s46, 393216
  s_cselect_b32 s46, s44, s46
  s_cmp_ge_u32 s45, 393216
  s_cselect_b32 s46, s45, s46
  v_exp_f32 v104, v104
  v_mfma_f32_32x32x16_bf16 v[80:95], a[192:195], v[168:171], v[48:63]
  s_add_u32 m0, s28, 36864
  s_nop 0
  buffer_load_dwordx4 v10, s[12:15], s46 offen offset:0 nt lds
  v_exp_f32 v105, v105
  s_waitcnt lgkmcnt(2)
  v_mfma_f32_32x32x16_bf16 v[64:79], a[196:199], v[164:167], v[64:79]
  ds_read_b128 a[192:195], v2 offset:49280
  v_exp_f32 v106, v106
  v_add_f32 v16, v16, v104
  v_mfma_f32_32x32x16_bf16 v[80:95], a[196:199], v[172:175], v[80:95]
  buffer_load_dwordx4 v11, s[12:15], s46 offen offset:1024 nt lds
  v_add_f32 v16, v16, v105
  v_cvt_pk_bf16_f32 v104, v104, v105
  s_waitcnt lgkmcnt(2)
  v_mfma_f32_32x32x16_bf16 v[64:79], a[200:203], v[176:179], v[64:79]
  ds_read_b128 a[196:199], v3 offset:49280
  v_exp_f32 v107, v107
  v_add_f32 v16, v16, v106
  v_mfma_f32_32x32x16_bf16 v[80:95], a[200:203], v[184:187], v[80:95]
  buffer_load_dwordx4 v12, s[12:15], s46 offen offset:2048 nt lds
  v_exp_f32 v108, v108
  s_waitcnt lgkmcnt(2)
  v_mfma_f32_32x32x16_bf16 v[64:79], a[204:207], v[180:183], v[64:79]
  ds_read_b128 a[200:203], v4 offset:49280
  s_add_u32 s47, s48, s30
  s_sub_u32 s44, s47, 393216
  s_cmp_ge_u32 s47, 393216
  s_cselect_b32 s47, s44, s47
  s_cmp_ge_u32 s30, 393216
  s_cselect_b32 s47, s30, s47
  v_add_f32 v16, v16, v107
  v_cvt_pk_bf16_f32 v105, v106, v107
  v_mfma_f32_32x32x16_bf16 v[80:95], a[204:207], v[188:191], v[80:95]
  s_add_u32 m0, s28, 98304
  s_nop 0
  buffer_load_dwordx4 v13, s[16:19], s47 offen offset:0 nt lds
  v_exp_f32 v109, v109
  v_add_f32 v16, v16, v108
  s_waitcnt lgkmcnt(2)
  v_mfma_f32_32x32x16_bf16 v[64:79], a[192:195], v[192:195], v[64:79]
  ds_read_b128 a[204:207], v5 offset:49280
  v_exp_f32 v110, v110
  v_mfma_f32_32x32x16_bf16 v[80:95], a[192:195], v[200:203], v[80:95]
  buffer_load_dwordx4 v14, s[16:19], s47 offen offset:1024 nt lds
  v_add_f32 v16, v16, v109
  v_cvt_pk_bf16_f32 v106, v108, v109
  s_waitcnt lgkmcnt(2)
  v_mfma_f32_32x32x16_bf16 v[64:79], a[196:199], v[196:199], v[64:79]
  ds_read_b128 a[192:195], v2 offset:49408
  v_exp_f32 v111, v111
  v_add_f32 v16, v16, v110
  v_mfma_f32_32x32x16_bf16 v[80:95], a[196:199], v[204:207], v[80:95]
  buffer_load_dwordx4 v15, s[16:19], s47 offen offset:2048 nt lds
  s_add_u32 s30, s30, 12288
  v_add_f32 v16, v16, v111
  v_cvt_pk_bf16_f32 v107, v110, v111
  s_waitcnt lgkmcnt(2)
  v_mfma_f32_32x32x16_bf16 v[64:79], a[200:203], v[208:211], v[64:79]
  ds_read_b128 a[196:199], v3 offset:49408
  v_exp_f32 v120, v120
  v_mfma_f32_32x32x16_bf16 v[80:95], a[200:203], v[216:219], v[80:95]
  v_exp_f32 v121, v121
  s_waitcnt lgkmcnt(2)
  v_mfma_f32_32x32x16_bf16 v[64:79], a[204:207], v[212:215], v[64:79]
  ds_read_b128 a[200:203], v4 offset:49408
  v_exp_f32 v122, v122
  v_add_f32 v17, v17, v120
  v_mfma_f32_32x32x16_bf16 v[80:95], a[204:207], v[220:223], v[80:95]
  v_add_f32 v17, v17, v121
  v_cvt_pk_bf16_f32 v120, v120, v121
  s_waitcnt lgkmcnt(2)
  v_mfma_f32_32x32x16_bf16 v[64:79], a[192:195], v[224:227], v[64:79]
  ds_read_b128 a[204:207], v5 offset:49408
  v_exp_f32 v123, v123
  v_add_f32 v17, v17, v122
  v_mfma_f32_32x32x16_bf16 v[80:95], a[192:195], v[232:235], v[80:95]
  v_exp_f32 v124, v124
  s_waitcnt lgkmcnt(2)
  v_mfma_f32_32x32x16_bf16 v[64:79], a[196:199], v[228:231], v[64:79]
  ds_read_b64_tr_b16 a[208:209], v8 offset:0
  v_add_f32 v17, v17, v123
  v_cvt_pk_bf16_f32 v121, v122, v123
  v_mfma_f32_32x32x16_bf16 v[80:95], a[196:199], v[236:239], v[80:95]
  ds_read_b64_tr_b16 a[210:211], v8 offset:3072
  v_exp_f32 v125, v125
  v_add_f32 v17, v17, v124
  s_waitcnt lgkmcnt(3)
  v_mfma_f32_32x32x16_bf16 v[64:79], a[200:203], v[240:243], v[64:79]
  ds_read_b64_tr_b16 a[212:213], v9 offset:0
  v_exp_f32 v126, v126
  v_mfma_f32_32x32x16_bf16 v[80:95], a[200:203], v[248:251], v[80:95]
  ds_read_b64_tr_b16 a[214:215], v9 offset:3072
  v_add_f32 v17, v17, v125
  v_cvt_pk_bf16_f32 v122, v124, v125
  s_waitcnt lgkmcnt(4)
  v_mfma_f32_32x32x16_bf16 v[64:79], a[204:207], v[244:247], v[64:79]
  ds_read_b64_tr_b16 a[216:217], v8 offset:128
  v_exp_f32 v127, v127
  v_add_f32 v17, v17, v126
  v_mfma_f32_32x32x16_bf16 v[80:95], a[204:207], v[252:255], v[80:95]
  ds_read_b64_tr_b16 a[218:219], v8 offset:3200
  v_add_f32 v17, v17, v127
  v_cvt_pk_bf16_f32 v123, v126, v127
  s_waitcnt lgkmcnt(4)
  v_mfma_f32_32x32x16_bf16 a[0:15], a[208:211], v[96:99], a[0:15]
  ds_read_b64_tr_b16 a[220:221], v9 offset:128
  v_mfma_f32_32x32x16_bf16 a[16:31], a[208:211], v[112:115], a[16:31]
  ds_read_b64_tr_b16 a[222:223], v9 offset:3200
  s_waitcnt lgkmcnt(4)
  v_mfma_f32_32x32x16_bf16 a[32:47], a[212:215], v[96:99], a[32:47]
  ds_read_b64_tr_b16 a[208:209], v8 offset:256
  v_mfma_f32_32x32x16_bf16 a[48:63], a[212:215], v[112:115], a[48:63]
  ds_read_b64_tr_b16 a[210:211], v8 offset:3328
  v_max3_f32 v18, v64, v65, v66
  v_max3_f32 v18, v18, v67, v68
  v_max3_f32 v18, v18, v69, v70
  s_waitcnt lgkmcnt(4)
  v_mfma_f32_32x32x16_bf16 a[64:79], a[216:219], v[96:99], a[64:79]
  ds_read_b64_tr_b16 a[212:213], v9 offset:256
  v_max3_f32 v18, v18, v71, v72
  v_max3_f32 v18, v18, v73, v74
  v_max3_f32 v18, v18, v75, v76
  v_mfma_f32_32x32x16_bf16 a[80:95], a[216:219], v[112:115], a[80:95]
  ds_read_b64_tr_b16 a[214:215], v9 offset:3328
  v_max3_f32 v18, v18, v77, v78
  v_max3_f32 v18, v18, v79, v80
  v_max3_f32 v18, v18, v81, v82
  v_max3_f32 v18, v18, v83, v84
  s_waitcnt lgkmcnt(4)
  v_mfma_f32_32x32x16_bf16 a[96:111], a[220:223], v[96:99], a[96:111]
  ds_read_b64_tr_b16 a[216:217], v8 offset:6144
  v_max3_f32 v18, v18, v85, v86
  v_max3_f32 v18, v18, v87, v88
  v_max3_f32 v18, v18, v89, v90
  v_mfma_f32_32x32x16_bf16 a[112:127], a[220:223], v[112:115], a[112:127]
  ds_read_b64_tr_b16 a[218:219], v8 offset:9216
  v_max3_f32 v18, v18, v91, v92
  v_max3_f32 v18, v18, v93, v94
  v_max_f32 v18, v18, v95
  v_cmp_lt_f32 vcc, 0x41000000, v18
  s_cbranch_vccz L_ok1_l3
  s_call_b64 s[36:37], L_rare1_0
L_ok1_l3:
  s_waitcnt lgkmcnt(4)
  v_mfma_f32_32x32x16_bf16 a[128:143], a[208:211], v[96:99], a[128:143]
  ds_read_b64_tr_b16 a[220:221], v9 offset:6144
  v_exp_f32 v64, v64
  v_exp_f32 v65, v65
  v_mfma_f32_32x32x16_bf16 a[144:159], a[208:211], v[112:115], a[144:159]
  ds_read_b64_tr_b16 a[222:223], v9 offset:9216
  v_exp_f32 v66, v66
  v_add_f32 v16, v16, v64
  s_waitcnt lgkmcnt(4)
  v_mfma_f32_32x32x16_bf16 a[160:175], a[212:215], v[96:99], a[160:175]
  ds_read_b64_tr_b16 a[208:209], v8 offset:6272
  v_add_f32 v16, v16, v65
  v_cvt_pk_bf16_f32 v64, v64, v65
  v_exp_f32 v67, v67
  v_mfma_f32_32x32x16_bf16 a[176:191], a[212:215], v[112:115], a[176:191]
  ds_read_b64_tr_b16 a[210:211], v8 offset:9344
  v_add_f32 v16, v16, v66
  v_exp_f32 v68, v68
  s_waitcnt lgkmcnt(4)
  v_mfma_f32_32x32x16_bf16 a[0:15], a[216:219], v[104:107], a[0:15]
  ds_read_b64_tr_b16 a[212:213], v9 offset:6272
  v_add_f32 v16, v16, v67
  v_cvt_pk_bf16_f32 v65, v66, v67
  v_exp_f32 v69, v69
  v_mfma_f32_32x32x16_bf16 a[16:31], a[216:219], v[120:123], a[16:31]
  ds_read_b64_tr_b16 a[214:215], v9 offset:9344
  v_add_f32 v16, v16, v68
  v_exp_f32 v70, v70
  s_waitcnt lgkmcnt(4)
  v_mfma_f32_32x32x16_bf16 a[32:47], a[220:223], v[104:107], a[32:47]
  ds_read_b64_tr_b16 a[216:217], v8 offset:6400
  v_add_f32 v16, v16, v69
  v_cvt_pk_bf16_f32 v66, v68, v69
  v_exp_f32 v71, v71
  v_mfma_f32_32x32x16_bf16 a[48:63], a[220:223], v[120:123], a[48:63]
  ds_read_b64_tr_b16 a[218:219], v8 offset:9472
  v_add_f32 v16, v16, v70
  v_add_f32 v16, v16, v71
  v_cvt_pk_bf16_f32 v67, v70, v71
  s_waitcnt lgkmcnt(4)
  v_mfma_f32_32x32x16_bf16 a[64:79], a[208:211], v[104:107], a[64:79]
  ds_read_b64_tr_b16 a[220:221], v9 offset:6400
  v_exp_f32 v80, v80
  v_exp_f32 v81, v81
  v_mfma_f32_32x32x16_bf16 a[80:95], a[208:211], v[120:123], a[80:95]
  ds_read_b64_tr_b16 a[222:223], v9 offset:9472
  v_exp_f32 v82, v82
  v_add_f32 v17, v17, v80
  s_waitcnt lgkmcnt(4)
  v_mfma_f32_32x32x16_bf16 a[96:111], a[212:215], v[104:107], a[96:111]
  ds_read_b128 a[192:195], v2 offset:61440
  v_add_f32 v17, v17, v81
  v_cvt_pk_bf16_f32 v80, v80, v81
  v_exp_f32 v83, v83
  v_mfma_f32_32x32x16_bf16 a[112:127], a[212:215], v[120:123], a[112:127]
  v_add_f32 v17, v17, v82
  v_exp_f32 v84, v84
  s_waitcnt lgkmcnt(3)
  v_mfma_f32_32x32x16_bf16 a[128:143], a[216:219], v[104:107], a[128:143]
  ds_read_b128 a[196:199], v3 offset:61440
  v_add_f32 v17, v17, v83
  v_cvt_pk_bf16_f32 v81, v82, v83
  v_exp_f32 v85, v85
  v_mfma_f32_32x32x16_bf16 a[144:159], a[216:219], v[120:123], a[144:159]
  v_add_f32 v17, v17, v84
  v_exp_f32 v86, v86
  s_waitcnt lgkmcnt(2)
  v_mfma_f32_32x32x16_bf16 a[160:175], a[220:223], v[104:107], a[160:175]
  ds_read_b128 a[200:203], v4 offset:61440
  v_add_f32 v17, v17, v85
  v_cvt_pk_bf16_f32 v82, v84, v85
  v_exp_f32 v87, v87
  v_mfma_f32_32x32x16_bf16 a[176:191], a[220:223], v[120:123], a[176:191]
  v_add_f32 v17, v17, v86
  v_add_f32 v17, v17, v87
  v_cvt_pk_bf16_f32 v83, v86, v87
  s_cmp_eq_u32 s32, 0
  s_cbranch_scc1 L_ok2_l3
  s_call_b64 s[36:37], L_rare2
L_ok2_l3:
  s_waitcnt vmcnt(21)
  s_barrier
  s_waitcnt lgkmcnt(2)
  v_mfma_f32_32x32x16_bf16 v[96:111], a[192:195], v[160:163], v[32:47]
  ds_read_b128 a[204:207], v5 offset:61440
  s_add_u32 s45, s30, 12288
  s_add_u32 s46, s48, s45
  s_sub_u32 s44, s46, 393216
  s_cmp_ge_u32 s46, 393216
  s_cselect_b32 s46, s44, s46
  s_cmp_ge_u32 s45, 393216
  s_cselect_b32 s46, s45, s46
  v_exp_f32 v72, v72
  v_mfma_f32_32x32x16_bf16 v[112:127], a[192:195], v[168:171], v[48:63]
  s_add_u32 m0, s28, 49152
  s_nop 0
  buffer_load_dwordx4 v10, s[12:15], s46 offen offset:0 nt lds
  v_exp_f32 v73, v73
  s_waitcnt lgkmcnt(2)
  v_mfma_f32_32x32x16_bf16 v[96:111], a[196:199], v[164:167], v[96:111]
  ds_read_b128 a[192:195], v2 offset:61568
  v_exp_f32 v74, v74
  v_add_f32 v16, v16, v72
  v_mfma_f32_32x32x16_bf16 v[112:127], a[196:199], v[172:175], v[112:127]
  buffer_load_dwordx4 v11, s[12:15], s46 offen offset:1024 nt lds
  v_add_f32 v16, v16, v73
  v_cvt_pk_bf16_f32 v72, v72, v73
  s_waitcnt lgkmcnt(2)
  v_mfma_f32_32x32x16_bf16 v[96:111], a[200:203], v[176:179], v[96:111]
  ds_read_b128 a[196:199], v3 offset:61568
  v_exp_f32 v75, v75
  v_add_f32 v16, v16, v74
  v_mfma_f32_32x32x16_bf16 v[112:127], a[200:203], v[184:187], v[112:127]
  buffer_load_dwordx4 v12, s[12:15], s46 offen offset:2048 nt lds
  v_exp_f32 v76, v76
  s_waitcnt lgkmcnt(2)
  v_mfma_f32_32x32x16_bf16 v[96:111], a[204:207], v[180:183], v[96:111]
  ds_read_b128 a[200:203], v4 offset:61568
  s_add_u32 s47, s48, s30
  s_sub_u32 s44, s47, 393216
  s_cmp_ge_u32 s47, 393216
  s_cselect_b32 s47, s44, s47
  s_cmp_ge_u32 s30, 393216
  s_cselect_b32 s47, s30, s47
  v_add_f32 v16, v16, v75
  v_cvt_pk_bf16_f32 v73, v74, v75
  v_mfma_f32_32x32x16_bf16 v[112:127], a[204:207], v[188:191], v[112:127]
  s_add_u32 m0, s28, 110592
  s_nop 0
  buffer_load_dwordx4 v13, s[16:19], s47 offen offset:0 nt lds
  v_exp_f32 v77, v77
  v_add_f32 v16, v16, v76
  s_waitcnt lgkmcnt(2)
  v_mfma_f32_32x32x16_bf16 v[96:111], a[192:195], v[192:195], v[96:111]
  ds_read_b128 a[204:207], v5 offset:61568
  v_exp_f32 v78, v78
  v_mfma_f32_32x32x16_bf16 v[112:127], a[192:195], v[200:203], v[112:127]
  buffer_load_dwordx4 v14, s[16:19], s47 offen offset:1024 nt lds
  v_add_f32 v16, v16, v77
  v_cvt_pk_bf16_f32 v74, v76, v77
  s_waitcnt lgkmcnt(2)
  v_mfma_f32_32x32x16_bf16 v[96:111], a[196:199], v[196:199], v[96:111]
  ds_read_b128 a[192:195], v2 offset:61696
  v_exp_f32 v79, v79
  v_add_f32 v16, v16, v78
  v_mfma_f32_32x32x16_bf16 v[112:127], a[196:199], v[204:207], v[112:127]
  buffer_load_dwordx4 v15, s[16:19], s47 offen offset:2048 nt lds
  s_add_u32 s30, s30, 12288
  v_add_f32 v16, v16, v79
  v_cvt_pk_bf16_f32 v75, v78, v79
  s_waitcnt lgkmcnt(2)
  v_mfma_f32_32x32x16_bf16 v[96:111], a[200:203], v[208:211], v[96:111]
  ds_read_b128 a[196:199], v3 offset:61696
  v_exp_f32 v88, v88
  v_mfma_f32_32x32x16_bf16 v[112:127], a[200:203], v[216:219], v[112:127]
  v_exp_f32 v89, v89
  s_waitcnt lgkmcnt(2)
  v_mfma_f32_32x32x16_bf16 v[96:111], a[204:207], v[212:215], v[96:111]
  ds_read_b128 a[200:203], v4 offset:61696
  v_exp_f32 v90, v90
  v_add_f32 v17, v17, v88
  v_mfma_f32_32x32x16_bf16 v[112:127], a[204:207], v[220:223], v[112:127]
  v_add_f32 v17, v17, v89
  v_cvt_pk_bf16_f32 v88, v88, v89
  s_waitcnt lgkmcnt(2)
  v_mfma_f32_32x32x16_bf16 v[96:111], a[192:195], v[224:227], v[96:111]
  ds_read_b128 a[204:207], v5 offset:61696
  v_exp_f32 v91, v91
  v_add_f32 v17, v17, v90
  v_mfma_f32_32x32x16_bf16 v[112:127], a[192:195], v[232:235], v[112:127]
  v_exp_f32 v92, v92
  s_waitcnt lgkmcnt(2)
  v_mfma_f32_32x32x16_bf16 v[96:111], a[196:199], v[228:231], v[96:111]
  ds_read_b64_tr_b16 a[208:209], v8 offset:12288
  v_add_f32 v17, v17, v91
  v_cvt_pk_bf16_f32 v89, v90, v91
  v_mfma_f32_32x32x16_bf16 v[112:127], a[196:199], v[236:239], v[112:127]
  ds_read_b64_tr_b16 a[210:211], v8 offset:15360
  v_exp_f32 v93, v93
  v_add_f32 v17, v17, v92
  s_waitcnt lgkmcnt(3)
  v_mfma_f32_32x32x16_bf16 v[96:111], a[200:203], v[240:243], v[96:111]
  ds_read_b64_tr_b16 a[212:213], v9 offset:12288
  v_exp_f32 v94, v94
  v_mfma_f32_32x32x16_bf16 v[112:127], a[200:203], v[248:251], v[112:127]
  ds_read_b64_tr_b16 a[214:215], v9 offset:15360
  v_add_f32 v17, v17, v93
  v_cvt_pk_bf16_f32 v90, v92, v93
  s_waitcnt lgkmcnt(4)
  v_mfma_f32_32x32x16_bf16 v[96:111], a[204:207], v[244:247], v[96:111]
  ds_read_b64_tr_b16 a[216:217], v8 offset:12416
  v_exp_f32 v95, v95
  v_add_f32 v17, v17, v94
  v_mfma_f32_32x32x16_bf16 v[112:127], a[204:207], v[252:255], v[112:127]
  ds_read_b64_tr_b16 a[218:219], v8 offset:15488
  v_add_f32 v17, v17, v95
  v_cvt_pk_bf16_f32 v91, v94, v95
  s_waitcnt lgkmcnt(4)
  v_mfma_f32_32x32x16_bf16 a[0:15], a[208:211], v[64:67], a[0:15]
  ds_read_b64_tr_b16 a[220:221], v9 offset:12416
  v_mfma_f32_32x32x16_bf16 a[16:31], a[208:211], v[80:83], a[16:31]
  ds_read_b64_tr_b16 a[222:223], v9 offset:15488
  s_waitcnt lgkmcnt(4)
  v_mfma_f32_32x32x16_bf16 a[32:47], a[212:215], v[64:67], a[32:47]
  ds_read_b64_tr_b16 a[208:209], v8 offset:12544
  v_mfma_f32_32x32x16_bf16 a[48:63], a[212:215], v[80:83], a[48:63]
  ds_read_b64_tr_b16 a[210:211], v8 offset:15616
  v_max3_f32 v18, v96, v97, v98
  v_max3_f32 v18, v18, v99, v100
  v_max3_f32 v18, v18, v101, v102
  s_waitcnt lgkmcnt(4)
  v_mfma_f32_32x32x16_bf16 a[64:79], a[216:219], v[64:67], a[64:79]
  ds_read_b64_tr_b16 a[212:213], v9 offset:12544
  v_max3_f32 v18, v18, v103, v104
  v_max3_f32 v18, v18, v105, v106
  v_max3_f32 v18, v18, v107, v108
  v_mfma_f32_32x32x16_bf16 a[80:95], a[216:219], v[80:83], a[80:95]
  ds_read_b64_tr_b16 a[214:215], v9 offset:15616
  v_max3_f32 v18, v18, v109, v110
  v_max3_f32 v18, v18, v111, v112
  v_max3_f32 v18, v18, v113, v114
  v_max3_f32 v18, v18, v115, v116
  s_waitcnt lgkmcnt(4)
  v_mfma_f32_32x32x16_bf16 a[96:111], a[220:223], v[64:67], a[96:111]
  ds_read_b64_tr_b16 a[216:217], v8 offset:18432
  v_max3_f32 v18, v18, v117, v118
  v_max3_f32 v18, v18, v119, v120
  v_max3_f32 v18, v18, v121, v122
  v_mfma_f32_32x32x16_bf16 a[112:127], a[220:223], v[80:83], a[112:127]
  ds_read_b64_tr_b16 a[218:219], v8 offset:21504
  v_max3_f32 v18, v18, v123, v124
  v_max3_f32 v18, v18, v125, v126
  v_max_f32 v18, v18, v127
  v_cmp_lt_f32 vcc, 0x41000000, v18
  s_cbranch_vccz L_ok1_l4
  s_call_b64 s[36:37], L_rare1_1
L_ok1_l4:
  s_waitcnt lgkmcnt(4)
  v_mfma_f32_32x32x16_bf16 a[128:143], a[208:211], v[64:67], a[128:143]
  ds_read_b64_tr_b16 a[220:221], v9 offset:18432
  v_exp_f32 v96, v96
  v_exp_f32 v97, v97
  v_mfma_f32_32x32x16_bf16 a[144:159], a[208:211], v[80:83], a[144:159]
  ds_read_b64_tr_b16 a[222:223], v9 offset:21504
  v_exp_f32 v98, v98
  v_add_f32 v16, v16, v96
  s_waitcnt lgkmcnt(4)
  v_mfma_f32_32x32x16_bf16 a[160:175], a[212:215], v[64:67], a[160:175]
  ds_read_b64_tr_b16 a[208:209], v8 offset:18560
  v_add_f32 v16, v16, v97
  v_cvt_pk_bf16_f32 v96, v96, v97
  v_exp_f32 v99, v99
  v_mfma_f32_32x32x16_bf16 a[176:191], a[212:215], v[80:83], a[176:191]
  ds_read_b64_tr_b16 a[210:211], v8 offset:21632
  v_add_f32 v16, v16, v98
  v_exp_f32 v100, v100
  s_waitcnt lgkmcnt(4)
  v_mfma_f32_32x32x16_bf16 a[0:15], a[216:219], v[72:75], a[0:15]
  ds_read_b64_tr_b16 a[212:213], v9 offset:18560
  v_add_f32 v16, v16, v99
  v_cvt_pk_bf16_f32 v97, v98, v99
  v_exp_f32 v101, v101
  v_mfma_f32_32x32x16_bf16 a[16:31], a[216:219], v[88:91], a[16:31]
  ds_read_b64_tr_b16 a[214:215], v9 offset:21632
  v_add_f32 v16, v16, v100
  v_exp_f32 v102, v102
  s_waitcnt lgkmcnt(4)
  v_mfma_f32_32x32x16_bf16 a[32:47], a[220:223], v[72:75], a[32:47]
  ds_read_b64_tr_b16 a[216:217], v8 offset:18688
  v_add_f32 v16, v16, v101
  v_cvt_pk_bf16_f32 v98, v100, v101
  v_exp_f32 v103, v103
  v_mfma_f32_32x32x16_bf16 a[48:63], a[220:223], v[88:91], a[48:63]
  ds_read_b64_tr_b16 a[218:219], v8 offset:21760
  v_add_f32 v16, v16, v102
  v_add_f32 v16, v16, v103
  v_cvt_pk_bf16_f32 v99, v102, v103
  s_waitcnt lgkmcnt(4)
  v_mfma_f32_32x32x16_bf16 a[64:79], a[208:211], v[72:75], a[64:79]
  ds_read_b64_tr_b16 a[220:221], v9 offset:18688
  v_exp_f32 v112, v112
  v_exp_f32 v113, v113
  v_mfma_f32_32x32x16_bf16 a[80:95], a[208:211], v[88:91], a[80:95]
  ds_read_b64_tr_b16 a[222:223], v9 offset:21760
  v_exp_f32 v114, v114
  v_add_f32 v17, v17, v112
  s_waitcnt lgkmcnt(4)
  v_mfma_f32_32x32x16_bf16 a[96:111], a[212:215], v[72:75], a[96:111]
  ds_read_b128 a[192:195], v2 offset:0
  v_add_f32 v17, v17, v113
  v_cvt_pk_bf16_f32 v112, v112, v113
  v_exp_f32 v115, v115
  v_mfma_f32_32x32x16_bf16 a[112:127], a[212:215], v[88:91], a[112:127]
  v_add_f32 v17, v17, v114
  v_exp_f32 v116, v116
  s_waitcnt lgkmcnt(3)
  v_mfma_f32_32x32x16_bf16 a[128:143], a[216:219], v[72:75], a[128:143]
  ds_read_b128 a[196:199], v3 offset:0
  v_add_f32 v17, v17, v115
  v_cvt_pk_bf16_f32 v113, v114, v115
  v_exp_f32 v117, v117
  v_mfma_f32_32x32x16_bf16 a[144:159], a[216:219], v[88:91], a[144:159]
  v_add_f32 v17, v17, v116
  v_exp_f32 v118, v118
  s_waitcnt lgkmcnt(2)
  v_mfma_f32_32x32x16_bf16 a[160:175], a[220:223], v[72:75], a[160:175]
  ds_read_b128 a[200:203], v4 offset:0
  v_add_f32 v17, v17, v117
  v_cvt_pk_bf16_f32 v114, v116, v117
  v_exp_f32 v119, v119
  v_mfma_f32_32x32x16_bf16 a[176:191], a[220:223], v[88:91], a[176:191]
  v_add_f32 v17, v17, v118
  v_add_f32 v17, v17, v119
  v_cvt_pk_bf16_f32 v115, v118, v119
  s_cmp_eq_u32 s32, 0
  s_cbranch_scc1 L_ok2_l4
  s_call_b64 s[36:37], L_rare2
L_ok2_l4:
  s_waitcnt vmcnt(21)
  s_barrier
  s_waitcnt lgkmcnt(2)
  v_mfma_f32_32x32x16_bf16 v[64:79], a[192:195], v[160:163], v[32:47]
  ds_read_b128 a[204:207], v5 offset:0
  s_add_u32 s45, s30, 12288
  s_add_u32 s46, s48, s45
  s_sub_u32 s44, s46, 393216
  s_cmp_ge_u32 s46, 393216
  s_cselect_b32 s46, s44, s46
  s_cmp_ge_u32 s45, 393216
  s_cselect_b32 s46, s45, s46
  v_exp_f32 v104, v104
  v_mfma_f32_32x32x16_bf16 v[80:95], a[192:195], v[168:171], v[48:63]
  s_add_u32 m0, s28, 61440
  s_nop 0
  buffer_load_dwordx4 v10, s[12:15], s46 offen offset:0 nt lds
  v_exp_f32 v105, v105
  s_waitcnt lgkmcnt(2)
  v_mfma_f32_32x32x16_bf16 v[64:79], a[196:199], v[164:167], v[64:79]
  ds_read_b128 a[192:195], v2 offset:128
  v_exp_f32 v106, v106
  v_add_f32 v16, v16, v104
  v_mfma_f32_32x32x16_bf16 v[80:95], a[196:199], v[172:175], v[80:95]
  buffer_load_dwordx4 v11, s[12:15], s46 offen offset:1024 nt lds
  v_add_f32 v16, v16, v105
  v_cvt_pk_bf16_f32 v104, v104, v105
  s_waitcnt lgkmcnt(2)
  v_mfma_f32_32x32x16_bf16 v[64:79], a[200:203], v[176:179], v[64:79]
  ds_read_b128 a[196:199], v3 offset:128
  v_exp_f32 v107, v107
  v_add_f32 v16, v16, v106
  v_mfma_f32_32x32x16_bf16 v[80:95], a[200:203], v[184:187], v[80:95]
  buffer_load_dwordx4 v12, s[12:15], s46 offen offset:2048 nt lds
  v_exp_f32 v108, v108
  s_waitcnt lgkmcnt(2)
  v_mfma_f32_32x32x16_bf16 v[64:79], a[204:207], v[180:183], v[64:79]
  ds_read_b128 a[200:203], v4 offset:128
  s_add_u32 s47, s48, s30
  s_sub_u32 s44, s47, 393216
  s_cmp_ge_u32 s47, 393216
  s_cselect_b32 s47, s44, s47
  s_cmp_ge_u32 s30, 393216
  s_cselect_b32 s47, s30, s47
  v_add_f32 v16, v16, v107
  v_cvt_pk_bf16_f32 v105, v106, v107
  v_mfma_f32_32x32x16_bf16 v[80:95], a[204:207], v[188:191], v[80:95]
  s_add_u32 m0, s28, 122880
  s_nop 0
  buffer_load_dwordx4 v13, s[16:19], s47 offen offset:0 nt lds
  v_exp_f32 v109, v109
  v_add_f32 v16, v16, v108
  s_waitcnt lgkmcnt(2)
  v_mfma_f32_32x32x16_bf16 v[64:79], a[192:195], v[192:195], v[64:79]
  ds_read_b128 a[204:207], v5 offset:128
  v_exp_f32 v110, v110
  v_mfma_f32_32x32x16_bf16 v[80:95], a[192:195], v[200:203], v[80:95]
  buffer_load_dwordx4 v14, s[16:19], s47 offen offset:1024 nt lds
  v_add_f32 v16, v16, v109
  v_cvt_pk_bf16_f32 v106, v108, v109
  s_waitcnt lgkmcnt(2)
  v_mfma_f32_32x32x16_bf16 v[64:79], a[196:199], v[196:199], v[64:79]
  ds_read_b128 a[192:195], v2 offset:256
  v_exp_f32 v111, v111
  v_add_f32 v16, v16, v110
  v_mfma_f32_32x32x16_bf16 v[80:95], a[196:199], v[204:207], v[80:95]
  buffer_load_dwordx4 v15, s[16:19], s47 offen offset:2048 nt lds
  s_add_u32 s30, s30, 12288
  v_add_f32 v16, v16, v111
  v_cvt_pk_bf16_f32 v107, v110, v111
  s_waitcnt lgkmcnt(2)
  v_mfma_f32_32x32x16_bf16 v[64:79], a[200:203], v[208:211], v[64:79]
  ds_read_b128 a[196:199], v3 offset:256
  v_exp_f32 v120, v120
  v_mfma_f32_32x32x16_bf16 v[80:95], a[200:203], v[216:219], v[80:95]
  v_exp_f32 v121, v121
  s_waitcnt lgkmcnt(2)
  v_mfma_f32_32x32x16_bf16 v[64:79], a[204:207], v[212:215], v[64:79]
  ds_read_b128 a[200:203], v4 offset:256
  v_exp_f32 v122, v122
  v_add_f32 v17, v17, v120
  v_mfma_f32_32x32x16_bf16 v[80:95], a[204:207], v[220:223], v[80:95]
  v_add_f32 v17, v17, v121
  v_cvt_pk_bf16_f32 v120, v120, v121
  s_waitcnt lgkmcnt(2)
  v_mfma_f32_32x32x16_bf16 v[64:79], a[192:195], v[224:227], v[64:79]
  ds_read_b128 a[204:207], v5 offset:256
  v_exp_f32 v123, v123
  v_add_f32 v17, v17, v122
  v_mfma_f32_32x32x16_bf16 v[80:95], a[192:195], v[232:235], v[80:95]
  v_exp_f32 v124, v124
  s_waitcnt lgkmcnt(2)
  v_mfma_f32_32x32x16_bf16 v[64:79], a[196:199], v[228:231], v[64:79]
  ds_read_b64_tr_b16 a[208:209], v8 offset:24576
  v_add_f32 v17, v17, v123
  v_cvt_pk_bf16_f32 v121, v122, v123
  v_mfma_f32_32x32x16_bf16 v[80:95], a[196:199], v[236:239], v[80:95]
  ds_read_b64_tr_b16 a[210:211], v8 offset:27648
  v_exp_f32 v125, v125
  v_add_f32 v17, v17, v124
  s_waitcnt lgkmcnt(3)
  v_mfma_f32_32x32x16_bf16 v[64:79], a[200:203], v[240:243], v[64:79]
  ds_read_b64_tr_b16 a[212:213], v9 offset:24576
  v_exp_f32 v126, v126
  v_mfma_f32_32x32x16_bf16 v[80:95], a[200:203], v[248:251], v[80:95]
  ds_read_b64_tr_b16 a[214:215], v9 offset:27648
  v_add_f32 v17, v17, v125
  v_cvt_pk_bf16_f32 v122, v124, v125
  s_waitcnt lgkmcnt(4)
  v_mfma_f32_32x32x16_bf16 v[64:79], a[204:207], v[244:247], v[64:79]
  ds_read_b64_tr_b16 a[216:217], v8 offset:24704
  v_exp_f32 v127, v127
  v_add_f32 v17, v17, v126
  v_mfma_f32_32x32x16_bf16 v[80:95], a[204:207], v[252:255], v[80:95]
  ds_read_b64_tr_b16 a[218:219], v8 offset:27776
  v_add_f32 v17, v17, v127
  v_cvt_pk_bf16_f32 v123, v126, v127
  s_waitcnt lgkmcnt(4)
  v_mfma_f32_32x32x16_bf16 a[0:15], a[208:211], v[96:99], a[0:15]
  ds_read_b64_tr_b16 a[220:221], v9 offset:24704
  v_mfma_f32_32x32x16_bf16 a[16:31], a[208:211], v[112:115], a[16:31]
  ds_read_b64_tr_b16 a[222:223], v9 offset:27776
  s_waitcnt lgkmcnt(4)
  v_mfma_f32_32x32x16_bf16 a[32:47], a[212:215], v[96:99], a[32:47]
  ds_read_b64_tr_b16 a[208:209], v8 offset:24832
  v_mfma_f32_32x32x16_bf16 a[48:63], a[212:215], v[112:115], a[48:63]
  ds_read_b64_tr_b16 a[210:211], v8 offset:27904
  v_max3_f32 v18, v64, v65, v66
  v_max3_f32 v18, v18, v67, v68
  v_max3_f32 v18, v18, v69, v70
  s_waitcnt lgkmcnt(4)
  v_mfma_f32_32x32x16_bf16 a[64:79], a[216:219], v[96:99], a[64:79]
  ds_read_b64_tr_b16 a[212:213], v9 offset:24832
  v_max3_f32 v18, v18, v71, v72
  v_max3_f32 v18, v18, v73, v74
  v_max3_f32 v18, v18, v75, v76
  v_mfma_f32_32x32x16_bf16 a[80:95], a[216:219], v[112:115], a[80:95]
  ds_read_b64_tr_b16 a[214:215], v9 offset:27904
  v_max3_f32 v18, v18, v77, v78
  v_max3_f32 v18, v18, v79, v80
  v_max3_f32 v18, v18, v81, v82
  v_max3_f32 v18, v18, v83, v84
  s_waitcnt lgkmcnt(4)
  v_mfma_f32_32x32x16_bf16 a[96:111], a[220:223], v[96:99], a[96:111]
  ds_read_b64_tr_b16 a[216:217], v8 offset:30720
  v_max3_f32 v18, v18, v85, v86
  v_max3_f32 v18, v18, v87, v88
  v_max3_f32 v18, v18, v89, v90
  v_mfma_f32_32x32x16_bf16 a[112:127], a[220:223], v[112:115], a[112:127]
  ds_read_b64_tr_b16 a[218:219], v8 offset:33792
  v_max3_f32 v18, v18, v91, v92
  v_max3_f32 v18, v18, v93, v94
  v_max_f32 v18, v18, v95
  v_cmp_lt_f32 vcc, 0x41000000, v18
  s_cbranch_vccz L_ok1_l5
  s_call_b64 s[36:37], L_rare1_0
L_ok1_l5:
  s_waitcnt lgkmcnt(4)
  v_mfma_f32_32x32x16_bf16 a[128:143], a[208:211], v[96:99], a[128:143]
  ds_read_b64_tr_b16 a[220:221], v9 offset:30720
  v_exp_f32 v64, v64
  v_exp_f32 v65, v65
  v_mfma_f32_32x32x16_bf16 a[144:159], a[208:211], v[112:115], a[144:159]
  ds_read_b64_tr_b16 a[222:223], v9 offset:33792
  v_exp_f32 v66, v66
  v_add_f32 v16, v16, v64
  s_waitcnt lgkmcnt(4)
  v_mfma_f32_32x32x16_bf16 a[160:175], a[212:215], v[96:99], a[160:175]
  ds_read_b64_tr_b16 a[208:209], v8 offset:30848
  v_add_f32 v16, v16, v65
  v_cvt_pk_bf16_f32 v64, v64, v65
  v_exp_f32 v67, v67
  v_mfma_f32_32x32x16_bf16 a[176:191], a[212:215], v[112:115], a[176:191]
  ds_read_b64_tr_b16 a[210:211], v8 offset:33920
  v_add_f32 v16, v16, v66
  v_exp_f32 v68, v68
  s_waitcnt lgkmcnt(4)
  v_mfma_f32_32x32x16_bf16 a[0:15], a[216:219], v[104:107], a[0:15]
  ds_read_b64_tr_b16 a[212:213], v9 offset:30848
  v_add_f32 v16, v16, v67
  v_cvt_pk_bf16_f32 v65, v66, v67
  v_exp_f32 v69, v69
  v_mfma_f32_32x32x16_bf16 a[16:31], a[216:219], v[120:123], a[16:31]
  ds_read_b64_tr_b16 a[214:215], v9 offset:33920
  v_add_f32 v16, v16, v68
  v_exp_f32 v70, v70
  s_waitcnt lgkmcnt(4)
  v_mfma_f32_32x32x16_bf16 a[32:47], a[220:223], v[104:107], a[32:47]
  ds_read_b64_tr_b16 a[216:217], v8 offset:30976
  v_add_f32 v16, v16, v69
  v_cvt_pk_bf16_f32 v66, v68, v69
  v_exp_f32 v71, v71
  v_mfma_f32_32x32x16_bf16 a[48:63], a[220:223], v[120:123], a[48:63]
  ds_read_b64_tr_b16 a[218:219], v8 offset:34048
  v_add_f32 v16, v16, v70
  v_add_f32 v16, v16, v71
  v_cvt_pk_bf16_f32 v67, v70, v71
  s_waitcnt lgkmcnt(4)
  v_mfma_f32_32x32x16_bf16 a[64:79], a[208:211], v[104:107], a[64:79]
  ds_read_b64_tr_b16 a[220:221], v9 offset:30976
  v_exp_f32 v80, v80
  v_exp_f32 v81, v81
  v_mfma_f32_32x32x16_bf16 a[80:95], a[208:211], v[120:123], a[80:95]
  ds_read_b64_tr_b16 a[222:223], v9 offset:34048
  v_exp_f32 v82, v82
  v_add_f32 v17, v17, v80
  s_waitcnt lgkmcnt(4)
  v_mfma_f32_32x32x16_bf16 a[96:111], a[212:215], v[104:107], a[96:111]
  ds_read_b128 a[192:195], v2 offset:12288
  v_add_f32 v17, v17, v81
  v_cvt_pk_bf16_f32 v80, v80, v81
  v_exp_f32 v83, v83
  v_mfma_f32_32x32x16_bf16 a[112:127], a[212:215], v[120:123], a[112:127]
  v_add_f32 v17, v17, v82
  v_exp_f32 v84, v84
  s_waitcnt lgkmcnt(3)
  v_mfma_f32_32x32x16_bf16 a[128:143], a[216:219], v[104:107], a[128:143]
  ds_read_b128 a[196:199], v3 offset:12288
  v_add_f32 v17, v17, v83
  v_cvt_pk_bf16_f32 v81, v82, v83
  v_exp_f32 v85, v85
  v_mfma_f32_32x32x16_bf16 a[144:159], a[216:219], v[120:123], a[144:159]
  v_add_f32 v17, v17, v84
  v_exp_f32 v86, v86
  s_waitcnt lgkmcnt(2)
  v_mfma_f32_32x32x16_bf16 a[160:175], a[220:223], v[104:107], a[160:175]
  ds_read_b128 a[200:203], v4 offset:12288
  v_add_f32 v17, v17, v85
  v_cvt_pk_bf16_f32 v82, v84, v85
  v_exp_f32 v87, v87
  v_mfma_f32_32x32x16_bf16 a[176:191], a[220:223], v[120:123], a[176:191]
  v_add_f32 v17, v17, v86
  v_add_f32 v17, v17, v87
  v_cvt_pk_bf16_f32 v83, v86, v87
  s_cmp_eq_u32 s32, 0
  s_cbranch_scc1 L_ok2_l5
  s_call_b64 s[36:37], L_rare2
L_ok2_l5:
  s_add_u32 s31, s31, 1
  s_cmp_lt_u32 s31, 5
  s_cbranch_scc1 L_loop
  s_waitcnt vmcnt(21)
  s_barrier
  s_waitcnt lgkmcnt(2)
  v_mfma_f32_32x32x16_bf16 v[96:111], a[192:195], v[160:163], v[32:47]
  ds_read_b128 a[204:207], v5 offset:12288
  s_add_u32 s45, s30, 12288
  s_add_u32 s46, s48, s45
  s_sub_u32 s44, s46, 393216
  s_cmp_ge_u32 s46, 393216
  s_cselect_b32 s46, s44, s46
  s_cmp_ge_u32 s45, 393216
  s_cselect_b32 s46, s45, s46
  v_exp_f32 v72, v72
  v_mfma_f32_32x32x16_bf16 v[112:127], a[192:195], v[168:171], v[48:63]
  s_add_u32 m0, s28, 0
  s_nop 0
  buffer_load_dwordx4 v10, s[12:15], s46 offen offset:0 nt lds
  v_exp_f32 v73, v73
  s_waitcnt lgkmcnt(2)
  v_mfma_f32_32x32x16_bf16 v[96:111], a[196:199], v[164:167], v[96:111]
  ds_read_b128 a[192:195], v2 offset:12416
  v_exp_f32 v74, v74
  v_add_f32 v16, v16, v72
  v_mfma_f32_32x32x16_bf16 v[112:127], a[196:199], v[172:175], v[112:127]
  buffer_load_dwordx4 v11, s[12:15], s46 offen offset:1024 nt lds
  v_add_f32 v16, v16, v73
  v_cvt_pk_bf16_f32 v72, v72, v73
  s_waitcnt lgkmcnt(2)
  v_mfma_f32_32x32x16_bf16 v[96:111], a[200:203], v[176:179], v[96:111]
  ds_read_b128 a[196:199], v3 offset:12416
  v_exp_f32 v75, v75
  v_add_f32 v16, v16, v74
  v_mfma_f32_32x32x16_bf16 v[112:127], a[200:203], v[184:187], v[112:127]
  buffer_load_dwordx4 v12, s[12:15], s46 offen offset:2048 nt lds
  v_exp_f32 v76, v76
  s_waitcnt lgkmcnt(2)
  v_mfma_f32_32x32x16_bf16 v[96:111], a[204:207], v[180:183], v[96:111]
  ds_read_b128 a[200:203], v4 offset:12416
  s_add_u32 s47, s48, s30
  s_sub_u32 s44, s47, 393216
  s_cmp_ge_u32 s47, 393216
  s_cselect_b32 s47, s44, s47
  s_cmp_ge_u32 s30, 393216
  s_cselect_b32 s47, s30, s47
  v_add_f32 v16, v16, v75
  v_cvt_pk_bf16_f32 v73, v74, v75
  v_mfma_f32_32x32x16_bf16 v[112:127], a[204:207], v[188:191], v[112:127]
  s_add_u32 m0, s28, 135168
  s_nop 0
  buffer_load_dwordx4 v13, s[16:19], s47 offen offset:0 nt lds
  v_exp_f32 v77, v77
  v_add_f32 v16, v16, v76
  s_waitcnt lgkmcnt(2)
  v_mfma_f32_32x32x16_bf16 v[96:111], a[192:195], v[192:195], v[96:111]
  ds_read_b128 a[204:207], v5 offset:12416
  v_exp_f32 v78, v78
  v_mfma_f32_32x32x16_bf16 v[112:127], a[192:195], v[200:203], v[112:127]
  buffer_load_dwordx4 v14, s[16:19], s47 offen offset:1024 nt lds
  v_add_f32 v16, v16, v77
  v_cvt_pk_bf16_f32 v74, v76, v77
  s_waitcnt lgkmcnt(2)
  v_mfma_f32_32x32x16_bf16 v[96:111], a[196:199], v[196:199], v[96:111]
  ds_read_b128 a[192:195], v2 offset:12544
  v_exp_f32 v79, v79
  v_add_f32 v16, v16, v78
  v_mfma_f32_32x32x16_bf16 v[112:127], a[196:199], v[204:207], v[112:127]
  buffer_load_dwordx4 v15, s[16:19], s47 offen offset:2048 nt lds
  s_add_u32 s30, s30, 12288
  v_add_f32 v16, v16, v79
  v_cvt_pk_bf16_f32 v75, v78, v79
  s_waitcnt lgkmcnt(2)
  v_mfma_f32_32x32x16_bf16 v[96:111], a[200:203], v[208:211], v[96:111]
  ds_read_b128 a[196:199], v3 offset:12544
  v_exp_f32 v88, v88
  v_mfma_f32_32x32x16_bf16 v[112:127], a[200:203], v[216:219], v[112:127]
  v_exp_f32 v89, v89
  s_waitcnt lgkmcnt(2)
  v_mfma_f32_32x32x16_bf16 v[96:111], a[204:207], v[212:215], v[96:111]
  ds_read_b128 a[200:203], v4 offset:12544
  v_exp_f32 v90, v90
  v_add_f32 v17, v17, v88
  v_mfma_f32_32x32x16_bf16 v[112:127], a[204:207], v[220:223], v[112:127]
  v_add_f32 v17, v17, v89
  v_cvt_pk_bf16_f32 v88, v88, v89
  s_waitcnt lgkmcnt(2)
  v_mfma_f32_32x32x16_bf16 v[96:111], a[192:195], v[224:227], v[96:111]
  ds_read_b128 a[204:207], v5 offset:12544
  v_exp_f32 v91, v91
  v_add_f32 v17, v17, v90
  v_mfma_f32_32x32x16_bf16 v[112:127], a[192:195], v[232:235], v[112:127]
  v_exp_f32 v92, v92
  s_waitcnt lgkmcnt(2)
  v_mfma_f32_32x32x16_bf16 v[96:111], a[196:199], v[228:231], v[96:111]
  ds_read_b64_tr_b16 a[208:209], v6 offset:0
  v_add_f32 v17, v17, v91
  v_cvt_pk_bf16_f32 v89, v90, v91
  v_mfma_f32_32x32x16_bf16 v[112:127], a[196:199], v[236:239], v[112:127]
  ds_read_b64_tr_b16 a[210:211], v6 offset:3072
  v_exp_f32 v93, v93
  v_add_f32 v17, v17, v92
  s_waitcnt lgkmcnt(3)
  v_mfma_f32_32x32x16_bf16 v[96:111], a[200:203], v[240:243], v[96:111]
  ds_read_b64_tr_b16 a[212:213], v7 offset:0
  v_exp_f32 v94, v94
  v_mfma_f32_32x32x16_bf16 v[112:127], a[200:203], v[248:251], v[112:127]
  ds_read_b64_tr_b16 a[214:215], v7 offset:3072
  v_add_f32 v17, v17, v93
  v_cvt_pk_bf16_f32 v90, v92, v93
  s_waitcnt lgkmcnt(4)
  v_mfma_f32_32x32x16_bf16 v[96:111], a[204:207], v[244:247], v[96:111]
  ds_read_b64_tr_b16 a[216:217], v6 offset:128
  v_exp_f32 v95, v95
  v_add_f32 v17, v17, v94
  v_mfma_f32_32x32x16_bf16 v[112:127], a[204:207], v[252:255], v[112:127]
  ds_read_b64_tr_b16 a[218:219], v6 offset:3200
  v_add_f32 v17, v17, v95
  v_cvt_pk_bf16_f32 v91, v94, v95
  s_waitcnt lgkmcnt(4)
  v_mfma_f32_32x32x16_bf16 a[0:15], a[208:211], v[64:67], a[0:15]
  ds_read_b64_tr_b16 a[220:221], v7 offset:128
  v_mfma_f32_32x32x16_bf16 a[16:31], a[208:211], v[80:83], a[16:31]
  ds_read_b64_tr_b16 a[222:223], v7 offset:3200
  s_waitcnt lgkmcnt(4)
  v_mfma_f32_32x32x16_bf16 a[32:47], a[212:215], v[64:67], a[32:47]
  ds_read_b64_tr_b16 a[208:209], v6 offset:256
  v_mfma_f32_32x32x16_bf16 a[48:63], a[212:215], v[80:83], a[48:63]
  ds_read_b64_tr_b16 a[210:211], v6 offset:3328
  v_max3_f32 v18, v96, v97, v98
  v_max3_f32 v18, v18, v99, v100
  v_max3_f32 v18, v18, v101, v102
  s_waitcnt lgkmcnt(4)
  v_mfma_f32_32x32x16_bf16 a[64:79], a[216:219], v[64:67], a[64:79]
  ds_read_b64_tr_b16 a[212:213], v7 offset:256
  v_max3_f32 v18, v18, v103, v104
  v_max3_f32 v18, v18, v105, v106
  v_max3_f32 v18, v18, v107, v108
  v_mfma_f32_32x32x16_bf16 a[80:95], a[216:219], v[80:83], a[80:95]
  ds_read_b64_tr_b16 a[214:215], v7 offset:3328
  v_max3_f32 v18, v18, v109, v110
  v_max3_f32 v18, v18, v111, v112
  v_max3_f32 v18, v18, v113, v114
  v_max3_f32 v18, v18, v115, v116
  s_waitcnt lgkmcnt(4)
  v_mfma_f32_32x32x16_bf16 a[96:111], a[220:223], v[64:67], a[96:111]
  ds_read_b64_tr_b16 a[216:217], v6 offset:6144
  v_max3_f32 v18, v18, v117, v118
  v_max3_f32 v18, v18, v119, v120
  v_max3_f32 v18, v18, v121, v122
  v_mfma_f32_32x32x16_bf16 a[112:127], a[220:223], v[80:83], a[112:127]
  ds_read_b64_tr_b16 a[218:219], v6 offset:9216
  v_max3_f32 v18, v18, v123, v124
  v_max3_f32 v18, v18, v125, v126
  v_max_f32 v18, v18, v127
  v_cmp_lt_f32 vcc, 0x41000000, v18
  s_cbranch_vccz L_ok1_p30
  s_call_b64 s[36:37], L_rare1_1
L_ok1_p30:
  s_waitcnt lgkmcnt(4)
  v_mfma_f32_32x32x16_bf16 a[128:143], a[208:211], v[64:67], a[128:143]
  ds_read_b64_tr_b16 a[220:221], v7 offset:6144
  v_exp_f32 v96, v96
  v_exp_f32 v97, v97
  v_mfma_f32_32x32x16_bf16 a[144:159], a[208:211], v[80:83], a[144:159]
  ds_read_b64_tr_b16 a[222:223], v7 offset:9216
  v_exp_f32 v98, v98
  v_add_f32 v16, v16, v96
  s_waitcnt lgkmcnt(4)
  v_mfma_f32_32x32x16_bf16 a[160:175], a[212:215], v[64:67], a[160:175]
  ds_read_b64_tr_b16 a[208:209], v6 offset:6272
  v_add_f32 v16, v16, v97
  v_cvt_pk_bf16_f32 v96, v96, v97
  v_exp_f32 v99, v99
  v_mfma_f32_32x32x16_bf16 a[176:191], a[212:215], v[80:83], a[176:191]
  ds_read_b64_tr_b16 a[210:211], v6 offset:9344
  v_add_f32 v16, v16, v98
  v_exp_f32 v100, v100
  s_waitcnt lgkmcnt(4)
  v_mfma_f32_32x32x16_bf16 a[0:15], a[216:219], v[72:75], a[0:15]
  ds_read_b64_tr_b16 a[212:213], v7 offset:6272
  v_add_f32 v16, v16, v99
  v_cvt_pk_bf16_f32 v97, v98, v99
  v_exp_f32 v101, v101
  v_mfma_f32_32x32x16_bf16 a[16:31], a[216:219], v[88:91], a[16:31]
  ds_read_b64_tr_b16 a[214:215], v7 offset:9344
  v_add_f32 v16, v16, v100
  v_exp_f32 v102, v102
  s_waitcnt lgkmcnt(4)
  v_mfma_f32_32x32x16_bf16 a[32:47], a[220:223], v[72:75], a[32:47]
  ds_read_b64_tr_b16 a[216:217], v6 offset:6400
  v_add_f32 v16, v16, v101
  v_cvt_pk_bf16_f32 v98, v100, v101
  v_exp_f32 v103, v103
  v_mfma_f32_32x32x16_bf16 a[48:63], a[220:223], v[88:91], a[48:63]
  ds_read_b64_tr_b16 a[218:219], v6 offset:9472
  v_add_f32 v16, v16, v102
  v_add_f32 v16, v16, v103
  v_cvt_pk_bf16_f32 v99, v102, v103
  s_waitcnt lgkmcnt(4)
  v_mfma_f32_32x32x16_bf16 a[64:79], a[208:211], v[72:75], a[64:79]
  ds_read_b64_tr_b16 a[220:221], v7 offset:6400
  v_exp_f32 v112, v112
  v_exp_f32 v113, v113
  v_mfma_f32_32x32x16_bf16 a[80:95], a[208:211], v[88:91], a[80:95]
  ds_read_b64_tr_b16 a[222:223], v7 offset:9472
  v_exp_f32 v114, v114
  v_add_f32 v17, v17, v112
  s_waitcnt lgkmcnt(4)
  v_mfma_f32_32x32x16_bf16 a[96:111], a[212:215], v[72:75], a[96:111]
  v_add_f32 v17, v17, v113
  v_cvt_pk_bf16_f32 v112, v112, v113
  v_exp_f32 v115, v115
  v_mfma_f32_32x32x16_bf16 a[112:127], a[212:215], v[88:91], a[112:127]
  v_add_f32 v17, v17, v114
  v_exp_f32 v116, v116
  s_waitcnt lgkmcnt(2)
  v_mfma_f32_32x32x16_bf16 a[128:143], a[216:219], v[72:75], a[128:143]
  v_add_f32 v17, v17, v115
  v_cvt_pk_bf16_f32 v113, v114, v115
  v_exp_f32 v117, v117
  v_mfma_f32_32x32x16_bf16 a[144:159], a[216:219], v[88:91], a[144:159]
  v_add_f32 v17, v17, v116
  v_exp_f32 v118, v118
  s_waitcnt lgkmcnt(0)
  v_mfma_f32_32x32x16_bf16 a[160:175], a[220:223], v[72:75], a[160:175]
  v_add_f32 v17, v17, v117
  v_cvt_pk_bf16_f32 v114, v116, v117
  v_exp_f32 v119, v119
  v_mfma_f32_32x32x16_bf16 a[176:191], a[220:223], v[88:91], a[176:191]
  v_add_f32 v17, v17, v118
  v_add_f32 v17, v17, v119
  v_cvt_pk_bf16_f32 v115, v118, v119
  s_cmp_eq_u32 s32, 0
  s_cbranch_scc1 L_ok2_p30
  s_call_b64 s[36:37], L_rare2
L_ok2_p30:
  s_waitcnt vmcnt(21)
  s_barrier
  v_exp_f32 v104, v104
  v_exp_f32 v105, v105
  v_exp_f32 v106, v106
  v_add_f32 v16, v16, v104
  v_add_f32 v16, v16, v105
  v_cvt_pk_bf16_f32 v104, v104, v105
  v_exp_f32 v107, v107
  v_add_f32 v16, v16, v106
  v_exp_f32 v108, v108
  v_add_f32 v16, v16, v107
  v_cvt_pk_bf16_f32 v105, v106, v107
  v_exp_f32 v109, v109
  v_add_f32 v16, v16, v108
  v_exp_f32 v110, v110
  v_add_f32 v16, v16, v109
  v_cvt_pk_bf16_f32 v106, v108, v109
  v_exp_f32 v111, v111
  v_add_f32 v16, v16, v110
  v_add_f32 v16, v16, v111
  v_cvt_pk_bf16_f32 v107, v110, v111
  v_exp_f32 v120, v120
  v_exp_f32 v121, v121
  v_exp_f32 v122, v122
  v_add_f32 v17, v17, v120
  v_add_f32 v17, v17, v121
  v_cvt_pk_bf16_f32 v120, v120, v121
  v_exp_f32 v123, v123
  v_add_f32 v17, v17, v122
  v_exp_f32 v124, v124
  ds_read_b64_tr_b16 a[208:209], v6 offset:12288
  v_add_f32 v17, v17, v123
  v_cvt_pk_bf16_f32 v121, v122, v123
  ds_read_b64_tr_b16 a[210:211], v6 offset:15360
  v_exp_f32 v125, v125
  v_add_f32 v17, v17, v124
  ds_read_b64_tr_b16 a[212:213], v7 offset:12288
  v_exp_f32 v126, v126
  ds_read_b64_tr_b16 a[214:215], v7 offset:15360
  v_add_f32 v17, v17, v125
  v_cvt_pk_bf16_f32 v122, v124, v125
  ds_read_b64_tr_b16 a[216:217], v6 offset:12416
  v_exp_f32 v127, v127
  v_add_f32 v17, v17, v126
  ds_read_b64_tr_b16 a[218:219], v6 offset:15488
  v_add_f32 v17, v17, v127
  v_cvt_pk_bf16_f32 v123, v126, v127
  s_waitcnt lgkmcnt(4)
  v_mfma_f32_32x32x16_bf16 a[0:15], a[208:211], v[96:99], a[0:15]
  ds_read_b64_tr_b16 a[220:221], v7 offset:12416
  v_mfma_f32_32x32x16_bf16 a[16:31], a[208:211], v[112:115], a[16:31]
  ds_read_b64_tr_b16 a[222:223], v7 offset:15488
  s_waitcnt lgkmcnt(4)
  v_mfma_f32_32x32x16_bf16 a[32:47], a[212:215], v[96:99], a[32:47]
  ds_read_b64_tr_b16 a[208:209], v6 offset:12544
  v_mfma_f32_32x32x16_bf16 a[48:63], a[212:215], v[112:115], a[48:63]
  ds_read_b64_tr_b16 a[210:211], v6 offset:15616
  s_waitcnt lgkmcnt(4)
  v_mfma_f32_32x32x16_bf16 a[64:79], a[216:219], v[96:99], a[64:79]
  ds_read_b64_tr_b16 a[212:213], v7 offset:12544
  v_mfma_f32_32x32x16_bf16 a[80:95], a[216:219], v[112:115], a[80:95]
  ds_read_b64_tr_b16 a[214:215], v7 offset:15616
  s_waitcnt lgkmcnt(4)
  v_mfma_f32_32x32x16_bf16 a[96:111], a[220:223], v[96:99], a[96:111]
  ds_read_b64_tr_b16 a[216:217], v6 offset:18432
  v_mfma_f32_32x32x16_bf16 a[112:127], a[220:223], v[112:115], a[112:127]
  ds_read_b64_tr_b16 a[218:219], v6 offset:21504
  s_waitcnt lgkmcnt(4)
  v_mfma_f32_32x32x16_bf16 a[128:143], a[208:211], v[96:99], a[128:143]
  ds_read_b64_tr_b16 a[220:221], v7 offset:18432
  v_mfma_f32_32x32x16_bf16 a[144:159], a[208:211], v[112:115], a[144:159]
  ds_read_b64_tr_b16 a[222:223], v7 offset:21504
  s_waitcnt lgkmcnt(4)
  v_mfma_f32_32x32x16_bf16 a[160:175], a[212:215], v[96:99], a[160:175]
  ds_read_b64_tr_b16 a[208:209], v6 offset:18560
  v_mfma_f32_32x32x16_bf16 a[176:191], a[212:215], v[112:115], a[176:191]
  ds_read_b64_tr_b16 a[210:211], v6 offset:21632
  s_waitcnt lgkmcnt(4)
  v_mfma_f32_32x32x16_bf16 a[0:15], a[216:219], v[104:107], a[0:15]
  ds_read_b64_tr_b16 a[212:213], v7 offset:18560
  v_mfma_f32_32x32x16_bf16 a[16:31], a[216:219], v[120:123], a[16:31]
  ds_read_b64_tr_b16 a[214:215], v7 offset:21632
  s_waitcnt lgkmcnt(4)
  v_mfma_f32_32x32x16_bf16 a[32:47], a[220:223], v[104:107], a[32:47]
  ds_read_b64_tr_b16 a[216:217], v6 offset:18688
  v_mfma_f32_32x32x16_bf16 a[48:63], a[220:223], v[120:123], a[48:63]
  ds_read_b64_tr_b16 a[218:219], v6 offset:21760
  s_waitcnt lgkmcnt(4)
  v_mfma_f32_32x32x16_bf16 a[64:79], a[208:211], v[104:107], a[64:79]
  ds_read_b64_tr_b16 a[220:221], v7 offset:18688
  v_mfma_f32_32x32x16_bf16 a[80:95], a[208:211], v[120:123], a[80:95]
  ds_read_b64_tr_b16 a[222:223], v7 offset:21760
  s_waitcnt lgkmcnt(4)
  v_mfma_f32_32x32x16_bf16 a[96:111], a[212:215], v[104:107], a[96:111]
  v_mfma_f32_32x32x16_bf16 a[112:127], a[212:215], v[120:123], a[112:127]
  s_waitcnt lgkmcnt(2)
  v_mfma_f32_32x32x16_bf16 a[128:143], a[216:219], v[104:107], a[128:143]
  v_mfma_f32_32x32x16_bf16 a[144:159], a[216:219], v[120:123], a[144:159]
  s_waitcnt lgkmcnt(0)
  v_mfma_f32_32x32x16_bf16 a[160:175], a[220:223], v[104:107], a[160:175]
  v_mfma_f32_32x32x16_bf16 a[176:191], a[220:223], v[120:123], a[176:191]
  s_nop 15
  v_mov_b32 v21, v16
  s_nop 1
  v_permlane32_swap_b32 v16, v21
  v_add_f32 v16, v16, v21
  v_rcp_f32 v19, v16
  v_mov_b32 v21, v17
  s_nop 1
  v_permlane32_swap_b32 v17, v21
  v_add_f32 v17, v17, v21
  v_rcp_f32 v20, v17
  v_lshlrev_b32 v22, 4, v1
  s_mul_i32 s38, s24, 24576
  v_accvgpr_read_b32 v64, a0
  v_accvgpr_read_b32 v65, a1
  v_accvgpr_read_b32 v66, a2
  v_accvgpr_read_b32 v67, a3
  v_accvgpr_read_b32 v68, a4
  v_accvgpr_read_b32 v69, a5
  v_accvgpr_read_b32 v70, a6
  v_accvgpr_read_b32 v71, a7
  v_mul_f32 v64, v64, v19
  v_mul_f32 v65, v65, v19
  v_mul_f32 v66, v66, v19
  v_mul_f32 v67, v67, v19
  v_mul_f32 v68, v68, v19
  v_mul_f32 v69, v69, v19
  v_mul_f32 v70, v70, v19
  v_mul_f32 v71, v71, v19
  v_cvt_pk_bf16_f32 v72, v64, v65
  v_cvt_pk_bf16_f32 v73, v66, v67
  v_cvt_pk_bf16_f32 v74, v68, v69
  v_cvt_pk_bf16_f32 v75, v70, v71
  s_add_u32 s39, s38, 0
  buffer_store_dwordx4 v[72:75], v22, s[20:23], s39 offen offset:0 sc1
  v_accvgpr_read_b32 v76, a8
  v_accvgpr_read_b32 v77, a9
  v_accvgpr_read_b32 v78, a10
  v_accvgpr_read_b32 v79, a11
  v_accvgpr_read_b32 v80, a12
  v_accvgpr_read_b32 v81, a13
  v_accvgpr_read_b32 v82, a14
  v_accvgpr_read_b32 v83, a15
  v_mul_f32 v76, v76, v19
  v_mul_f32 v77, v77, v19
  v_mul_f32 v78, v78, v19
  v_mul_f32 v79, v79, v19
  v_mul_f32 v80, v80, v19
  v_mul_f32 v81, v81, v19
  v_mul_f32 v82, v82, v19
  v_mul_f32 v83, v83, v19
  v_cvt_pk_bf16_f32 v84, v76, v77
  v_cvt_pk_bf16_f32 v85, v78, v79
  v_cvt_pk_bf16_f32 v86, v80, v81
  v_cvt_pk_bf16_f32 v87, v82, v83
  s_add_u32 s39, s38, 0
  buffer_store_dwordx4 v[84:87], v22, s[20:23], s39 offen offset:1024 sc1
  v_accvgpr_read_b32 v88, a32
  v_accvgpr_read_b32 v89, a33
  v_accvgpr_read_b32 v90, a34
  v_accvgpr_read_b32 v91, a35
  v_accvgpr_read_b32 v92, a36
  v_accvgpr_read_b32 v93, a37
  v_accvgpr_read_b32 v94, a38
  v_accvgpr_read_b32 v95, a39
  v_mul_f32 v88, v88, v19
  v_mul_f32 v89, v89, v19
  v_mul_f32 v90, v90, v19
  v_mul_f32 v91, v91, v19
  v_mul_f32 v92, v92, v19
  v_mul_f32 v93, v93, v19
  v_mul_f32 v94, v94, v19
  v_mul_f32 v95, v95, v19
  v_cvt_pk_bf16_f32 v96, v88, v89
  v_cvt_pk_bf16_f32 v97, v90, v91
  v_cvt_pk_bf16_f32 v98, v92, v93
  v_cvt_pk_bf16_f32 v99, v94, v95
  s_add_u32 s39, s38, 0
  buffer_store_dwordx4 v[96:99], v22, s[20:23], s39 offen offset:2048 sc1
  v_accvgpr_read_b32 v100, a40
  v_accvgpr_read_b32 v101, a41
  v_accvgpr_read_b32 v102, a42
  v_accvgpr_read_b32 v103, a43
  v_accvgpr_read_b32 v104, a44
  v_accvgpr_read_b32 v105, a45
  v_accvgpr_read_b32 v106, a46
  v_accvgpr_read_b32 v107, a47
  v_mul_f32 v100, v100, v19
  v_mul_f32 v101, v101, v19
  v_mul_f32 v102, v102, v19
  v_mul_f32 v103, v103, v19
  v_mul_f32 v104, v104, v19
  v_mul_f32 v105, v105, v19
  v_mul_f32 v106, v106, v19
  v_mul_f32 v107, v107, v19
  v_cvt_pk_bf16_f32 v108, v100, v101
  v_cvt_pk_bf16_f32 v109, v102, v103
  v_cvt_pk_bf16_f32 v110, v104, v105
  v_cvt_pk_bf16_f32 v111, v106, v107
  s_add_u32 s39, s38, 0
  buffer_store_dwordx4 v[108:111], v22, s[20:23], s39 offen offset:3072 sc1
  v_accvgpr_read_b32 v112, a64
  v_accvgpr_read_b32 v113, a65
  v_accvgpr_read_b32 v114, a66
  v_accvgpr_read_b32 v115, a67
  v_accvgpr_read_b32 v116, a68
  v_accvgpr_read_b32 v117, a69
  v_accvgpr_read_b32 v118, a70
  v_accvgpr_read_b32 v119, a71
  v_mul_f32 v112, v112, v19
  v_mul_f32 v113, v113, v19
  v_mul_f32 v114, v114, v19
  v_mul_f32 v115, v115, v19
  v_mul_f32 v116, v116, v19
  v_mul_f32 v117, v117, v19
  v_mul_f32 v118, v118, v19
  v_mul_f32 v119, v119, v19
  v_cvt_pk_bf16_f32 v120, v112, v113
  v_cvt_pk_bf16_f32 v121, v114, v115
  v_cvt_pk_bf16_f32 v122, v116, v117
  v_cvt_pk_bf16_f32 v123, v118, v119
  s_add_u32 s39, s38, 4096
  buffer_store_dwordx4 v[120:123], v22, s[20:23], s39 offen offset:0 sc1
  v_accvgpr_read_b32 v124, a72
  v_accvgpr_read_b32 v125, a73
  v_accvgpr_read_b32 v126, a74
  v_accvgpr_read_b32 v127, a75
  v_accvgpr_read_b32 v128, a76
  v_accvgpr_read_b32 v129, a77
  v_accvgpr_read_b32 v130, a78
  v_accvgpr_read_b32 v131, a79
  v_mul_f32 v124, v124, v19
  v_mul_f32 v125, v125, v19
  v_mul_f32 v126, v126, v19
  v_mul_f32 v127, v127, v19
  v_mul_f32 v128, v128, v19
  v_mul_f32 v129, v129, v19
  v_mul_f32 v130, v130, v19
  v_mul_f32 v131, v131, v19
  v_cvt_pk_bf16_f32 v132, v124, v125
  v_cvt_pk_bf16_f32 v133, v126, v127
  v_cvt_pk_bf16_f32 v134, v128, v129
  v_cvt_pk_bf16_f32 v135, v130, v131
  s_add_u32 s39, s38, 4096
  buffer_store_dwordx4 v[132:135], v22, s[20:23], s39 offen offset:1024 sc1
  v_accvgpr_read_b32 v136, a96
  v_accvgpr_read_b32 v137, a97
  v_accvgpr_read_b32 v138, a98
  v_accvgpr_read_b32 v139, a99
  v_accvgpr_read_b32 v140, a100
  v_accvgpr_read_b32 v141, a101
  v_accvgpr_read_b32 v142, a102
  v_accvgpr_read_b32 v143, a103
  v_mul_f32 v136, v136, v19
  v_mul_f32 v137, v137, v19
  v_mul_f32 v138, v138, v19
  v_mul_f32 v139, v139, v19
  v_mul_f32 v140, v140, v19
  v_mul_f32 v141, v141, v19
  v_mul_f32 v142, v142, v19
  v_mul_f32 v143, v143, v19
  v_cvt_pk_bf16_f32 v144, v136, v137
  v_cvt_pk_bf16_f32 v145, v138, v139
  v_cvt_pk_bf16_f32 v146, v140, v141
  v_cvt_pk_bf16_f32 v147, v142, v143
  s_add_u32 s39, s38, 4096
  buffer_store_dwordx4 v[144:147], v22, s[20:23], s39 offen offset:2048 sc1
  v_accvgpr_read_b32 v148, a104
  v_accvgpr_read_b32 v149, a105
  v_accvgpr_read_b32 v150, a106
  v_accvgpr_read_b32 v151, a107
  v_accvgpr_read_b32 v152, a108
  v_accvgpr_read_b32 v153, a109
  v_accvgpr_read_b32 v154, a110
  v_accvgpr_read_b32 v155, a111
  v_mul_f32 v148, v148, v19
  v_mul_f32 v149, v149, v19
  v_mul_f32 v150, v150, v19
  v_mul_f32 v151, v151, v19
  v_mul_f32 v152, v152, v19
  v_mul_f32 v153, v153, v19
  v_mul_f32 v154, v154, v19
  v_mul_f32 v155, v155, v19
  v_cvt_pk_bf16_f32 v156, v148, v149
  v_cvt_pk_bf16_f32 v157, v150, v151
  v_cvt_pk_bf16_f32 v158, v152, v153
  v_cvt_pk_bf16_f32 v159, v154, v155
  s_add_u32 s39, s38, 4096
  buffer_store_dwordx4 v[156:159], v22, s[20:23], s39 offen offset:3072 sc1
  v_accvgpr_read_b32 v64, a128
  v_accvgpr_read_b32 v65, a129
  v_accvgpr_read_b32 v66, a130
  v_accvgpr_read_b32 v67, a131
  v_accvgpr_read_b32 v68, a132
  v_accvgpr_read_b32 v69, a133
  v_accvgpr_read_b32 v70, a134
  v_accvgpr_read_b32 v71, a135
  v_mul_f32 v64, v64, v19
  v_mul_f32 v65, v65, v19
  v_mul_f32 v66, v66, v19
  v_mul_f32 v67, v67, v19
  v_mul_f32 v68, v68, v19
  v_mul_f32 v69, v69, v19
  v_mul_f32 v70, v70, v19
  v_mul_f32 v71, v71, v19
  v_cvt_pk_bf16_f32 v72, v64, v65
  v_cvt_pk_bf16_f32 v73, v66, v67
  v_cvt_pk_bf16_f32 v74, v68, v69
  v_cvt_pk_bf16_f32 v75, v70, v71
  s_add_u32 s39, s38, 8192
  buffer_store_dwordx4 v[72:75], v22, s[20:23], s39 offen offset:0 sc1
  v_accvgpr_read_b32 v76, a136
  v_accvgpr_read_b32 v77, a137
  v_accvgpr_read_b32 v78, a138
  v_accvgpr_read_b32 v79, a139
  v_accvgpr_read_b32 v80, a140
  v_accvgpr_read_b32 v81, a141
  v_accvgpr_read_b32 v82, a142
  v_accvgpr_read_b32 v83, a143
  v_mul_f32 v76, v76, v19
  v_mul_f32 v77, v77, v19
  v_mul_f32 v78, v78, v19
  v_mul_f32 v79, v79, v19
  v_mul_f32 v80, v80, v19
  v_mul_f32 v81, v81, v19
  v_mul_f32 v82, v82, v19
  v_mul_f32 v83, v83, v19
  v_cvt_pk_bf16_f32 v84, v76, v77
  v_cvt_pk_bf16_f32 v85, v78, v79
  v_cvt_pk_bf16_f32 v86, v80, v81
  v_cvt_pk_bf16_f32 v87, v82, v83
  s_add_u32 s39, s38, 8192
  buffer_store_dwordx4 v[84:87], v22, s[20:23], s39 offen offset:1024 sc1
  v_accvgpr_read_b32 v88, a160
  v_accvgpr_read_b32 v89, a161
  v_accvgpr_read_b32 v90, a162
  v_accvgpr_read_b32 v91, a163
  v_accvgpr_read_b32 v92, a164
  v_accvgpr_read_b32 v93, a165
  v_accvgpr_read_b32 v94, a166
  v_accvgpr_read_b32 v95, a167
  v_mul_f32 v88, v88, v19
  v_mul_f32 v89, v89, v19
  v_mul_f32 v90, v90, v19
  v_mul_f32 v91, v91, v19
  v_mul_f32 v92, v92, v19
  v_mul_f32 v93, v93, v19
  v_mul_f32 v94, v94, v19
  v_mul_f32 v95, v95, v19
  v_cvt_pk_bf16_f32 v96, v88, v89
  v_cvt_pk_bf16_f32 v97, v90, v91
  v_cvt_pk_bf16_f32 v98, v92, v93
  v_cvt_pk_bf16_f32 v99, v94, v95
  s_add_u32 s39, s38, 8192
  buffer_store_dwordx4 v[96:99], v22, s[20:23], s39 offen offset:2048 sc1
  v_accvgpr_read_b32 v100, a168
  v_accvgpr_read_b32 v101, a169
  v_accvgpr_read_b32 v102, a170
  v_accvgpr_read_b32 v103, a171
  v_accvgpr_read_b32 v104, a172
  v_accvgpr_read_b32 v105, a173
  v_accvgpr_read_b32 v106, a174
  v_accvgpr_read_b32 v107, a175
  v_mul_f32 v100, v100, v19
  v_mul_f32 v101, v101, v19
  v_mul_f32 v102, v102, v19
  v_mul_f32 v103, v103, v19
  v_mul_f32 v104, v104, v19
  v_mul_f32 v105, v105, v19
  v_mul_f32 v106, v106, v19
  v_mul_f32 v107, v107, v19
  v_cvt_pk_bf16_f32 v108, v100, v101
  v_cvt_pk_bf16_f32 v109, v102, v103
  v_cvt_pk_bf16_f32 v110, v104, v105
  v_cvt_pk_bf16_f32 v111, v106, v107
  s_add_u32 s39, s38, 8192
  buffer_store_dwordx4 v[108:111], v22, s[20:23], s39 offen offset:3072 sc1
  v_accvgpr_read_b32 v112, a16
  v_accvgpr_read_b32 v113, a17
  v_accvgpr_read_b32 v114, a18
  v_accvgpr_read_b32 v115, a19
  v_accvgpr_read_b32 v116, a20
  v_accvgpr_read_b32 v117, a21
  v_accvgpr_read_b32 v118, a22
  v_accvgpr_read_b32 v119, a23
  v_mul_f32 v112, v112, v20
  v_mul_f32 v113, v113, v20
  v_mul_f32 v114, v114, v20
  v_mul_f32 v115, v115, v20
  v_mul_f32 v116, v116, v20
  v_mul_f32 v117, v117, v20
  v_mul_f32 v118, v118, v20
  v_mul_f32 v119, v119, v20
  v_cvt_pk_bf16_f32 v120, v112, v113
  v_cvt_pk_bf16_f32 v121, v114, v115
  v_cvt_pk_bf16_f32 v122, v116, v117
  v_cvt_pk_bf16_f32 v123, v118, v119
  s_add_u32 s39, s38, 12288
  buffer_store_dwordx4 v[120:123], v22, s[20:23], s39 offen offset:0 sc1
  v_accvgpr_read_b32 v124, a24
  v_accvgpr_read_b32 v125, a25
  v_accvgpr_read_b32 v126, a26
  v_accvgpr_read_b32 v127, a27
  v_accvgpr_read_b32 v128, a28
  v_accvgpr_read_b32 v129, a29
  v_accvgpr_read_b32 v130, a30
  v_accvgpr_read_b32 v131, a31
  v_mul_f32 v124, v124, v20
  v_mul_f32 v125, v125, v20
  v_mul_f32 v126, v126, v20
  v_mul_f32 v127, v127, v20
  v_mul_f32 v128, v128, v20
  v_mul_f32 v129, v129, v20
  v_mul_f32 v130, v130, v20
  v_mul_f32 v131, v131, v20
  v_cvt_pk_bf16_f32 v132, v124, v125
  v_cvt_pk_bf16_f32 v133, v126, v127
  v_cvt_pk_bf16_f32 v134, v128, v129
  v_cvt_pk_bf16_f32 v135, v130, v131
  s_add_u32 s39, s38, 12288
  buffer_store_dwordx4 v[132:135], v22, s[20:23], s39 offen offset:1024 sc1
  v_accvgpr_read_b32 v136, a48
  v_accvgpr_read_b32 v137, a49
  v_accvgpr_read_b32 v138, a50
  v_accvgpr_read_b32 v139, a51
  v_accvgpr_read_b32 v140, a52
  v_accvgpr_read_b32 v141, a53
  v_accvgpr_read_b32 v142, a54
  v_accvgpr_read_b32 v143, a55
  v_mul_f32 v136, v136, v20
  v_mul_f32 v137, v137, v20
  v_mul_f32 v138, v138, v20
  v_mul_f32 v139, v139, v20
  v_mul_f32 v140, v140, v20
  v_mul_f32 v141, v141, v20
  v_mul_f32 v142, v142, v20
  v_mul_f32 v143, v143, v20
  v_cvt_pk_bf16_f32 v144, v136, v137
  v_cvt_pk_bf16_f32 v145, v138, v139
  v_cvt_pk_bf16_f32 v146, v140, v141
  v_cvt_pk_bf16_f32 v147, v142, v143
  s_add_u32 s39, s38, 12288
  buffer_store_dwordx4 v[144:147], v22, s[20:23], s39 offen offset:2048 sc1
  v_accvgpr_read_b32 v148, a56
  v_accvgpr_read_b32 v149, a57
  v_accvgpr_read_b32 v150, a58
  v_accvgpr_read_b32 v151, a59
  v_accvgpr_read_b32 v152, a60
  v_accvgpr_read_b32 v153, a61
  v_accvgpr_read_b32 v154, a62
  v_accvgpr_read_b32 v155, a63
  v_mul_f32 v148, v148, v20
  v_mul_f32 v149, v149, v20
  v_mul_f32 v150, v150, v20
  v_mul_f32 v151, v151, v20
  v_mul_f32 v152, v152, v20
  v_mul_f32 v153, v153, v20
  v_mul_f32 v154, v154, v20
  v_mul_f32 v155, v155, v20
  v_cvt_pk_bf16_f32 v156, v148, v149
  v_cvt_pk_bf16_f32 v157, v150, v151
  v_cvt_pk_bf16_f32 v158, v152, v153
  v_cvt_pk_bf16_f32 v159, v154, v155
  s_add_u32 s39, s38, 12288
  buffer_store_dwordx4 v[156:159], v22, s[20:23], s39 offen offset:3072 sc1
  v_accvgpr_read_b32 v64, a80
  v_accvgpr_read_b32 v65, a81
  v_accvgpr_read_b32 v66, a82
  v_accvgpr_read_b32 v67, a83
  v_accvgpr_read_b32 v68, a84
  v_accvgpr_read_b32 v69, a85
  v_accvgpr_read_b32 v70, a86
  v_accvgpr_read_b32 v71, a87
  v_mul_f32 v64, v64, v20
  v_mul_f32 v65, v65, v20
  v_mul_f32 v66, v66, v20
  v_mul_f32 v67, v67, v20
  v_mul_f32 v68, v68, v20
  v_mul_f32 v69, v69, v20
  v_mul_f32 v70, v70, v20
  v_mul_f32 v71, v71, v20
  v_cvt_pk_bf16_f32 v72, v64, v65
  v_cvt_pk_bf16_f32 v73, v66, v67
  v_cvt_pk_bf16_f32 v74, v68, v69
  v_cvt_pk_bf16_f32 v75, v70, v71
  s_add_u32 s39, s38, 16384
  buffer_store_dwordx4 v[72:75], v22, s[20:23], s39 offen offset:0 sc1
  v_accvgpr_read_b32 v76, a88
  v_accvgpr_read_b32 v77, a89
  v_accvgpr_read_b32 v78, a90
  v_accvgpr_read_b32 v79, a91
  v_accvgpr_read_b32 v80, a92
  v_accvgpr_read_b32 v81, a93
  v_accvgpr_read_b32 v82, a94
  v_accvgpr_read_b32 v83, a95
  v_mul_f32 v76, v76, v20
  v_mul_f32 v77, v77, v20
  v_mul_f32 v78, v78, v20
  v_mul_f32 v79, v79, v20
  v_mul_f32 v80, v80, v20
  v_mul_f32 v81, v81, v20
  v_mul_f32 v82, v82, v20
  v_mul_f32 v83, v83, v20
  v_cvt_pk_bf16_f32 v84, v76, v77
  v_cvt_pk_bf16_f32 v85, v78, v79
  v_cvt_pk_bf16_f32 v86, v80, v81
  v_cvt_pk_bf16_f32 v87, v82, v83
  s_add_u32 s39, s38, 16384
  buffer_store_dwordx4 v[84:87], v22, s[20:23], s39 offen offset:1024 sc1
  v_accvgpr_read_b32 v88, a112
  v_accvgpr_read_b32 v89, a113
  v_accvgpr_read_b32 v90, a114
  v_accvgpr_read_b32 v91, a115
  v_accvgpr_read_b32 v92, a116
  v_accvgpr_read_b32 v93, a117
  v_accvgpr_read_b32 v94, a118
  v_accvgpr_read_b32 v95, a119
  v_mul_f32 v88, v88, v20
  v_mul_f32 v89, v89, v20
  v_mul_f32 v90, v90, v20
  v_mul_f32 v91, v91, v20
  v_mul_f32 v92, v92, v20
  v_mul_f32 v93, v93, v20
  v_mul_f32 v94, v94, v20
  v_mul_f32 v95, v95, v20
  v_cvt_pk_bf16_f32 v96, v88, v89
  v_cvt_pk_bf16_f32 v97, v90, v91
  v_cvt_pk_bf16_f32 v98, v92, v93
  v_cvt_pk_bf16_f32 v99, v94, v95
  s_add_u32 s39, s38, 16384
  buffer_store_dwordx4 v[96:99], v22, s[20:23], s39 offen offset:2048 sc1
  v_accvgpr_read_b32 v100, a120
  v_accvgpr_read_b32 v101, a121
  v_accvgpr_read_b32 v102, a122
  v_accvgpr_read_b32 v103, a123
  v_accvgpr_read_b32 v104, a124
  v_accvgpr_read_b32 v105, a125
  v_accvgpr_read_b32 v106, a126
  v_accvgpr_read_b32 v107, a127
  v_mul_f32 v100, v100, v20
  v_mul_f32 v101, v101, v20
  v_mul_f32 v102, v102, v20
  v_mul_f32 v103, v103, v20
  v_mul_f32 v104, v104, v20
  v_mul_f32 v105, v105, v20
  v_mul_f32 v106, v106, v20
  v_mul_f32 v107, v107, v20
  v_cvt_pk_bf16_f32 v108, v100, v101
  v_cvt_pk_bf16_f32 v109, v102, v103
  v_cvt_pk_bf16_f32 v110, v104, v105
  v_cvt_pk_bf16_f32 v111, v106, v107
  s_add_u32 s39, s38, 16384
  buffer_store_dwordx4 v[108:111], v22, s[20:23], s39 offen offset:3072 sc1
  v_accvgpr_read_b32 v112, a144
  v_accvgpr_read_b32 v113, a145
  v_accvgpr_read_b32 v114, a146
  v_accvgpr_read_b32 v115, a147
  v_accvgpr_read_b32 v116, a148
  v_accvgpr_read_b32 v117, a149
  v_accvgpr_read_b32 v118, a150
  v_accvgpr_read_b32 v119, a151
  v_mul_f32 v112, v112, v20
  v_mul_f32 v113, v113, v20
  v_mul_f32 v114, v114, v20
  v_mul_f32 v115, v115, v20
  v_mul_f32 v116, v116, v20
  v_mul_f32 v117, v117, v20
  v_mul_f32 v118, v118, v20
  v_mul_f32 v119, v119, v20
  v_cvt_pk_bf16_f32 v120, v112, v113
  v_cvt_pk_bf16_f32 v121, v114, v115
  v_cvt_pk_bf16_f32 v122, v116, v117
  v_cvt_pk_bf16_f32 v123, v118, v119
  s_add_u32 s39, s38, 20480
  buffer_store_dwordx4 v[120:123], v22, s[20:23], s39 offen offset:0 sc1
  v_accvgpr_read_b32 v124, a152
  v_accvgpr_read_b32 v125, a153
  v_accvgpr_read_b32 v126, a154
  v_accvgpr_read_b32 v127, a155
  v_accvgpr_read_b32 v128, a156
  v_accvgpr_read_b32 v129, a157
  v_accvgpr_read_b32 v130, a158
  v_accvgpr_read_b32 v131, a159
  v_mul_f32 v124, v124, v20
  v_mul_f32 v125, v125, v20
  v_mul_f32 v126, v126, v20
  v_mul_f32 v127, v127, v20
  v_mul_f32 v128, v128, v20
  v_mul_f32 v129, v129, v20
  v_mul_f32 v130, v130, v20
  v_mul_f32 v131, v131, v20
  v_cvt_pk_bf16_f32 v132, v124, v125
  v_cvt_pk_bf16_f32 v133, v126, v127
  v_cvt_pk_bf16_f32 v134, v128, v129
  v_cvt_pk_bf16_f32 v135, v130, v131
  s_add_u32 s39, s38, 20480
  buffer_store_dwordx4 v[132:135], v22, s[20:23], s39 offen offset:1024 sc1
  v_accvgpr_read_b32 v136, a176
  v_accvgpr_read_b32 v137, a177
  v_accvgpr_read_b32 v138, a178
  v_accvgpr_read_b32 v139, a179
  v_accvgpr_read_b32 v140, a180
  v_accvgpr_read_b32 v141, a181
  v_accvgpr_read_b32 v142, a182
  v_accvgpr_read_b32 v143, a183
  v_mul_f32 v136, v136, v20
  v_mul_f32 v137, v137, v20
  v_mul_f32 v138, v138, v20
  v_mul_f32 v139, v139, v20
  v_mul_f32 v140, v140, v20
  v_mul_f32 v141, v141, v20
  v_mul_f32 v142, v142, v20
  v_mul_f32 v143, v143, v20
  v_cvt_pk_bf16_f32 v144, v136, v137
  v_cvt_pk_bf16_f32 v145, v138, v139
  v_cvt_pk_bf16_f32 v146, v140, v141
  v_cvt_pk_bf16_f32 v147, v142, v143
  s_add_u32 s39, s38, 20480
  buffer_store_dwordx4 v[144:147], v22, s[20:23], s39 offen offset:2048 sc1
  v_accvgpr_read_b32 v148, a184
  v_accvgpr_read_b32 v149, a185
  v_accvgpr_read_b32 v150, a186
  v_accvgpr_read_b32 v151, a187
  v_accvgpr_read_b32 v152, a188
  v_accvgpr_read_b32 v153, a189
  v_accvgpr_read_b32 v154, a190
  v_accvgpr_read_b32 v155, a191
  v_mul_f32 v148, v148, v20
  v_mul_f32 v149, v149, v20
  v_mul_f32 v150, v150, v20
  v_mul_f32 v151, v151, v20
  v_mul_f32 v152, v152, v20
  v_mul_f32 v153, v153, v20
  v_mul_f32 v154, v154, v20
  v_mul_f32 v155, v155, v20
  v_cvt_pk_bf16_f32 v156, v148, v149
  v_cvt_pk_bf16_f32 v157, v150, v151
  v_cvt_pk_bf16_f32 v158, v152, v153
  v_cvt_pk_bf16_f32 v159, v154, v155
  s_add_u32 s39, s38, 20480
  buffer_store_dwordx4 v[156:159], v22, s[20:23], s39 offen offset:3072 sc1
L_k1_end:
  s_endpgm
L_rare1_0:
  s_nop 15
  v_max3_f32 v21, v64, v65, v66
  v_max3_f32 v21, v21, v67, v68
  v_max3_f32 v21, v21, v69, v70
  v_max3_f32 v21, v21, v71, v72
  v_max3_f32 v21, v21, v73, v74
  v_max3_f32 v21, v21, v75, v76
  v_max3_f32 v21, v21, v77, v78
  v_max_f32 v21, v21, v79
  v_mov_b32 v22, v21
  s_nop 1
  v_permlane32_swap_b32 v21, v22
  v_max_f32 v23, v21, v22
  v_max_f32 v23, 0, v23
  v_sub_f32 v64, v64, v23
  v_sub_f32 v65, v65, v23
  v_sub_f32 v66, v66, v23
  v_sub_f32 v67, v67, v23
  v_sub_f32 v68, v68, v23
  v_sub_f32 v69, v69, v23
  v_sub_f32 v70, v70, v23
  v_sub_f32 v71, v71, v23
  v_sub_f32 v72, v72, v23
  v_sub_f32 v73, v73, v23
  v_sub_f32 v74, v74, v23
  v_sub_f32 v75, v75, v23
  v_sub_f32 v76, v76, v23
  v_sub_f32 v77, v77, v23
  v_sub_f32 v78, v78, v23
  v_sub_f32 v79, v79, v23
  v_sub_f32 v32, v32, v23
  v_sub_f32 v33, v33, v23
  v_sub_f32 v34, v34, v23
  v_sub_f32 v35, v35, v23
  v_sub_f32 v36, v36, v23
  v_sub_f32 v37, v37, v23
  v_sub_f32 v38, v38, v23
  v_sub_f32 v39, v39, v23
  v_sub_f32 v40, v40, v23
  v_sub_f32 v41, v41, v23
  v_sub_f32 v42, v42, v23
  v_sub_f32 v43, v43, v23
  v_sub_f32 v44, v44, v23
  v_sub_f32 v45, v45, v23
  v_sub_f32 v46, v46, v23
  v_sub_f32 v47, v47, v23
  v_exp_f32 v19, -v23
  s_nop 0
  v_mul_f32 v16, v16, v19
  v_max3_f32 v21, v80, v81, v82
  v_max3_f32 v21, v21, v83, v84
  v_max3_f32 v21, v21, v85, v86
  v_max3_f32 v21, v21, v87, v88
  v_max3_f32 v21, v21, v89, v90
  v_max3_f32 v21, v21, v91, v92
  v_max3_f32 v21, v21, v93, v94
  v_max_f32 v21, v21, v95
  v_mov_b32 v22, v21
  s_nop 1
  v_permlane32_swap_b32 v21, v22
  v_max_f32 v23, v21, v22
  v_max_f32 v23, 0, v23
  v_sub_f32 v80, v80, v23
  v_sub_f32 v81, v81, v23
  v_sub_f32 v82, v82, v23
  v_sub_f32 v83, v83, v23
  v_sub_f32 v84, v84, v23
  v_sub_f32 v85, v85, v23
  v_sub_f32 v86, v86, v23
  v_sub_f32 v87, v87, v23
  v_sub_f32 v88, v88, v23
  v_sub_f32 v89, v89, v23
  v_sub_f32 v90, v90, v23
  v_sub_f32 v91, v91, v23
  v_sub_f32 v92, v92, v23
  v_sub_f32 v93, v93, v23
  v_sub_f32 v94, v94, v23
  v_sub_f32 v95, v95, v23
  v_sub_f32 v48, v48, v23
  v_sub_f32 v49, v49, v23
  v_sub_f32 v50, v50, v23
  v_sub_f32 v51, v51, v23
  v_sub_f32 v52, v52, v23
  v_sub_f32 v53, v53, v23
  v_sub_f32 v54, v54, v23
  v_sub_f32 v55, v55, v23
  v_sub_f32 v56, v56, v23
  v_sub_f32 v57, v57, v23
  v_sub_f32 v58, v58, v23
  v_sub_f32 v59, v59, v23
  v_sub_f32 v60, v60, v23
  v_sub_f32 v61, v61, v23
  v_sub_f32 v62, v62, v23
  v_sub_f32 v63, v63, v23
  v_exp_f32 v20, -v23
  s_nop 0
  v_mul_f32 v17, v17, v20
  s_mov_b32 s32, 1
  s_nop 3
  s_setpc_b64 s[36:37]
L_rare1_1:
  s_nop 15
  v_max3_f32 v21, v96, v97, v98
  v_max3_f32 v21, v21, v99, v100
  v_max3_f32 v21, v21, v101, v102
  v_max3_f32 v21, v21, v103, v104
  v_max3_f32 v21, v21, v105, v106
  v_max3_f32 v21, v21, v107, v108
  v_max3_f32 v21, v21, v109, v110
  v_max_f32 v21, v21, v111
  v_mov_b32 v22, v21
  s_nop 1
  v_permlane32_swap_b32 v21, v22
  v_max_f32 v23, v21, v22
  v_max_f32 v23, 0, v23
  v_sub_f32 v96, v96, v23
  v_sub_f32 v97, v97, v23
  v_sub_f32 v98, v98, v23
  v_sub_f32 v99, v99, v23
  v_sub_f32 v100, v100, v23
  v_sub_f32 v101, v101, v23
  v_sub_f32 v102, v102, v23
  v_sub_f32 v103, v103, v23
  v_sub_f32 v104, v104, v23
  v_sub_f32 v105, v105, v23
  v_sub_f32 v106, v106, v23
  v_sub_f32 v107, v107, v23
  v_sub_f32 v108, v108, v23
  v_sub_f32 v109, v109, v23
  v_sub_f32 v110, v110, v23
  v_sub_f32 v111, v111, v23
  v_sub_f32 v32, v32, v23
  v_sub_f32 v33, v33, v23
  v_sub_f32 v34, v34, v23
  v_sub_f32 v35, v35, v23
  v_sub_f32 v36, v36, v23
  v_sub_f32 v37, v37, v23
  v_sub_f32 v38, v38, v23
  v_sub_f32 v39, v39, v23
  v_sub_f32 v40, v40, v23
  v_sub_f32 v41, v41, v23
  v_sub_f32 v42, v42, v23
  v_sub_f32 v43, v43, v23
  v_sub_f32 v44, v44, v23
  v_sub_f32 v45, v45, v23
  v_sub_f32 v46, v46, v23
  v_sub_f32 v47, v47, v23
  v_exp_f32 v19, -v23
  s_nop 0
  v_mul_f32 v16, v16, v19
  v_max3_f32 v21, v112, v113, v114
  v_max3_f32 v21, v21, v115, v116
  v_max3_f32 v21, v21, v117, v118
  v_max3_f32 v21, v21, v119, v120
  v_max3_f32 v21, v21, v121, v122
  v_max3_f32 v21, v21, v123, v124
  v_max3_f32 v21, v21, v125, v126
  v_max_f32 v21, v21, v127
  v_mov_b32 v22, v21
  s_nop 1
  v_permlane32_swap_b32 v21, v22
  v_max_f32 v23, v21, v22
  v_max_f32 v23, 0, v23
  v_sub_f32 v112, v112, v23
  v_sub_f32 v113, v113, v23
  v_sub_f32 v114, v114, v23
  v_sub_f32 v115, v115, v23
  v_sub_f32 v116, v116, v23
  v_sub_f32 v117, v117, v23
  v_sub_f32 v118, v118, v23
  v_sub_f32 v119, v119, v23
  v_sub_f32 v120, v120, v23
  v_sub_f32 v121, v121, v23
  v_sub_f32 v122, v122, v23
  v_sub_f32 v123, v123, v23
  v_sub_f32 v124, v124, v23
  v_sub_f32 v125, v125, v23
  v_sub_f32 v126, v126, v23
  v_sub_f32 v127, v127, v23
  v_sub_f32 v48, v48, v23
  v_sub_f32 v49, v49, v23
  v_sub_f32 v50, v50, v23
  v_sub_f32 v51, v51, v23
  v_sub_f32 v52, v52, v23
  v_sub_f32 v53, v53, v23
  v_sub_f32 v54, v54, v23
  v_sub_f32 v55, v55, v23
  v_sub_f32 v56, v56, v23
  v_sub_f32 v57, v57, v23
  v_sub_f32 v58, v58, v23
  v_sub_f32 v59, v59, v23
  v_sub_f32 v60, v60, v23
  v_sub_f32 v61, v61, v23
  v_sub_f32 v62, v62, v23
  v_sub_f32 v63, v63, v23
  v_exp_f32 v20, -v23
  s_nop 0
  v_mul_f32 v17, v17, v20
  s_mov_b32 s32, 1
  s_nop 3
  s_setpc_b64 s[36:37]
L_rare2:
  s_nop 15
  v_accvgpr_read_b32 v21, a0
  v_mul_f32 v21, v21, v19
  v_accvgpr_write_b32 a0, v21
  v_accvgpr_read_b32 v22, a1
  v_mul_f32 v22, v22, v19
  v_accvgpr_write_b32 a1, v22
  v_accvgpr_read_b32 v23, a2
  v_mul_f32 v23, v23, v19
  v_accvgpr_write_b32 a2, v23
  v_accvgpr_read_b32 v24, a3
  v_mul_f32 v24, v24, v19
  v_accvgpr_write_b32 a3, v24
  v_accvgpr_read_b32 v21, a4
  v_mul_f32 v21, v21, v19
  v_accvgpr_write_b32 a4, v21
  v_accvgpr_read_b32 v22, a5
  v_mul_f32 v22, v22, v19
  v_accvgpr_write_b32 a5, v22
  v_accvgpr_read_b32 v23, a6
  v_mul_f32 v23, v23, v19
  v_accvgpr_write_b32 a6, v23
  v_accvgpr_read_b32 v24, a7
  v_mul_f32 v24, v24, v19
  v_accvgpr_write_b32 a7, v24
  v_accvgpr_read_b32 v21, a8
  v_mul_f32 v21, v21, v19
  v_accvgpr_write_b32 a8, v21
  v_accvgpr_read_b32 v22, a9
  v_mul_f32 v22, v22, v19
  v_accvgpr_write_b32 a9, v22
  v_accvgpr_read_b32 v23, a10
  v_mul_f32 v23, v23, v19
  v_accvgpr_write_b32 a10, v23
  v_accvgpr_read_b32 v24, a11
  v_mul_f32 v24, v24, v19
  v_accvgpr_write_b32 a11, v24
  v_accvgpr_read_b32 v21, a12
  v_mul_f32 v21, v21, v19
  v_accvgpr_write_b32 a12, v21
  v_accvgpr_read_b32 v22, a13
  v_mul_f32 v22, v22, v19
  v_accvgpr_write_b32 a13, v22
  v_accvgpr_read_b32 v23, a14
  v_mul_f32 v23, v23, v19
  v_accvgpr_write_b32 a14, v23
  v_accvgpr_read_b32 v24, a15
  v_mul_f32 v24, v24, v19
  v_accvgpr_write_b32 a15, v24
  v_accvgpr_read_b32 v21, a16
  v_mul_f32 v21, v21, v20
  v_accvgpr_write_b32 a16, v21
  v_accvgpr_read_b32 v22, a17
  v_mul_f32 v22, v22, v20
  v_accvgpr_write_b32 a17, v22
  v_accvgpr_read_b32 v23, a18
  v_mul_f32 v23, v23, v20
  v_accvgpr_write_b32 a18, v23
  v_accvgpr_read_b32 v24, a19
  v_mul_f32 v24, v24, v20
  v_accvgpr_write_b32 a19, v24
  v_accvgpr_read_b32 v21, a20
  v_mul_f32 v21, v21, v20
  v_accvgpr_write_b32 a20, v21
  v_accvgpr_read_b32 v22, a21
  v_mul_f32 v22, v22, v20
  v_accvgpr_write_b32 a21, v22
  v_accvgpr_read_b32 v23, a22
  v_mul_f32 v23, v23, v20
  v_accvgpr_write_b32 a22, v23
  v_accvgpr_read_b32 v24, a23
  v_mul_f32 v24, v24, v20
  v_accvgpr_write_b32 a23, v24
  v_accvgpr_read_b32 v21, a24
  v_mul_f32 v21, v21, v20
  v_accvgpr_write_b32 a24, v21
  v_accvgpr_read_b32 v22, a25
  v_mul_f32 v22, v22, v20
  v_accvgpr_write_b32 a25, v22
  v_accvgpr_read_b32 v23, a26
  v_mul_f32 v23, v23, v20
  v_accvgpr_write_b32 a26, v23
  v_accvgpr_read_b32 v24, a27
  v_mul_f32 v24, v24, v20
  v_accvgpr_write_b32 a27, v24
  v_accvgpr_read_b32 v21, a28
  v_mul_f32 v21, v21, v20
  v_accvgpr_write_b32 a28, v21
  v_accvgpr_read_b32 v22, a29
  v_mul_f32 v22, v22, v20
  v_accvgpr_write_b32 a29, v22
  v_accvgpr_read_b32 v23, a30
  v_mul_f32 v23, v23, v20
  v_accvgpr_write_b32 a30, v23
  v_accvgpr_read_b32 v24, a31
  v_mul_f32 v24, v24, v20
  v_accvgpr_write_b32 a31, v24
  v_accvgpr_read_b32 v21, a32
  v_mul_f32 v21, v21, v19
  v_accvgpr_write_b32 a32, v21
  v_accvgpr_read_b32 v22, a33
  v_mul_f32 v22, v22, v19
  v_accvgpr_write_b32 a33, v22
  v_accvgpr_read_b32 v23, a34
  v_mul_f32 v23, v23, v19
  v_accvgpr_write_b32 a34, v23
  v_accvgpr_read_b32 v24, a35
  v_mul_f32 v24, v24, v19
  v_accvgpr_write_b32 a35, v24
  v_accvgpr_read_b32 v21, a36
  v_mul_f32 v21, v21, v19
  v_accvgpr_write_b32 a36, v21
  v_accvgpr_read_b32 v22, a37
  v_mul_f32 v22, v22, v19
  v_accvgpr_write_b32 a37, v22
  v_accvgpr_read_b32 v23, a38
  v_mul_f32 v23, v23, v19
  v_accvgpr_write_b32 a38, v23
  v_accvgpr_read_b32 v24, a39
  v_mul_f32 v24, v24, v19
  v_accvgpr_write_b32 a39, v24
  v_accvgpr_read_b32 v21, a40
  v_mul_f32 v21, v21, v19
  v_accvgpr_write_b32 a40, v21
  v_accvgpr_read_b32 v22, a41
  v_mul_f32 v22, v22, v19
  v_accvgpr_write_b32 a41, v22
  v_accvgpr_read_b32 v23, a42
  v_mul_f32 v23, v23, v19
  v_accvgpr_write_b32 a42, v23
  v_accvgpr_read_b32 v24, a43
  v_mul_f32 v24, v24, v19
  v_accvgpr_write_b32 a43, v24
  v_accvgpr_read_b32 v21, a44
  v_mul_f32 v21, v21, v19
  v_accvgpr_write_b32 a44, v21
  v_accvgpr_read_b32 v22, a45
  v_mul_f32 v22, v22, v19
  v_accvgpr_write_b32 a45, v22
  v_accvgpr_read_b32 v23, a46
  v_mul_f32 v23, v23, v19
  v_accvgpr_write_b32 a46, v23
  v_accvgpr_read_b32 v24, a47
  v_mul_f32 v24, v24, v19
  v_accvgpr_write_b32 a47, v24
  v_accvgpr_read_b32 v21, a48
  v_mul_f32 v21, v21, v20
  v_accvgpr_write_b32 a48, v21
  v_accvgpr_read_b32 v22, a49
  v_mul_f32 v22, v22, v20
  v_accvgpr_write_b32 a49, v22
  v_accvgpr_read_b32 v23, a50
  v_mul_f32 v23, v23, v20
  v_accvgpr_write_b32 a50, v23
  v_accvgpr_read_b32 v24, a51
  v_mul_f32 v24, v24, v20
  v_accvgpr_write_b32 a51, v24
  v_accvgpr_read_b32 v21, a52
  v_mul_f32 v21, v21, v20
  v_accvgpr_write_b32 a52, v21
  v_accvgpr_read_b32 v22, a53
  v_mul_f32 v22, v22, v20
  v_accvgpr_write_b32 a53, v22
  v_accvgpr_read_b32 v23, a54
  v_mul_f32 v23, v23, v20
  v_accvgpr_write_b32 a54, v23
  v_accvgpr_read_b32 v24, a55
  v_mul_f32 v24, v24, v20
  v_accvgpr_write_b32 a55, v24
  v_accvgpr_read_b32 v21, a56
  v_mul_f32 v21, v21, v20
  v_accvgpr_write_b32 a56, v21
  v_accvgpr_read_b32 v22, a57
  v_mul_f32 v22, v22, v20
  v_accvgpr_write_b32 a57, v22
  v_accvgpr_read_b32 v23, a58
  v_mul_f32 v23, v23, v20
  v_accvgpr_write_b32 a58, v23
  v_accvgpr_read_b32 v24, a59
  v_mul_f32 v24, v24, v20
  v_accvgpr_write_b32 a59, v24
  v_accvgpr_read_b32 v21, a60
  v_mul_f32 v21, v21, v20
  v_accvgpr_write_b32 a60, v21
  v_accvgpr_read_b32 v22, a61
  v_mul_f32 v22, v22, v20
  v_accvgpr_write_b32 a61, v22
  v_accvgpr_read_b32 v23, a62
  v_mul_f32 v23, v23, v20
  v_accvgpr_write_b32 a62, v23
  v_accvgpr_read_b32 v24, a63
  v_mul_f32 v24, v24, v20
  v_accvgpr_write_b32 a63, v24
  v_accvgpr_read_b32 v21, a64
  v_mul_f32 v21, v21, v19
  v_accvgpr_write_b32 a64, v21
  v_accvgpr_read_b32 v22, a65
  v_mul_f32 v22, v22, v19
  v_accvgpr_write_b32 a65, v22
  v_accvgpr_read_b32 v23, a66
  v_mul_f32 v23, v23, v19
  v_accvgpr_write_b32 a66, v23
  v_accvgpr_read_b32 v24, a67
  v_mul_f32 v24, v24, v19
  v_accvgpr_write_b32 a67, v24
  v_accvgpr_read_b32 v21, a68
  v_mul_f32 v21, v21, v19
  v_accvgpr_write_b32 a68, v21
  v_accvgpr_read_b32 v22, a69
  v_mul_f32 v22, v22, v19
  v_accvgpr_write_b32 a69, v22
  v_accvgpr_read_b32 v23, a70
  v_mul_f32 v23, v23, v19
  v_accvgpr_write_b32 a70, v23
  v_accvgpr_read_b32 v24, a71
  v_mul_f32 v24, v24, v19
  v_accvgpr_write_b32 a71, v24
  v_accvgpr_read_b32 v21, a72
  v_mul_f32 v21, v21, v19
  v_accvgpr_write_b32 a72, v21
  v_accvgpr_read_b32 v22, a73
  v_mul_f32 v22, v22, v19
  v_accvgpr_write_b32 a73, v22
  v_accvgpr_read_b32 v23, a74
  v_mul_f32 v23, v23, v19
  v_accvgpr_write_b32 a74, v23
  v_accvgpr_read_b32 v24, a75
  v_mul_f32 v24, v24, v19
  v_accvgpr_write_b32 a75, v24
  v_accvgpr_read_b32 v21, a76
  v_mul_f32 v21, v21, v19
  v_accvgpr_write_b32 a76, v21
  v_accvgpr_read_b32 v22, a77
  v_mul_f32 v22, v22, v19
  v_accvgpr_write_b32 a77, v22
  v_accvgpr_read_b32 v23, a78
  v_mul_f32 v23, v23, v19
  v_accvgpr_write_b32 a78, v23
  v_accvgpr_read_b32 v24, a79
  v_mul_f32 v24, v24, v19
  v_accvgpr_write_b32 a79, v24
  v_accvgpr_read_b32 v21, a80
  v_mul_f32 v21, v21, v20
  v_accvgpr_write_b32 a80, v21
  v_accvgpr_read_b32 v22, a81
  v_mul_f32 v22, v22, v20
  v_accvgpr_write_b32 a81, v22
  v_accvgpr_read_b32 v23, a82
  v_mul_f32 v23, v23, v20
  v_accvgpr_write_b32 a82, v23
  v_accvgpr_read_b32 v24, a83
  v_mul_f32 v24, v24, v20
  v_accvgpr_write_b32 a83, v24
  v_accvgpr_read_b32 v21, a84
  v_mul_f32 v21, v21, v20
  v_accvgpr_write_b32 a84, v21
  v_accvgpr_read_b32 v22, a85
  v_mul_f32 v22, v22, v20
  v_accvgpr_write_b32 a85, v22
  v_accvgpr_read_b32 v23, a86
  v_mul_f32 v23, v23, v20
  v_accvgpr_write_b32 a86, v23
  v_accvgpr_read_b32 v24, a87
  v_mul_f32 v24, v24, v20
  v_accvgpr_write_b32 a87, v24
  v_accvgpr_read_b32 v21, a88
  v_mul_f32 v21, v21, v20
  v_accvgpr_write_b32 a88, v21
  v_accvgpr_read_b32 v22, a89
  v_mul_f32 v22, v22, v20
  v_accvgpr_write_b32 a89, v22
  v_accvgpr_read_b32 v23, a90
  v_mul_f32 v23, v23, v20
  v_accvgpr_write_b32 a90, v23
  v_accvgpr_read_b32 v24, a91
  v_mul_f32 v24, v24, v20
  v_accvgpr_write_b32 a91, v24
  v_accvgpr_read_b32 v21, a92
  v_mul_f32 v21, v21, v20
  v_accvgpr_write_b32 a92, v21
  v_accvgpr_read_b32 v22, a93
  v_mul_f32 v22, v22, v20
  v_accvgpr_write_b32 a93, v22
  v_accvgpr_read_b32 v23, a94
  v_mul_f32 v23, v23, v20
  v_accvgpr_write_b32 a94, v23
  v_accvgpr_read_b32 v24, a95
  v_mul_f32 v24, v24, v20
  v_accvgpr_write_b32 a95, v24
  v_accvgpr_read_b32 v21, a96
  v_mul_f32 v21, v21, v19
  v_accvgpr_write_b32 a96, v21
  v_accvgpr_read_b32 v22, a97
  v_mul_f32 v22, v22, v19
  v_accvgpr_write_b32 a97, v22
  v_accvgpr_read_b32 v23, a98
  v_mul_f32 v23, v23, v19
  v_accvgpr_write_b32 a98, v23
  v_accvgpr_read_b32 v24, a99
  v_mul_f32 v24, v24, v19
  v_accvgpr_write_b32 a99, v24
  v_accvgpr_read_b32 v21, a100
  v_mul_f32 v21, v21, v19
  v_accvgpr_write_b32 a100, v21
  v_accvgpr_read_b32 v22, a101
  v_mul_f32 v22, v22, v19
  v_accvgpr_write_b32 a101, v22
  v_accvgpr_read_b32 v23, a102
  v_mul_f32 v23, v23, v19
  v_accvgpr_write_b32 a102, v23
  v_accvgpr_read_b32 v24, a103
  v_mul_f32 v24, v24, v19
  v_accvgpr_write_b32 a103, v24
  v_accvgpr_read_b32 v21, a104
  v_mul_f32 v21, v21, v19
  v_accvgpr_write_b32 a104, v21
  v_accvgpr_read_b32 v22, a105
  v_mul_f32 v22, v22, v19
  v_accvgpr_write_b32 a105, v22
  v_accvgpr_read_b32 v23, a106
  v_mul_f32 v23, v23, v19
  v_accvgpr_write_b32 a106, v23
  v_accvgpr_read_b32 v24, a107
  v_mul_f32 v24, v24, v19
  v_accvgpr_write_b32 a107, v24
  v_accvgpr_read_b32 v21, a108
  v_mul_f32 v21, v21, v19
  v_accvgpr_write_b32 a108, v21
  v_accvgpr_read_b32 v22, a109
  v_mul_f32 v22, v22, v19
  v_accvgpr_write_b32 a109, v22
  v_accvgpr_read_b32 v23, a110
  v_mul_f32 v23, v23, v19
  v_accvgpr_write_b32 a110, v23
  v_accvgpr_read_b32 v24, a111
  v_mul_f32 v24, v24, v19
  v_accvgpr_write_b32 a111, v24
  v_accvgpr_read_b32 v21, a112
  v_mul_f32 v21, v21, v20
  v_accvgpr_write_b32 a112, v21
  v_accvgpr_read_b32 v22, a113
  v_mul_f32 v22, v22, v20
  v_accvgpr_write_b32 a113, v22
  v_accvgpr_read_b32 v23, a114
  v_mul_f32 v23, v23, v20
  v_accvgpr_write_b32 a114, v23
  v_accvgpr_read_b32 v24, a115
  v_mul_f32 v24, v24, v20
  v_accvgpr_write_b32 a115, v24
  v_accvgpr_read_b32 v21, a116
  v_mul_f32 v21, v21, v20
  v_accvgpr_write_b32 a116, v21
  v_accvgpr_read_b32 v22, a117
  v_mul_f32 v22, v22, v20
  v_accvgpr_write_b32 a117, v22
  v_accvgpr_read_b32 v23, a118
  v_mul_f32 v23, v23, v20
  v_accvgpr_write_b32 a118, v23
  v_accvgpr_read_b32 v24, a119
  v_mul_f32 v24, v24, v20
  v_accvgpr_write_b32 a119, v24
  v_accvgpr_read_b32 v21, a120
  v_mul_f32 v21, v21, v20
  v_accvgpr_write_b32 a120, v21
  v_accvgpr_read_b32 v22, a121
  v_mul_f32 v22, v22, v20
  v_accvgpr_write_b32 a121, v22
  v_accvgpr_read_b32 v23, a122
  v_mul_f32 v23, v23, v20
  v_accvgpr_write_b32 a122, v23
  v_accvgpr_read_b32 v24, a123
  v_mul_f32 v24, v24, v20
  v_accvgpr_write_b32 a123, v24
  v_accvgpr_read_b32 v21, a124
  v_mul_f32 v21, v21, v20
  v_accvgpr_write_b32 a124, v21
  v_accvgpr_read_b32 v22, a125
  v_mul_f32 v22, v22, v20
  v_accvgpr_write_b32 a125, v22
  v_accvgpr_read_b32 v23, a126
  v_mul_f32 v23, v23, v20
  v_accvgpr_write_b32 a126, v23
  v_accvgpr_read_b32 v24, a127
  v_mul_f32 v24, v24, v20
  v_accvgpr_write_b32 a127, v24
  v_accvgpr_read_b32 v21, a128
  v_mul_f32 v21, v21, v19
  v_accvgpr_write_b32 a128, v21
  v_accvgpr_read_b32 v22, a129
  v_mul_f32 v22, v22, v19
  v_accvgpr_write_b32 a129, v22
  v_accvgpr_read_b32 v23, a130
  v_mul_f32 v23, v23, v19
  v_accvgpr_write_b32 a130, v23
  v_accvgpr_read_b32 v24, a131
  v_mul_f32 v24, v24, v19
  v_accvgpr_write_b32 a131, v24
  v_accvgpr_read_b32 v21, a132
  v_mul_f32 v21, v21, v19
  v_accvgpr_write_b32 a132, v21
  v_accvgpr_read_b32 v22, a133
  v_mul_f32 v22, v22, v19
  v_accvgpr_write_b32 a133, v22
  v_accvgpr_read_b32 v23, a134
  v_mul_f32 v23, v23, v19
  v_accvgpr_write_b32 a134, v23
  v_accvgpr_read_b32 v24, a135
  v_mul_f32 v24, v24, v19
  v_accvgpr_write_b32 a135, v24
  v_accvgpr_read_b32 v21, a136
  v_mul_f32 v21, v21, v19
  v_accvgpr_write_b32 a136, v21
  v_accvgpr_read_b32 v22, a137
  v_mul_f32 v22, v22, v19
  v_accvgpr_write_b32 a137, v22
  v_accvgpr_read_b32 v23, a138
  v_mul_f32 v23, v23, v19
  v_accvgpr_write_b32 a138, v23
  v_accvgpr_read_b32 v24, a139
  v_mul_f32 v24, v24, v19
  v_accvgpr_write_b32 a139, v24
  v_accvgpr_read_b32 v21, a140
  v_mul_f32 v21, v21, v19
  v_accvgpr_write_b32 a140, v21
  v_accvgpr_read_b32 v22, a141
  v_mul_f32 v22, v22, v19
  v_accvgpr_write_b32 a141, v22
  v_accvgpr_read_b32 v23, a142
  v_mul_f32 v23, v23, v19
  v_accvgpr_write_b32 a142, v23
  v_accvgpr_read_b32 v24, a143
  v_mul_f32 v24, v24, v19
  v_accvgpr_write_b32 a143, v24
  v_accvgpr_read_b32 v21, a144
  v_mul_f32 v21, v21, v20
  v_accvgpr_write_b32 a144, v21
  v_accvgpr_read_b32 v22, a145
  v_mul_f32 v22, v22, v20
  v_accvgpr_write_b32 a145, v22
  v_accvgpr_read_b32 v23, a146
  v_mul_f32 v23, v23, v20
  v_accvgpr_write_b32 a146, v23
  v_accvgpr_read_b32 v24, a147
  v_mul_f32 v24, v24, v20
  v_accvgpr_write_b32 a147, v24
  v_accvgpr_read_b32 v21, a148
  v_mul_f32 v21, v21, v20
  v_accvgpr_write_b32 a148, v21
  v_accvgpr_read_b32 v22, a149
  v_mul_f32 v22, v22, v20
  v_accvgpr_write_b32 a149, v22
  v_accvgpr_read_b32 v23, a150
  v_mul_f32 v23, v23, v20
  v_accvgpr_write_b32 a150, v23
  v_accvgpr_read_b32 v24, a151
  v_mul_f32 v24, v24, v20
  v_accvgpr_write_b32 a151, v24
  v_accvgpr_read_b32 v21, a152
  v_mul_f32 v21, v21, v20
  v_accvgpr_write_b32 a152, v21
  v_accvgpr_read_b32 v22, a153
  v_mul_f32 v22, v22, v20
  v_accvgpr_write_b32 a153, v22
  v_accvgpr_read_b32 v23, a154
  v_mul_f32 v23, v23, v20
  v_accvgpr_write_b32 a154, v23
  v_accvgpr_read_b32 v24, a155
  v_mul_f32 v24, v24, v20
  v_accvgpr_write_b32 a155, v24
  v_accvgpr_read_b32 v21, a156
  v_mul_f32 v21, v21, v20
  v_accvgpr_write_b32 a156, v21
  v_accvgpr_read_b32 v22, a157
  v_mul_f32 v22, v22, v20
  v_accvgpr_write_b32 a157, v22
  v_accvgpr_read_b32 v23, a158
  v_mul_f32 v23, v23, v20
  v_accvgpr_write_b32 a158, v23
  v_accvgpr_read_b32 v24, a159
  v_mul_f32 v24, v24, v20
  v_accvgpr_write_b32 a159, v24
  v_accvgpr_read_b32 v21, a160
  v_mul_f32 v21, v21, v19
  v_accvgpr_write_b32 a160, v21
  v_accvgpr_read_b32 v22, a161
  v_mul_f32 v22, v22, v19
  v_accvgpr_write_b32 a161, v22
  v_accvgpr_read_b32 v23, a162
  v_mul_f32 v23, v23, v19
  v_accvgpr_write_b32 a162, v23
  v_accvgpr_read_b32 v24, a163
  v_mul_f32 v24, v24, v19
  v_accvgpr_write_b32 a163, v24
  v_accvgpr_read_b32 v21, a164
  v_mul_f32 v21, v21, v19
  v_accvgpr_write_b32 a164, v21
  v_accvgpr_read_b32 v22, a165
  v_mul_f32 v22, v22, v19
  v_accvgpr_write_b32 a165, v22
  v_accvgpr_read_b32 v23, a166
  v_mul_f32 v23, v23, v19
  v_accvgpr_write_b32 a166, v23
  v_accvgpr_read_b32 v24, a167
  v_mul_f32 v24, v24, v19
  v_accvgpr_write_b32 a167, v24
  v_accvgpr_read_b32 v21, a168
  v_mul_f32 v21, v21, v19
  v_accvgpr_write_b32 a168, v21
  v_accvgpr_read_b32 v22, a169
  v_mul_f32 v22, v22, v19
  v_accvgpr_write_b32 a169, v22
  v_accvgpr_read_b32 v23, a170
  v_mul_f32 v23, v23, v19
  v_accvgpr_write_b32 a170, v23
  v_accvgpr_read_b32 v24, a171
  v_mul_f32 v24, v24, v19
  v_accvgpr_write_b32 a171, v24
  v_accvgpr_read_b32 v21, a172
  v_mul_f32 v21, v21, v19
  v_accvgpr_write_b32 a172, v21
  v_accvgpr_read_b32 v22, a173
  v_mul_f32 v22, v22, v19
  v_accvgpr_write_b32 a173, v22
  v_accvgpr_read_b32 v23, a174
  v_mul_f32 v23, v23, v19
  v_accvgpr_write_b32 a174, v23
  v_accvgpr_read_b32 v24, a175
  v_mul_f32 v24, v24, v19
  v_accvgpr_write_b32 a175, v24
  v_accvgpr_read_b32 v21, a176
  v_mul_f32 v21, v21, v20
  v_accvgpr_write_b32 a176, v21
  v_accvgpr_read_b32 v22, a177
  v_mul_f32 v22, v22, v20
  v_accvgpr_write_b32 a177, v22
  v_accvgpr_read_b32 v23, a178
  v_mul_f32 v23, v23, v20
  v_accvgpr_write_b32 a178, v23
  v_accvgpr_read_b32 v24, a179
  v_mul_f32 v24, v24, v20
  v_accvgpr_write_b32 a179, v24
  v_accvgpr_read_b32 v21, a180
  v_mul_f32 v21, v21, v20
  v_accvgpr_write_b32 a180, v21
  v_accvgpr_read_b32 v22, a181
  v_mul_f32 v22, v22, v20
  v_accvgpr_write_b32 a181, v22
  v_accvgpr_read_b32 v23, a182
  v_mul_f32 v23, v23, v20
  v_accvgpr_write_b32 a182, v23
  v_accvgpr_read_b32 v24, a183
  v_mul_f32 v24, v24, v20
  v_accvgpr_write_b32 a183, v24
  v_accvgpr_read_b32 v21, a184
  v_mul_f32 v21, v21, v20
  v_accvgpr_write_b32 a184, v21
  v_accvgpr_read_b32 v22, a185
  v_mul_f32 v22, v22, v20
  v_accvgpr_write_b32 a185, v22
  v_accvgpr_read_b32 v23, a186
  v_mul_f32 v23, v23, v20
  v_accvgpr_write_b32 a186, v23
  v_accvgpr_read_b32 v24, a187
  v_mul_f32 v24, v24, v20
  v_accvgpr_write_b32 a187, v24
  v_accvgpr_read_b32 v21, a188
  v_mul_f32 v21, v21, v20
  v_accvgpr_write_b32 a188, v21
  v_accvgpr_read_b32 v22, a189
  v_mul_f32 v22, v22, v20
  v_accvgpr_write_b32 a189, v22
  v_accvgpr_read_b32 v23, a190
  v_mul_f32 v23, v23, v20
  v_accvgpr_write_b32 a190, v23
  v_accvgpr_read_b32 v24, a191
  v_mul_f32 v24, v24, v20
  v_accvgpr_write_b32 a191, v24
  s_mov_b32 s32, 0
  s_nop 3
  s_setpc_b64 s[36:37]
.p2align 8
.type oproj_kernel,@function
oproj_kernel:
  s_cmp_ge_u32 s2, 256
  s_cbranch_scc1 L_k2_end
  s_load_dwordx2 s[40:41], s[0:1], 32
  s_load_dwordx2 s[42:43], s[0:1], 56
  v_and_b32 v1, 63, v0
  v_lshrrev_b32 v2, 6, v0
  s_nop 0
  v_readfirstlane_b32 s24, v2
  s_and_b32 s29, s2, 7
  s_lshr_b32 s37, s2, 3
  s_lshr_b32 s27, s37, 2
  s_and_b32 s28, s37, 3
  s_mul_i32 s31, s29, 983040
  s_lshl_b32 s37, s27, 5
  s_lshl_b32 s38, s29, 2
  s_add_u32 s37, s37, s38
  s_lshl_b32 s37, s37, 3
  s_lshl_b32 s38, s24, 1
  s_add_u32 s37, s37, s38
  s_mul_i32 s30, s37, 12288
  s_mul_i32 s32, s24, 5120
  s_mul_i32 s44, s28, 1
  s_mul_i32 s45, s27, 3
  s_add_u32 s45, s45, 1
  s_lshr_b32 s45, s45, 1
  s_add_u32 s44, s44, s45
  s_sub_u32 s45, s44, 12
  s_cmp_ge_u32 s44, 12
  s_cselect_b32 s44, s45, s44
  s_mov_b32 s45, s44
  v_mov_b32 v64, s24
  v_mul_u32_u24 v64, 320, v64
  v_add_u32 v64, v64, v1
  v_add_u32 v64, 0, v64
  v_mul_u32_u24 v65, 3277, v64
  v_lshrrev_b32 v65, 16, v65
  v_mul_u32_u24 v66, 20, v65
  v_sub_u32 v66, v64, v66
  v_mul_u32_u24 v65, 1280, v65
  v_lshlrev_b32 v66, 4, v66
  v_add_u32 v65, v65, v66
  v_subrev_u32 v2, 0, v65
  v_mov_b32 v64, s24
  v_mul_u32_u24 v64, 320, v64
  v_add_u32 v64, v64, v1
  v_add_u32 v64, 64, v64
  v_mul_u32_u24 v65, 3277, v64
  v_lshrrev_b32 v65, 16, v65
  v_mul_u32_u24 v66, 20, v65
  v_sub_u32 v66, v64, v66
  v_mul_u32_u24 v65, 1280, v65
  v_lshlrev_b32 v66, 4, v66
  v_add_u32 v65, v65, v66
  v_subrev_u32 v3, 1024, v65
  v_mov_b32 v64, s24
  v_mul_u32_u24 v64, 320, v64
  v_add_u32 v64, v64, v1
  v_add_u32 v64, 128, v64
  v_mul_u32_u24 v65, 3277, v64
  v_lshrrev_b32 v65, 16, v65
  v_mul_u32_u24 v66, 20, v65
  v_sub_u32 v66, v64, v66
  v_mul_u32_u24 v65, 1280, v65
  v_lshlrev_b32 v66, 4, v66
  v_add_u32 v65, v65, v66
  v_subrev_u32 v4, 2048, v65
  v_mov_b32 v64, s24
  v_mul_u32_u24 v64, 320, v64
  v_add_u32 v64, v64, v1
  v_add_u32 v64, 192, v64
  v_mul_u32_u24 v65, 3277, v64
  v_lshrrev_b32 v65, 16, v65
  v_mul_u32_u24 v66, 20, v65
  v_sub_u32 v66, v64, v66
  v_mul_u32_u24 v65, 1280, v65
  v_lshlrev_b32 v66, 4, v66
  v_add_u32 v65, v65, v66
  v_subrev_u32 v5, 3072, v65
  v_mov_b32 v64, s24
  v_mul_u32_u24 v64, 320, v64
  v_add_u32 v64, v64, v1
  v_add_u32 v64, 256, v64
  v_mul_u32_u24 v65, 3277, v64
  v_lshrrev_b32 v65, 16, v65
  v_mul_u32_u24 v66, 20, v65
  v_sub_u32 v66, v64, v66
  v_mul_u32_u24 v65, 1280, v65
  v_lshlrev_b32 v66, 4, v66
  v_add_u32 v65, v65, v66
  v_subrev_u32 v6, 0, v65
  v_lshlrev_b32 v12, 4, v1
  v_add_u32 v13, 12288, v12
  s_waitcnt lgkmcnt(0)
  s_mul_i32 s36, s28, 320
  s_add_u32 s40, s40, s36
  s_addc_u32 s41, s41, 0
  s_mov_b32 s8, s40
  s_and_b32 s9, s41, 0xffff
  s_mov_b32 s10, 0
  s_mov_b32 s11, 0x20000
  s_sub_u32 s10, 7864320, s36
  s_mov_b32 s4, s42
  s_and_b32 s5, s43, 0xffff
  s_mov_b32 s6, 25165824
  s_mov_b32 s7, 0x20000
  s_mov_b32 s36, 25165824
  s_add_u32 s42, s42, s36
  s_addc_u32 s43, s43, 0
  s_mov_b32 s12, s42
  s_and_b32 s13, s43, 0xffff
  s_mov_b32 s14, 20971520
  s_mov_b32 s15, 0x20000
  s_mul_i32 s38, s44, 81920
  s_add_u32 s38, s38, s31
  s_add_u32 s44, s44, 1
  s_cmp_eq_u32 s44, 12
  s_cselect_b32 s44, 0, s44
  s_add_u32 m0, s32, 0
  s_nop 0
  buffer_load_dwordx4 v2, s[8:11], s38 offen offset:0 lds
  buffer_load_dwordx4 v3, s[8:11], s38 offen offset:1024 lds
  buffer_load_dwordx4 v4, s[8:11], s38 offen offset:2048 lds
  buffer_load_dwordx4 v5, s[8:11], s38 offen offset:3072 lds
  s_add_u32 m0, s32, 4096
  s_nop 0
  buffer_load_dwordx4 v6, s[8:11], s38 offen offset:0 lds
  s_mul_i32 s46, s45, 43
  s_lshr_b32 s46, s46, 7
  s_mul_i32 s47, s46, 3
  s_sub_u32 s47, s45, s47
  s_mul_i32 s46, s46, 98304
  s_lshl_b32 s47, s47, 12
  s_add_u32 s37, s30, s46
  s_add_u32 s37, s37, s47
  s_add_u32 s45, s45, 1
  s_cmp_eq_u32 s45, 12
  s_cselect_b32 s45, 0, s45
  buffer_load_dwordx4 v[64:67], v12, s[4:7], s37 offen offset:0
  buffer_load_dwordx4 v[68:71], v13, s[4:7], s37 offen offset:0
  buffer_load_dwordx4 v[72:75], v12, s[4:7], s37 offen offset:1024
  buffer_load_dwordx4 v[76:79], v13, s[4:7], s37 offen offset:1024
  buffer_load_dwordx4 v[80:83], v12, s[4:7], s37 offen offset:2048
  buffer_load_dwordx4 v[84:87], v13, s[4:7], s37 offen offset:2048
  buffer_load_dwordx4 v[88:91], v12, s[4:7], s37 offen offset:3072
  buffer_load_dwordx4 v[92:95], v13, s[4:7], s37 offen offset:3072
  s_mul_i32 s38, s44, 81920
  s_add_u32 s38, s38, s31
  s_add_u32 s44, s44, 1
  s_cmp_eq_u32 s44, 12
  s_cselect_b32 s44, 0, s44
  s_add_u32 m0, s32, 20480
  s_nop 0
  buffer_load_dwordx4 v2, s[8:11], s38 offen offset:0 lds
  buffer_load_dwordx4 v3, s[8:11], s38 offen offset:1024 lds
  buffer_load_dwordx4 v4, s[8:11], s38 offen offset:2048 lds
  buffer_load_dwordx4 v5, s[8:11], s38 offen offset:3072 lds
  s_add_u32 m0, s32, 24576
  s_nop 0
  buffer_load_dwordx4 v6, s[8:11], s38 offen offset:0 lds
  v_bfe_u32 v16, v1, 4, 1
  v_lshrrev_b32 v17, 5, v1
  v_bfe_u32 v18, v1, 2, 2
  v_and_b32 v19, 3, v1
  v_lshlrev_b32 v17, 2, v17
  v_add_u32 v17, v17, v18
  v_mul_u32_u24 v17, 320, v17
  v_lshlrev_b32 v16, 4, v16
  v_add_u32 v17, v17, v16
  v_and_b32 v16, 1, v19
  v_lshlrev_b32 v16, 5, v16
  v_add_u32 v17, v17, v16
  v_lshrrev_b32 v16, 1, v19
  v_lshlrev_b32 v16, 3, v16
  v_add_u32 v14, v17, v16
  v_add_u32 v15, 61440, v14
  s_waitcnt vmcnt(5)
  s_barrier
  ds_read_b64_tr_b16 a[160:161], v14 offset:0
  ds_read_b64_tr_b16 a[162:163], v14 offset:2560
  ds_read_b64_tr_b16 a[164:165], v14 offset:64
  ds_read_b64_tr_b16 a[166:167], v14 offset:2624
  ds_read_b64_tr_b16 a[168:169], v14 offset:128
  ds_read_b64_tr_b16 a[170:171], v14 offset:2688
  ds_read_b64_tr_b16 a[172:173], v14 offset:192
  ds_read_b64_tr_b16 a[174:175], v14 offset:2752
  ds_read_b64_tr_b16 a[176:177], v14 offset:256
  ds_read_b64_tr_b16 a[178:179], v14 offset:2816
  s_waitcnt lgkmcnt(8)
  v_mfma_f32_32x32x16_bf16 a[0:15], a[160:163], v[64:67], 0
  ds_read_b64_tr_b16 a[180:181], v14 offset:5120
  v_mfma_f32_32x32x16_bf16 a[80:95], a[160:163], v[68:71], 0
  ds_read_b64_tr_b16 a[182:183], v14 offset:7680
  s_mul_i32 s46, s45, 43
  s_lshr_b32 s46, s46, 7
  s_mul_i32 s47, s46, 3
  s_sub_u32 s47, s45, s47
  s_mul_i32 s46, s46, 98304
  s_lshl_b32 s47, s47, 12
  s_add_u32 s37, s30, s46
  s_add_u32 s37, s37, s47
  s_add_u32 s45, s45, 1
  s_cmp_eq_u32 s45, 12
  s_cselect_b32 s45, 0, s45
  buffer_load_dwordx4 v[96:99], v12, s[4:7], s37 offen offset:0
  s_waitcnt lgkmcnt(8)
  v_mfma_f32_32x32x16_bf16 a[16:31], a[164:167], v[64:67], 0
  ds_read_b64_tr_b16 a[184:185], v14 offset:5184
  buffer_load_dwordx4 v[100:103], v13, s[4:7], s37 offen offset:0
  v_mfma_f32_32x32x16_bf16 a[96:111], a[164:167], v[68:71], 0
  ds_read_b64_tr_b16 a[186:187], v14 offset:7744
  buffer_load_dwordx4 v[104:107], v12, s[4:7], s37 offen offset:1024
  s_waitcnt lgkmcnt(8)
  v_mfma_f32_32x32x16_bf16 a[32:47], a[168:171], v[64:67], 0
  ds_read_b64_tr_b16 a[188:189], v14 offset:5248
  buffer_load_dwordx4 v[108:111], v13, s[4:7], s37 offen offset:1024
  v_mfma_f32_32x32x16_bf16 a[112:127], a[168:171], v[68:71], 0
  ds_read_b64_tr_b16 a[190:191], v14 offset:7808
  buffer_load_dwordx4 v[112:115], v12, s[4:7], s37 offen offset:2048
  s_waitcnt lgkmcnt(8)
  v_mfma_f32_32x32x16_bf16 a[48:63], a[172:175], v[64:67], 0
  ds_read_b64_tr_b16 a[160:161], v14 offset:5312
  buffer_load_dwordx4 v[116:119], v13, s[4:7], s37 offen offset:2048
  v_mfma_f32_32x32x16_bf16 a[128:143], a[172:175], v[68:71], 0
  ds_read_b64_tr_b16 a[162:163], v14 offset:7872
  buffer_load_dwordx4 v[120:123], v12, s[4:7], s37 offen offset:3072
  s_waitcnt lgkmcnt(8)
  v_mfma_f32_32x32x16_bf16 a[64:79], a[176:179], v[64:67], 0
  ds_read_b64_tr_b16 a[164:165], v14 offset:5376
  buffer_load_dwordx4 v[124:127], v13, s[4:7], s37 offen offset:3072
  v_mfma_f32_32x32x16_bf16 a[144:159], a[176:179], v[68:71], 0
  ds_read_b64_tr_b16 a[166:167], v14 offset:7936
  s_mul_i32 s38, s44, 81920
  s_add_u32 s38, s38, s31
  s_add_u32 s44, s44, 1
  s_cmp_eq_u32 s44, 12
  s_cselect_b32 s44, 0, s44
  s_add_u32 m0, s32, 40960
  s_nop 0
  buffer_load_dwordx4 v2, s[8:11], s38 offen offset:0 lds
  s_waitcnt lgkmcnt(8)
  v_mfma_f32_32x32x16_bf16 a[0:15], a[180:183], v[72:75], a[0:15]
  ds_read_b64_tr_b16 a[168:169], v14 offset:10240
  buffer_load_dwordx4 v3, s[8:11], s38 offen offset:1024 lds
  v_mfma_f32_32x32x16_bf16 a[80:95], a[180:183], v[76:79], a[80:95]
  ds_read_b64_tr_b16 a[170:171], v14 offset:12800
  buffer_load_dwordx4 v4, s[8:11], s38 offen offset:2048 lds
  s_waitcnt lgkmcnt(8)
  v_mfma_f32_32x32x16_bf16 a[16:31], a[184:187], v[72:75], a[16:31]
  ds_read_b64_tr_b16 a[172:173], v14 offset:10304
  buffer_load_dwordx4 v5, s[8:11], s38 offen offset:3072 lds
  v_mfma_f32_32x32x16_bf16 a[96:111], a[184:187], v[76:79], a[96:111]
  ds_read_b64_tr_b16 a[174:175], v14 offset:12864
  s_add_u32 m0, s32, 45056
  s_nop 0
  buffer_load_dwordx4 v6, s[8:11], s38 offen offset:0 lds
  s_waitcnt lgkmcnt(8)
  v_mfma_f32_32x32x16_bf16 a[32:47], a[188:191], v[72:75], a[32:47]
  ds_read_b64_tr_b16 a[176:177], v14 offset:10368
  s_mul_i32 s46, s45, 43
  s_lshr_b32 s46, s46, 7
  s_mul_i32 s47, s46, 3
  s_sub_u32 s47, s45, s47
  s_mul_i32 s46, s46, 98304
  s_lshl_b32 s47, s47, 12
  s_add_u32 s37, s30, s46
  s_add_u32 s37, s37, s47
  s_add_u32 s45, s45, 1
  s_cmp_eq_u32 s45, 12
  s_cselect_b32 s45, 0, s45
  buffer_load_dwordx4 v[128:131], v12, s[4:7], s37 offen offset:0
  v_mfma_f32_32x32x16_bf16 a[112:127], a[188:191], v[76:79], a[112:127]
  ds_read_b64_tr_b16 a[178:179], v14 offset:12928
  buffer_load_dwordx4 v[132:135], v13, s[4:7], s37 offen offset:0
  s_waitcnt lgkmcnt(8)
  v_mfma_f32_32x32x16_bf16 a[48:63], a[160:163], v[72:75], a[48:63]
  ds_read_b64_tr_b16 a[180:181], v14 offset:10432
  buffer_load_dwordx4 v[136:139], v12, s[4:7], s37 offen offset:1024
  v_mfma_f32_32x32x16_bf16 a[128:143], a[160:163], v[76:79], a[128:143]
  ds_read_b64_tr_b16 a[182:183], v14 offset:12992
  buffer_load_dwordx4 v[140:143], v13, s[4:7], s37 offen offset:1024
  s_waitcnt lgkmcnt(8)
  v_mfma_f32_32x32x16_bf16 a[64:79], a[164:167], v[72:75], a[64:79]
  ds_read_b64_tr_b16 a[184:185], v14 offset:10496
  buffer_load_dwordx4 v[144:147], v12, s[4:7], s37 offen offset:2048
  v_mfma_f32_32x32x16_bf16 a[144:159], a[164:167], v[76:79], a[144:159]
  ds_read_b64_tr_b16 a[186:187], v14 offset:13056
  buffer_load_dwordx4 v[148:151], v13, s[4:7], s37 offen offset:2048
  s_waitcnt lgkmcnt(8)
  v_mfma_f32_32x32x16_bf16 a[0:15], a[168:171], v[80:83], a[0:15]
  ds_read_b64_tr_b16 a[188:189], v14 offset:15360
  buffer_load_dwordx4 v[152:155], v12, s[4:7], s37 offen offset:3072
  v_mfma_f32_32x32x16_bf16 a[80:95], a[168:171], v[84:87], a[80:95]
  ds_read_b64_tr_b16 a[190:191], v14 offset:17920
  buffer_load_dwordx4 v[156:159], v13, s[4:7], s37 offen offset:3072
  s_waitcnt lgkmcnt(8)
  v_mfma_f32_32x32x16_bf16 a[16:31], a[172:175], v[80:83], a[16:31]
  ds_read_b64_tr_b16 a[160:161], v14 offset:15424
  s_mul_i32 s38, s44, 81920
  s_add_u32 s38, s38, s31
  s_add_u32 s44, s44, 1
  s_cmp_eq_u32 s44, 12
  s_cselect_b32 s44, 0, s44
  s_add_u32 m0, s32, 61440
  s_nop 0
  buffer_load_dwordx4 v2, s[8:11], s38 offen offset:0 lds
  v_mfma_f32_32x32x16_bf16 a[96:111], a[172:175], v[84:87], a[96:111]
  ds_read_b64_tr_b16 a[162:163], v14 offset:17984
  buffer_load_dwordx4 v3, s[8:11], s38 offen offset:1024 lds
  s_waitcnt lgkmcnt(8)
  v_mfma_f32_32x32x16_bf16 a[32:47], a[176:179], v[80:83], a[32:47]
  ds_read_b64_tr_b16 a[164:165], v14 offset:15488
  buffer_load_dwordx4 v4, s[8:11], s38 offen offset:2048 lds
  v_mfma_f32_32x32x16_bf16 a[112:127], a[176:179], v[84:87], a[112:127]
  ds_read_b64_tr_b16 a[166:167], v14 offset:18048
  buffer_load_dwordx4 v5, s[8:11], s38 offen offset:3072 lds
  s_waitcnt lgkmcnt(8)
  v_mfma_f32_32x32x16_bf16 a[48:63], a[180:183], v[80:83], a[48:63]
  ds_read_b64_tr_b16 a[168:169], v14 offset:15552
  s_add_u32 m0, s32, 65536
  s_nop 0
  buffer_load_dwordx4 v6, s[8:11], s38 offen offset:0 lds
  v_mfma_f32_32x32x16_bf16 a[128:143], a[180:183], v[84:87], a[128:143]
  ds_read_b64_tr_b16 a[170:171], v14 offset:18112
  s_waitcnt lgkmcnt(8)
  v_mfma_f32_32x32x16_bf16 a[64:79], a[184:187], v[80:83], a[64:79]
  ds_read_b64_tr_b16 a[172:173], v14 offset:15616
  v_mfma_f32_32x32x16_bf16 a[144:159], a[184:187], v[84:87], a[144:159]
  ds_read_b64_tr_b16 a[174:175], v14 offset:18176
  s_waitcnt vmcnt(26)
  s_barrier
  s_waitcnt lgkmcnt(8)
  v_mfma_f32_32x32x16_bf16 a[0:15], a[188:191], v[88:91], a[0:15]
  ds_read_b64_tr_b16 a[176:177], v14 offset:20480
  s_mul_i32 s46, s45, 43
  s_lshr_b32 s46, s46, 7
  s_mul_i32 s47, s46, 3
  s_sub_u32 s47, s45, s47
  s_mul_i32 s46, s46, 98304
  s_lshl_b32 s47, s47, 12
  s_add_u32 s37, s30, s46
  s_add_u32 s37, s37, s47
  s_add_u32 s45, s45, 1
  s_cmp_eq_u32 s45, 12
  s_cselect_b32 s45, 0, s45
  buffer_load_dwordx4 v[160:163], v12, s[4:7], s37 offen offset:0
  v_mfma_f32_32x32x16_bf16 a[80:95], a[188:191], v[92:95], a[80:95]
  ds_read_b64_tr_b16 a[178:179], v14 offset:23040
  buffer_load_dwordx4 v[164:167], v13, s[4:7], s37 offen offset:0
  s_waitcnt lgkmcnt(8)
  v_mfma_f32_32x32x16_bf16 a[16:31], a[160:163], v[88:91], a[16:31]
  ds_read_b64_tr_b16 a[180:181], v14 offset:20544
  buffer_load_dwordx4 v[168:171], v12, s[4:7], s37 offen offset:1024
  v_mfma_f32_32x32x16_bf16 a[96:111], a[160:163], v[92:95], a[96:111]
  ds_read_b64_tr_b16 a[182:183], v14 offset:23104
  buffer_load_dwordx4 v[172:175], v13, s[4:7], s37 offen offset:1024
  s_waitcnt lgkmcnt(8)
  v_mfma_f32_32x32x16_bf16 a[32:47], a[164:167], v[88:91], a[32:47]
  ds_read_b64_tr_b16 a[184:185], v14 offset:20608
  buffer_load_dwordx4 v[176:179], v12, s[4:7], s37 offen offset:2048
  v_mfma_f32_32x32x16_bf16 a[112:127], a[164:167], v[92:95], a[112:127]
  ds_read_b64_tr_b16 a[186:187], v14 offset:23168
  buffer_load_dwordx4 v[180:183], v13, s[4:7], s37 offen offset:2048
  s_waitcnt lgkmcnt(8)
  v_mfma_f32_32x32x16_bf16 a[48:63], a[168:171], v[88:91], a[48:63]
  ds_read_b64_tr_b16 a[188:189], v14 offset:20672
  buffer_load_dwordx4 v[184:187], v12, s[4:7], s37 offen offset:3072
  v_mfma_f32_32x32x16_bf16 a[128:143], a[168:171], v[92:95], a[128:143]
  ds_read_b64_tr_b16 a[190:191], v14 offset:23232
  buffer_load_dwordx4 v[188:191], v13, s[4:7], s37 offen offset:3072
  s_waitcnt lgkmcnt(8)
  v_mfma_f32_32x32x16_bf16 a[64:79], a[172:175], v[88:91], a[64:79]
  ds_read_b64_tr_b16 a[160:161], v14 offset:20736
  v_mfma_f32_32x32x16_bf16 a[144:159], a[172:175], v[92:95], a[144:159]
  ds_read_b64_tr_b16 a[162:163], v14 offset:23296
  s_waitcnt lgkmcnt(8)
  s_waitcnt vmcnt(33)
  v_mfma_f32_32x32x16_bf16 a[0:15], a[176:179], v[96:99], a[0:15]
  ds_read_b64_tr_b16 a[164:165], v14 offset:25600
  s_waitcnt vmcnt(32)
  v_mfma_f32_32x32x16_bf16 a[80:95], a[176:179], v[100:103], a[80:95]
  ds_read_b64_tr_b16 a[166:167], v14 offset:28160
  s_mul_i32 s38, s44, 81920
  s_add_u32 s38, s38, s31
  s_add_u32 s44, s44, 1
  s_cmp_eq_u32 s44, 12
  s_cselect_b32 s44, 0, s44
  s_add_u32 m0, s32, 81920
  s_nop 0
  buffer_load_dwordx4 v2, s[8:11], s38 offen offset:0 lds
  s_waitcnt lgkmcnt(8)
  v_mfma_f32_32x32x16_bf16 a[16:31], a[180:183], v[96:99], a[16:31]
  ds_read_b64_tr_b16 a[168:169], v14 offset:25664
  buffer_load_dwordx4 v3, s[8:11], s38 offen offset:1024 lds
  v_mfma_f32_32x32x16_bf16 a[96:111], a[180:183], v[100:103], a[96:111]
  ds_read_b64_tr_b16 a[170:171], v14 offset:28224
  buffer_load_dwordx4 v4, s[8:11], s38 offen offset:2048 lds
  s_waitcnt lgkmcnt(8)
  v_mfma_f32_32x32x16_bf16 a[32:47], a[184:187], v[96:99], a[32:47]
  ds_read_b64_tr_b16 a[172:173], v14 offset:25728
  buffer_load_dwordx4 v5, s[8:11], s38 offen offset:3072 lds
  v_mfma_f32_32x32x16_bf16 a[112:127], a[184:187], v[100:103], a[112:127]
  ds_read_b64_tr_b16 a[174:175], v14 offset:28288
  s_add_u32 m0, s32, 86016
  s_nop 0
  buffer_load_dwordx4 v6, s[8:11], s38 offen offset:0 lds
  s_waitcnt lgkmcnt(8)
  v_mfma_f32_32x32x16_bf16 a[48:63], a[188:191], v[96:99], a[48:63]
  ds_read_b64_tr_b16 a[176:177], v14 offset:25792
  s_mul_i32 s46, s45, 43
  s_lshr_b32 s46, s46, 7
  s_mul_i32 s47, s46, 3
  s_sub_u32 s47, s45, s47
  s_mul_i32 s46, s46, 98304
  s_lshl_b32 s47, s47, 12
  s_add_u32 s37, s30, s46
  s_add_u32 s37, s37, s47
  s_add_u32 s45, s45, 1
  s_cmp_eq_u32 s45, 12
  s_cselect_b32 s45, 0, s45
  buffer_load_dwordx4 v[192:195], v12, s[4:7], s37 offen offset:0
  v_mfma_f32_32x32x16_bf16 a[128:143], a[188:191], v[100:103], a[128:143]
  ds_read_b64_tr_b16 a[178:179], v14 offset:28352
  buffer_load_dwordx4 v[196:199], v13, s[4:7], s37 offen offset:0
  s_waitcnt lgkmcnt(8)
  v_mfma_f32_32x32x16_bf16 a[64:79], a[160:163], v[96:99], a[64:79]
  ds_read_b64_tr_b16 a[180:181], v14 offset:25856
  buffer_load_dwordx4 v[200:203], v12, s[4:7], s37 offen offset:1024
  v_mfma_f32_32x32x16_bf16 a[144:159], a[160:163], v[100:103], a[144:159]
  ds_read_b64_tr_b16 a[182:183], v14 offset:28416
  buffer_load_dwordx4 v[204:207], v13, s[4:7], s37 offen offset:1024
  s_waitcnt lgkmcnt(8)
  s_waitcnt vmcnt(40)
  v_mfma_f32_32x32x16_bf16 a[0:15], a[164:167], v[104:107], a[0:15]
  ds_read_b64_tr_b16 a[184:185], v14 offset:30720
  buffer_load_dwordx4 v[208:211], v12, s[4:7], s37 offen offset:2048
  s_waitcnt vmcnt(40)
  v_mfma_f32_32x32x16_bf16 a[80:95], a[164:167], v[108:111], a[80:95]
  ds_read_b64_tr_b16 a[186:187], v14 offset:33280
  buffer_load_dwordx4 v[212:215], v13, s[4:7], s37 offen offset:2048
  s_waitcnt lgkmcnt(8)
  v_mfma_f32_32x32x16_bf16 a[16:31], a[168:171], v[104:107], a[16:31]
  ds_read_b64_tr_b16 a[188:189], v14 offset:30784
  buffer_load_dwordx4 v[216:219], v12, s[4:7], s37 offen offset:3072
  v_mfma_f32_32x32x16_bf16 a[96:111], a[168:171], v[108:111], a[96:111]
  ds_read_b64_tr_b16 a[190:191], v14 offset:33344
  buffer_load_dwordx4 v[220:223], v13, s[4:7], s37 offen offset:3072
  s_waitcnt lgkmcnt(8)
  v_mfma_f32_32x32x16_bf16 a[32:47], a[172:175], v[104:107], a[32:47]
  ds_read_b64_tr_b16 a[160:161], v14 offset:30848
  s_mul_i32 s38, s44, 81920
  s_add_u32 s38, s38, s31
  s_add_u32 s44, s44, 1
  s_cmp_eq_u32 s44, 12
  s_cselect_b32 s44, 0, s44
  s_add_u32 m0, s32, 102400
  s_nop 0
  buffer_load_dwordx4 v2, s[8:11], s38 offen offset:0 lds
  v_mfma_f32_32x32x16_bf16 a[112:127], a[172:175], v[108:111], a[112:127]
  ds_read_b64_tr_b16 a[162:163], v14 offset:33408
  buffer_load_dwordx4 v3, s[8:11], s38 offen offset:1024 lds
  s_waitcnt lgkmcnt(8)
  v_mfma_f32_32x32x16_bf16 a[48:63], a[176:179], v[104:107], a[48:63]
  ds_read_b64_tr_b16 a[164:165], v14 offset:30912
  buffer_load_dwordx4 v4, s[8:11], s38 offen offset:2048 lds
  v_mfma_f32_32x32x16_bf16 a[128:143], a[176:179], v[108:111], a[128:143]
  ds_read_b64_tr_b16 a[166:167], v14 offset:33472
  buffer_load_dwordx4 v5, s[8:11], s38 offen offset:3072 lds
  s_waitcnt lgkmcnt(8)
  v_mfma_f32_32x32x16_bf16 a[64:79], a[180:183], v[104:107], a[64:79]
  ds_read_b64_tr_b16 a[168:169], v14 offset:30976
  s_add_u32 m0, s32, 106496
  s_nop 0
  buffer_load_dwordx4 v6, s[8:11], s38 offen offset:0 lds
  v_mfma_f32_32x32x16_bf16 a[144:159], a[180:183], v[108:111], a[144:159]
  ds_read_b64_tr_b16 a[170:171], v14 offset:33536
  s_waitcnt lgkmcnt(8)
  s_waitcnt vmcnt(47)
  v_mfma_f32_32x32x16_bf16 a[0:15], a[184:187], v[112:115], a[0:15]
  ds_read_b64_tr_b16 a[172:173], v14 offset:35840
  s_waitcnt vmcnt(46)
  v_mfma_f32_32x32x16_bf16 a[80:95], a[184:187], v[116:119], a[80:95]
  ds_read_b64_tr_b16 a[174:175], v14 offset:38400
  s_waitcnt lgkmcnt(8)
  v_mfma_f32_32x32x16_bf16 a[16:31], a[188:191], v[112:115], a[16:31]
  ds_read_b64_tr_b16 a[176:177], v14 offset:35904
  v_mfma_f32_32x32x16_bf16 a[96:111], a[188:191], v[116:119], a[96:111]
  ds_read_b64_tr_b16 a[178:179], v14 offset:38464
  s_waitcnt lgkmcnt(8)
  v_mfma_f32_32x32x16_bf16 a[32:47], a[160:163], v[112:115], a[32:47]
  ds_read_b64_tr_b16 a[180:181], v14 offset:35968
  v_mfma_f32_32x32x16_bf16 a[112:127], a[160:163], v[116:119], a[112:127]
  ds_read_b64_tr_b16 a[182:183], v14 offset:38528
  s_waitcnt lgkmcnt(8)
  v_mfma_f32_32x32x16_bf16 a[48:63], a[164:167], v[112:115], a[48:63]
  ds_read_b64_tr_b16 a[184:185], v14 offset:36032
  v_mfma_f32_32x32x16_bf16 a[128:143], a[164:167], v[116:119], a[128:143]
  ds_read_b64_tr_b16 a[186:187], v14 offset:38592
  s_waitcnt lgkmcnt(8)
  v_mfma_f32_32x32x16_bf16 a[64:79], a[168:171], v[112:115], a[64:79]
  ds_read_b64_tr_b16 a[188:189], v14 offset:36096
  v_mfma_f32_32x32x16_bf16 a[144:159], a[168:171], v[116:119], a[144:159]
  ds_read_b64_tr_b16 a[190:191], v14 offset:38656
  s_waitcnt vmcnt(39)
  s_barrier
  s_waitcnt lgkmcnt(8)
  v_mfma_f32_32x32x16_bf16 a[0:15], a[172:175], v[120:123], a[0:15]
  ds_read_b64_tr_b16 a[160:161], v14 offset:40960
  s_mul_i32 s38, s44, 81920
  s_add_u32 s38, s38, s31
  s_add_u32 s44, s44, 1
  s_cmp_eq_u32 s44, 12
  s_cselect_b32 s44, 0, s44
  s_add_u32 m0, s32, 0
  s_nop 0
  buffer_load_dwordx4 v2, s[8:11], s38 offen offset:0 lds
  v_mfma_f32_32x32x16_bf16 a[80:95], a[172:175], v[124:127], a[80:95]
  ds_read_b64_tr_b16 a[162:163], v14 offset:43520
  s_waitcnt lgkmcnt(8)
  v_mfma_f32_32x32x16_bf16 a[16:31], a[176:179], v[120:123], a[16:31]
  ds_read_b64_tr_b16 a[164:165], v14 offset:41024
  buffer_load_dwordx4 v3, s[8:11], s38 offen offset:1024 lds
  v_mfma_f32_32x32x16_bf16 a[96:111], a[176:179], v[124:127], a[96:111]
  ds_read_b64_tr_b16 a[166:167], v14 offset:43584
  s_waitcnt lgkmcnt(8)
  v_mfma_f32_32x32x16_bf16 a[32:47], a[180:183], v[120:123], a[32:47]
  ds_read_b64_tr_b16 a[168:169], v14 offset:41088
  buffer_load_dwordx4 v4, s[8:11], s38 offen offset:2048 lds
  v_mfma_f32_32x32x16_bf16 a[112:127], a[180:183], v[124:127], a[112:127]
  ds_read_b64_tr_b16 a[170:171], v14 offset:43648
  s_waitcnt lgkmcnt(8)
  v_mfma_f32_32x32x16_bf16 a[48:63], a[184:187], v[120:123], a[48:63]
  ds_read_b64_tr_b16 a[172:173], v14 offset:41152
  buffer_load_dwordx4 v5, s[8:11], s38 offen offset:3072 lds
  v_mfma_f32_32x32x16_bf16 a[128:143], a[184:187], v[124:127], a[128:143]
  ds_read_b64_tr_b16 a[174:175], v14 offset:43712
  s_waitcnt lgkmcnt(8)
  v_mfma_f32_32x32x16_bf16 a[64:79], a[188:191], v[120:123], a[64:79]
  ds_read_b64_tr_b16 a[176:177], v14 offset:41216
  s_add_u32 m0, s32, 4096
  s_nop 0
  buffer_load_dwordx4 v6, s[8:11], s38 offen offset:0 lds
  v_mfma_f32_32x32x16_bf16 a[144:159], a[188:191], v[124:127], a[144:159]
  ds_read_b64_tr_b16 a[178:179], v14 offset:43776
  s_waitcnt lgkmcnt(8)
  s_waitcnt vmcnt(43)
  v_mfma_f32_32x32x16_bf16 a[0:15], a[160:163], v[128:131], a[0:15]
  ds_read_b64_tr_b16 a[180:181], v14 offset:46080
  s_waitcnt vmcnt(42)
  v_mfma_f32_32x32x16_bf16 a[80:95], a[160:163], v[132:135], a[80:95]
  ds_read_b64_tr_b16 a[182:183], v14 offset:48640
  s_mul_i32 s46, s45, 43
  s_lshr_b32 s46, s46, 7
  s_mul_i32 s47, s46, 3
  s_sub_u32 s47, s45, s47
  s_mul_i32 s46, s46, 98304
  s_lshl_b32 s47, s47, 12
  s_add_u32 s37, s30, s46
  s_add_u32 s37, s37, s47
  s_add_u32 s45, s45, 1
  s_cmp_eq_u32 s45, 12
  s_cselect_b32 s45, 0, s45
  buffer_load_dwordx4 v[64:67], v12, s[4:7], s37 offen offset:0
  s_waitcnt lgkmcnt(8)
  v_mfma_f32_32x32x16_bf16 a[16:31], a[164:167], v[128:131], a[16:31]
  ds_read_b64_tr_b16 a[184:185], v14 offset:46144
  buffer_load_dwordx4 v[68:71], v13, s[4:7], s37 offen offset:0
  v_mfma_f32_32x32x16_bf16 a[96:111], a[164:167], v[132:135], a[96:111]
  ds_read_b64_tr_b16 a[186:187], v14 offset:48704
  buffer_load_dwordx4 v[72:75], v12, s[4:7], s37 offen offset:1024
  s_waitcnt lgkmcnt(8)
  v_mfma_f32_32x32x16_bf16 a[32:47], a[168:171], v[128:131], a[32:47]
  ds_read_b64_tr_b16 a[188:189], v14 offset:46208
  buffer_load_dwordx4 v[76:79], v13, s[4:7], s37 offen offset:1024
  v_mfma_f32_32x32x16_bf16 a[112:127], a[168:171], v[132:135], a[112:127]
  ds_read_b64_tr_b16 a[190:191], v14 offset:48768
  buffer_load_dwordx4 v[80:83], v12, s[4:7], s37 offen offset:2048
  s_waitcnt lgkmcnt(8)
  v_mfma_f32_32x32x16_bf16 a[48:63], a[172:175], v[128:131], a[48:63]
  ds_read_b64_tr_b16 a[160:161], v14 offset:46272
  buffer_load_dwordx4 v[84:87], v13, s[4:7], s37 offen offset:2048
  v_mfma_f32_32x32x16_bf16 a[128:143], a[172:175], v[132:135], a[128:143]
  ds_read_b64_tr_b16 a[162:163], v14 offset:48832
  buffer_load_dwordx4 v[88:91], v12, s[4:7], s37 offen offset:3072
  s_waitcnt lgkmcnt(8)
  v_mfma_f32_32x32x16_bf16 a[64:79], a[176:179], v[128:131], a[64:79]
  ds_read_b64_tr_b16 a[164:165], v14 offset:46336
  buffer_load_dwordx4 v[92:95], v13, s[4:7], s37 offen offset:3072
  v_mfma_f32_32x32x16_bf16 a[144:159], a[176:179], v[132:135], a[144:159]
  ds_read_b64_tr_b16 a[166:167], v14 offset:48896
  s_mul_i32 s46, s45, 43
  s_lshr_b32 s46, s46, 7
  s_mul_i32 s47, s46, 3
  s_sub_u32 s47, s45, s47
  s_mul_i32 s46, s46, 98304
  s_lshl_b32 s47, s47, 12
  s_add_u32 s37, s30, s46
  s_add_u32 s37, s37, s47
  s_add_u32 s45, s45, 1
  s_cmp_eq_u32 s45, 12
  s_cselect_b32 s45, 0, s45
  buffer_load_dwordx4 v[96:99], v12, s[4:7], s37 offen offset:0
  s_waitcnt lgkmcnt(8)
  s_waitcnt vmcnt(50)
  v_mfma_f32_32x32x16_bf16 a[0:15], a[180:183], v[136:139], a[0:15]
  ds_read_b64_tr_b16 a[168:169], v14 offset:51200
  buffer_load_dwordx4 v[100:103], v13, s[4:7], s37 offen offset:0
  s_waitcnt vmcnt(50)
  v_mfma_f32_32x32x16_bf16 a[80:95], a[180:183], v[140:143], a[80:95]
  ds_read_b64_tr_b16 a[170:171], v14 offset:53760
  buffer_load_dwordx4 v[104:107], v12, s[4:7], s37 offen offset:1024
  s_waitcnt lgkmcnt(8)
  v_mfma_f32_32x32x16_bf16 a[16:31], a[184:187], v[136:139], a[16:31]
  ds_read_b64_tr_b16 a[172:173], v14 offset:51264
  buffer_load_dwordx4 v[108:111], v13, s[4:7], s37 offen offset:1024
  v_mfma_f32_32x32x16_bf16 a[96:111], a[184:187], v[140:143], a[96:111]
  ds_read_b64_tr_b16 a[174:175], v14 offset:53824
  buffer_load_dwordx4 v[112:115], v12, s[4:7], s37 offen offset:2048
  s_waitcnt lgkmcnt(8)
  v_mfma_f32_32x32x16_bf16 a[32:47], a[188:191], v[136:139], a[32:47]
  ds_read_b64_tr_b16 a[176:177], v14 offset:51328
  buffer_load_dwordx4 v[116:119], v13, s[4:7], s37 offen offset:2048
  v_mfma_f32_32x32x16_bf16 a[112:127], a[188:191], v[140:143], a[112:127]
  ds_read_b64_tr_b16 a[178:179], v14 offset:53888
  buffer_load_dwordx4 v[120:123], v12, s[4:7], s37 offen offset:3072
  s_waitcnt lgkmcnt(8)
  v_mfma_f32_32x32x16_bf16 a[48:63], a[160:163], v[136:139], a[48:63]
  ds_read_b64_tr_b16 a[180:181], v14 offset:51392
  buffer_load_dwordx4 v[124:127], v13, s[4:7], s37 offen offset:3072
  v_mfma_f32_32x32x16_bf16 a[128:143], a[160:163], v[140:143], a[128:143]
  ds_read_b64_tr_b16 a[182:183], v14 offset:53952
  s_waitcnt lgkmcnt(8)
  v_mfma_f32_32x32x16_bf16 a[64:79], a[164:167], v[136:139], a[64:79]
  ds_read_b64_tr_b16 a[184:185], v14 offset:51456
  v_mfma_f32_32x32x16_bf16 a[144:159], a[164:167], v[140:143], a[144:159]
  ds_read_b64_tr_b16 a[186:187], v14 offset:54016
  s_waitcnt lgkmcnt(8)
  s_waitcnt vmcnt(55)
  v_mfma_f32_32x32x16_bf16 a[0:15], a[168:171], v[144:147], a[0:15]
  ds_read_b64_tr_b16 a[188:189], v14 offset:56320
  s_waitcnt vmcnt(54)
  v_mfma_f32_32x32x16_bf16 a[80:95], a[168:171], v[148:151], a[80:95]
  ds_read_b64_tr_b16 a[190:191], v14 offset:58880
  s_waitcnt lgkmcnt(8)
  v_mfma_f32_32x32x16_bf16 a[16:31], a[172:175], v[144:147], a[16:31]
  ds_read_b64_tr_b16 a[160:161], v14 offset:56384
  v_mfma_f32_32x32x16_bf16 a[96:111], a[172:175], v[148:151], a[96:111]
  ds_read_b64_tr_b16 a[162:163], v14 offset:58944
  s_waitcnt lgkmcnt(8)
  v_mfma_f32_32x32x16_bf16 a[32:47], a[176:179], v[144:147], a[32:47]
  ds_read_b64_tr_b16 a[164:165], v14 offset:56448
  v_mfma_f32_32x32x16_bf16 a[112:127], a[176:179], v[148:151], a[112:127]
  ds_read_b64_tr_b16 a[166:167], v14 offset:59008
  s_waitcnt lgkmcnt(8)
  v_mfma_f32_32x32x16_bf16 a[48:63], a[180:183], v[144:147], a[48:63]
  ds_read_b64_tr_b16 a[168:169], v14 offset:56512
  v_mfma_f32_32x32x16_bf16 a[128:143], a[180:183], v[148:151], a[128:143]
  ds_read_b64_tr_b16 a[170:171], v14 offset:59072
  s_waitcnt lgkmcnt(8)
  v_mfma_f32_32x32x16_bf16 a[64:79], a[184:187], v[144:147], a[64:79]
  ds_read_b64_tr_b16 a[172:173], v14 offset:56576
  v_mfma_f32_32x32x16_bf16 a[144:159], a[184:187], v[148:151], a[144:159]
  ds_read_b64_tr_b16 a[174:175], v14 offset:59136
  s_waitcnt vmcnt(47)
  s_barrier
  s_waitcnt lgkmcnt(8)
  v_mfma_f32_32x32x16_bf16 a[0:15], a[188:191], v[152:155], a[0:15]
  ds_read_b64_tr_b16 a[176:177], v15 offset:0
  s_mul_i32 s38, s44, 81920
  s_add_u32 s38, s38, s31
  s_add_u32 s44, s44, 1
  s_cmp_eq_u32 s44, 12
  s_cselect_b32 s44, 0, s44
  s_add_u32 m0, s32, 20480
  s_nop 0
  buffer_load_dwordx4 v2, s[8:11], s38 offen offset:0 lds
  v_mfma_f32_32x32x16_bf16 a[80:95], a[188:191], v[156:159], a[80:95]
  ds_read_b64_tr_b16 a[178:179], v15 offset:2560
  s_waitcnt lgkmcnt(8)
  v_mfma_f32_32x32x16_bf16 a[16:31], a[160:163], v[152:155], a[16:31]
  ds_read_b64_tr_b16 a[180:181], v15 offset:64
  buffer_load_dwordx4 v3, s[8:11], s38 offen offset:1024 lds
  v_mfma_f32_32x32x16_bf16 a[96:111], a[160:163], v[156:159], a[96:111]
  ds_read_b64_tr_b16 a[182:183], v15 offset:2624
  s_waitcnt lgkmcnt(8)
  v_mfma_f32_32x32x16_bf16 a[32:47], a[164:167], v[152:155], a[32:47]
  ds_read_b64_tr_b16 a[184:185], v15 offset:128
  buffer_load_dwordx4 v4, s[8:11], s38 offen offset:2048 lds
  v_mfma_f32_32x32x16_bf16 a[112:127], a[164:167], v[156:159], a[112:127]
  ds_read_b64_tr_b16 a[186:187], v15 offset:2688
  s_waitcnt lgkmcnt(8)
  v_mfma_f32_32x32x16_bf16 a[48:63], a[168:171], v[152:155], a[48:63]
  ds_read_b64_tr_b16 a[188:189], v15 offset:192
  buffer_load_dwordx4 v5, s[8:11], s38 offen offset:3072 lds
  v_mfma_f32_32x32x16_bf16 a[128:143], a[168:171], v[156:159], a[128:143]
  ds_read_b64_tr_b16 a[190:191], v15 offset:2752
  s_waitcnt lgkmcnt(8)
  v_mfma_f32_32x32x16_bf16 a[64:79], a[172:175], v[152:155], a[64:79]
  ds_read_b64_tr_b16 a[160:161], v15 offset:256
  s_add_u32 m0, s32, 24576
  s_nop 0
  buffer_load_dwordx4 v6, s[8:11], s38 offen offset:0 lds
  v_mfma_f32_32x32x16_bf16 a[144:159], a[172:175], v[156:159], a[144:159]
  ds_read_b64_tr_b16 a[162:163], v15 offset:2816
  s_waitcnt lgkmcnt(8)
  s_waitcnt vmcnt(51)
  v_mfma_f32_32x32x16_bf16 a[0:15], a[176:179], v[160:163], a[0:15]
  ds_read_b64_tr_b16 a[164:165], v15 offset:5120
  s_waitcnt vmcnt(50)
  v_mfma_f32_32x32x16_bf16 a[80:95], a[176:179], v[164:167], a[80:95]
  ds_read_b64_tr_b16 a[166:167], v15 offset:7680
  s_mul_i32 s46, s45, 43
  s_lshr_b32 s46, s46, 7
  s_mul_i32 s47, s46, 3
  s_sub_u32 s47, s45, s47
  s_mul_i32 s46, s46, 98304
  s_lshl_b32 s47, s47, 12
  s_add_u32 s37, s30, s46
  s_add_u32 s37, s37, s47
  s_add_u32 s45, s45, 1
  s_cmp_eq_u32 s45, 12
  s_cselect_b32 s45, 0, s45
  buffer_load_dwordx4 v[128:131], v12, s[4:7], s37 offen offset:0
  s_waitcnt lgkmcnt(8)
  v_mfma_f32_32x32x16_bf16 a[16:31], a[180:183], v[160:163], a[16:31]
  ds_read_b64_tr_b16 a[168:169], v15 offset:5184
  v_mfma_f32_32x32x16_bf16 a[96:111], a[180:183], v[164:167], a[96:111]
  ds_read_b64_tr_b16 a[170:171], v15 offset:7744
  s_waitcnt lgkmcnt(8)
  v_mfma_f32_32x32x16_bf16 a[32:47], a[184:187], v[160:163], a[32:47]
  ds_read_b64_tr_b16 a[172:173], v15 offset:5248
  buffer_load_dwordx4 v[132:135], v13, s[4:7], s37 offen offset:0
  v_mfma_f32_32x32x16_bf16 a[112:127], a[184:187], v[164:167], a[112:127]
  ds_read_b64_tr_b16 a[174:175], v15 offset:7808
  s_waitcnt lgkmcnt(8)
  v_mfma_f32_32x32x16_bf16 a[48:63], a[188:191], v[160:163], a[48:63]
  ds_read_b64_tr_b16 a[176:177], v15 offset:5312
  v_mfma_f32_32x32x16_bf16 a[128:143], a[188:191], v[164:167], a[128:143]
  ds_read_b64_tr_b16 a[178:179], v15 offset:7872
  buffer_load_dwordx4 v[136:139], v12, s[4:7], s37 offen offset:1024
  s_waitcnt lgkmcnt(8)
  v_mfma_f32_32x32x16_bf16 a[64:79], a[160:163], v[160:163], a[64:79]
  ds_read_b64_tr_b16 a[180:181], v15 offset:5376
  v_mfma_f32_32x32x16_bf16 a[144:159], a[160:163], v[164:167], a[144:159]
  ds_read_b64_tr_b16 a[182:183], v15 offset:7936
  s_waitcnt lgkmcnt(8)
  s_waitcnt vmcnt(52)
  v_mfma_f32_32x32x16_bf16 a[0:15], a[164:167], v[168:171], a[0:15]
  ds_read_b64_tr_b16 a[184:185], v15 offset:10240
  buffer_load_dwordx4 v[140:143], v13, s[4:7], s37 offen offset:1024
  s_waitcnt vmcnt(52)
  v_mfma_f32_32x32x16_bf16 a[80:95], a[164:167], v[172:175], a[80:95]
  ds_read_b64_tr_b16 a[186:187], v15 offset:12800
  s_waitcnt lgkmcnt(8)
  v_mfma_f32_32x32x16_bf16 a[16:31], a[168:171], v[168:171], a[16:31]
  ds_read_b64_tr_b16 a[188:189], v15 offset:10304
  v_mfma_f32_32x32x16_bf16 a[96:111], a[168:171], v[172:175], a[96:111]
  ds_read_b64_tr_b16 a[190:191], v15 offset:12864
  buffer_load_dwordx4 v[144:147], v12, s[4:7], s37 offen offset:2048
  s_waitcnt lgkmcnt(8)
  v_mfma_f32_32x32x16_bf16 a[32:47], a[172:175], v[168:171], a[32:47]
  ds_read_b64_tr_b16 a[160:161], v15 offset:10368
  v_mfma_f32_32x32x16_bf16 a[112:127], a[172:175], v[172:175], a[112:127]
  ds_read_b64_tr_b16 a[162:163], v15 offset:12928
  s_waitcnt lgkmcnt(8)
  v_mfma_f32_32x32x16_bf16 a[48:63], a[176:179], v[168:171], a[48:63]
  ds_read_b64_tr_b16 a[164:165], v15 offset:10432
  buffer_load_dwordx4 v[148:151], v13, s[4:7], s37 offen offset:2048
  v_mfma_f32_32x32x16_bf16 a[128:143], a[176:179], v[172:175], a[128:143]
  ds_read_b64_tr_b16 a[166:167], v15 offset:12992
  s_waitcnt lgkmcnt(8)
  v_mfma_f32_32x32x16_bf16 a[64:79], a[180:183], v[168:171], a[64:79]
  ds_read_b64_tr_b16 a[168:169], v15 offset:10496
  v_mfma_f32_32x32x16_bf16 a[144:159], a[180:183], v[172:175], a[144:159]
  ds_read_b64_tr_b16 a[170:171], v15 offset:13056
  buffer_load_dwordx4 v[152:155], v12, s[4:7], s37 offen offset:3072
  s_waitcnt lgkmcnt(8)
  s_waitcnt vmcnt(54)
  v_mfma_f32_32x32x16_bf16 a[0:15], a[184:187], v[176:179], a[0:15]
  ds_read_b64_tr_b16 a[172:173], v15 offset:15360
  s_waitcnt vmcnt(53)
  v_mfma_f32_32x32x16_bf16 a[80:95], a[184:187], v[180:183], a[80:95]
  ds_read_b64_tr_b16 a[174:175], v15 offset:17920
  s_waitcnt lgkmcnt(8)
  v_mfma_f32_32x32x16_bf16 a[16:31], a[188:191], v[176:179], a[16:31]
  ds_read_b64_tr_b16 a[176:177], v15 offset:15424
  buffer_load_dwordx4 v[156:159], v13, s[4:7], s37 offen offset:3072
  v_mfma_f32_32x32x16_bf16 a[96:111], a[188:191], v[180:183], a[96:111]
  ds_read_b64_tr_b16 a[178:179], v15 offset:17984
  s_waitcnt lgkmcnt(8)
  v_mfma_f32_32x32x16_bf16 a[32:47], a[160:163], v[176:179], a[32:47]
  ds_read_b64_tr_b16 a[180:181], v15 offset:15488
  v_mfma_f32_32x32x16_bf16 a[112:127], a[160:163], v[180:183], a[112:127]
  ds_read_b64_tr_b16 a[182:183], v15 offset:18048
  s_waitcnt lgkmcnt(8)
  v_mfma_f32_32x32x16_bf16 a[48:63], a[164:167], v[176:179], a[48:63]
  ds_read_b64_tr_b16 a[184:185], v15 offset:15552
  v_mfma_f32_32x32x16_bf16 a[128:143], a[164:167], v[180:183], a[128:143]
  ds_read_b64_tr_b16 a[186:187], v15 offset:18112
  s_waitcnt lgkmcnt(8)
  v_mfma_f32_32x32x16_bf16 a[64:79], a[168:171], v[176:179], a[64:79]
  ds_read_b64_tr_b16 a[188:189], v15 offset:15616
  v_mfma_f32_32x32x16_bf16 a[144:159], a[168:171], v[180:183], a[144:159]
  ds_read_b64_tr_b16 a[190:191], v15 offset:18176
  s_waitcnt vmcnt(47)
  s_barrier
  s_waitcnt lgkmcnt(8)
  v_mfma_f32_32x32x16_bf16 a[0:15], a[172:175], v[184:187], a[0:15]
  ds_read_b64_tr_b16 a[160:161], v15 offset:20480
  s_mul_i32 s38, s44, 81920
  s_add_u32 s38, s38, s31
  s_add_u32 s44, s44, 1
  s_cmp_eq_u32 s44, 12
  s_cselect_b32 s44, 0, s44
  s_add_u32 m0, s32, 40960
  s_nop 0
  buffer_load_dwordx4 v2, s[8:11], s38 offen offset:0 lds
  v_mfma_f32_32x32x16_bf16 a[80:95], a[172:175], v[188:191], a[80:95]
  ds_read_b64_tr_b16 a[162:163], v15 offset:23040
  s_waitcnt lgkmcnt(8)
  v_mfma_f32_32x32x16_bf16 a[16:31], a[176:179], v[184:187], a[16:31]
  ds_read_b64_tr_b16 a[164:165], v15 offset:20544
  buffer_load_dwordx4 v3, s[8:11], s38 offen offset:1024 lds
  v_mfma_f32_32x32x16_bf16 a[96:111], a[176:179], v[188:191], a[96:111]
  ds_read_b64_tr_b16 a[166:167], v15 offset:23104
  s_waitcnt lgkmcnt(8)
  v_mfma_f32_32x32x16_bf16 a[32:47], a[180:183], v[184:187], a[32:47]
  ds_read_b64_tr_b16 a[168:169], v15 offset:20608
  buffer_load_dwordx4 v4, s[8:11], s38 offen offset:2048 lds
  v_mfma_f32_32x32x16_bf16 a[112:127], a[180:183], v[188:191], a[112:127]
  ds_read_b64_tr_b16 a[170:171], v15 offset:23168
  s_waitcnt lgkmcnt(8)
  v_mfma_f32_32x32x16_bf16 a[48:63], a[184:187], v[184:187], a[48:63]
  ds_read_b64_tr_b16 a[172:173], v15 offset:20672
  buffer_load_dwordx4 v5, s[8:11], s38 offen offset:3072 lds
  v_mfma_f32_32x32x16_bf16 a[128:143], a[184:187], v[188:191], a[128:143]
  ds_read_b64_tr_b16 a[174:175], v15 offset:23232
  s_waitcnt lgkmcnt(8)
  v_mfma_f32_32x32x16_bf16 a[64:79], a[188:191], v[184:187], a[64:79]
  ds_read_b64_tr_b16 a[176:177], v15 offset:20736
  s_add_u32 m0, s32, 45056
  s_nop 0
  buffer_load_dwordx4 v6, s[8:11], s38 offen offset:0 lds
  v_mfma_f32_32x32x16_bf16 a[144:159], a[188:191], v[188:191], a[144:159]
  ds_read_b64_tr_b16 a[178:179], v15 offset:23296
  s_waitcnt lgkmcnt(8)
  s_waitcnt vmcnt(51)
  v_mfma_f32_32x32x16_bf16 a[0:15], a[160:163], v[192:195], a[0:15]
  ds_read_b64_tr_b16 a[180:181], v15 offset:25600
  s_waitcnt vmcnt(50)
  v_mfma_f32_32x32x16_bf16 a[80:95], a[160:163], v[196:199], a[80:95]
  ds_read_b64_tr_b16 a[182:183], v15 offset:28160
  s_mul_i32 s46, s45, 43
  s_lshr_b32 s46, s46, 7
  s_mul_i32 s47, s46, 3
  s_sub_u32 s47, s45, s47
  s_mul_i32 s46, s46, 98304
  s_lshl_b32 s47, s47, 12
  s_add_u32 s37, s30, s46
  s_add_u32 s37, s37, s47
  s_add_u32 s45, s45, 1
  s_cmp_eq_u32 s45, 12
  s_cselect_b32 s45, 0, s45
  buffer_load_dwordx4 v[160:163], v12, s[4:7], s37 offen offset:0
  s_waitcnt lgkmcnt(8)
  v_mfma_f32_32x32x16_bf16 a[16:31], a[164:167], v[192:195], a[16:31]
  ds_read_b64_tr_b16 a[184:185], v15 offset:25664
  v_mfma_f32_32x32x16_bf16 a[96:111], a[164:167], v[196:199], a[96:111]
  ds_read_b64_tr_b16 a[186:187], v15 offset:28224
  s_waitcnt lgkmcnt(8)
  v_mfma_f32_32x32x16_bf16 a[32:47], a[168:171], v[192:195], a[32:47]
  ds_read_b64_tr_b16 a[188:189], v15 offset:25728
  buffer_load_dwordx4 v[164:167], v13, s[4:7], s37 offen offset:0
  v_mfma_f32_32x32x16_bf16 a[112:127], a[168:171], v[196:199], a[112:127]
  ds_read_b64_tr_b16 a[190:191], v15 offset:28288
  s_waitcnt lgkmcnt(8)
  v_mfma_f32_32x32x16_bf16 a[48:63], a[172:175], v[192:195], a[48:63]
  ds_read_b64_tr_b16 a[160:161], v15 offset:25792
  v_mfma_f32_32x32x16_bf16 a[128:143], a[172:175], v[196:199], a[128:143]
  ds_read_b64_tr_b16 a[162:163], v15 offset:28352
  buffer_load_dwordx4 v[168:171], v12, s[4:7], s37 offen offset:1024
  s_waitcnt lgkmcnt(8)
  v_mfma_f32_32x32x16_bf16 a[64:79], a[176:179], v[192:195], a[64:79]
  ds_read_b64_tr_b16 a[164:165], v15 offset:25856
  v_mfma_f32_32x32x16_bf16 a[144:159], a[176:179], v[196:199], a[144:159]
  ds_read_b64_tr_b16 a[166:167], v15 offset:28416
  s_waitcnt lgkmcnt(8)
  s_waitcnt vmcnt(52)
  v_mfma_f32_32x32x16_bf16 a[0:15], a[180:183], v[200:203], a[0:15]
  ds_read_b64_tr_b16 a[168:169], v15 offset:30720
  buffer_load_dwordx4 v[172:175], v13, s[4:7], s37 offen offset:1024
  s_waitcnt vmcnt(52)
  v_mfma_f32_32x32x16_bf16 a[80:95], a[180:183], v[204:207], a[80:95]
  ds_read_b64_tr_b16 a[170:171], v15 offset:33280
  s_waitcnt lgkmcnt(8)
  v_mfma_f32_32x32x16_bf16 a[16:31], a[184:187], v[200:203], a[16:31]
  ds_read_b64_tr_b16 a[172:173], v15 offset:30784
  v_mfma_f32_32x32x16_bf16 a[96:111], a[184:187], v[204:207], a[96:111]
  ds_read_b64_tr_b16 a[174:175], v15 offset:33344
  buffer_load_dwordx4 v[176:179], v12, s[4:7], s37 offen offset:2048
  s_waitcnt lgkmcnt(8)
  v_mfma_f32_32x32x16_bf16 a[32:47], a[188:191], v[200:203], a[32:47]
  ds_read_b64_tr_b16 a[176:177], v15 offset:30848
  v_mfma_f32_32x32x16_bf16 a[112:127], a[188:191], v[204:207], a[112:127]
  ds_read_b64_tr_b16 a[178:179], v15 offset:33408
  s_waitcnt lgkmcnt(8)
  v_mfma_f32_32x32x16_bf16 a[48:63], a[160:163], v[200:203], a[48:63]
  ds_read_b64_tr_b16 a[180:181], v15 offset:30912
  buffer_load_dwordx4 v[180:183], v13, s[4:7], s37 offen offset:2048
  v_mfma_f32_32x32x16_bf16 a[128:143], a[160:163], v[204:207], a[128:143]
  ds_read_b64_tr_b16 a[182:183], v15 offset:33472
  s_waitcnt lgkmcnt(8)
  v_mfma_f32_32x32x16_bf16 a[64:79], a[164:167], v[200:203], a[64:79]
  ds_read_b64_tr_b16 a[184:185], v15 offset:30976
  v_mfma_f32_32x32x16_bf16 a[144:159], a[164:167], v[204:207], a[144:159]
  ds_read_b64_tr_b16 a[186:187], v15 offset:33536
  buffer_load_dwordx4 v[184:187], v12, s[4:7], s37 offen offset:3072
  s_waitcnt lgkmcnt(8)
  s_waitcnt vmcnt(54)
  v_mfma_f32_32x32x16_bf16 a[0:15], a[168:171], v[208:211], a[0:15]
  ds_read_b64_tr_b16 a[188:189], v15 offset:35840
  s_waitcnt vmcnt(53)
  v_mfma_f32_32x32x16_bf16 a[80:95], a[168:171], v[212:215], a[80:95]
  ds_read_b64_tr_b16 a[190:191], v15 offset:38400
  s_waitcnt lgkmcnt(8)
  v_mfma_f32_32x32x16_bf16 a[16:31], a[172:175], v[208:211], a[16:31]
  ds_read_b64_tr_b16 a[160:161], v15 offset:35904
  buffer_load_dwordx4 v[188:191], v13, s[4:7], s37 offen offset:3072
  v_mfma_f32_32x32x16_bf16 a[96:111], a[172:175], v[212:215], a[96:111]
  ds_read_b64_tr_b16 a[162:163], v15 offset:38464
  s_waitcnt lgkmcnt(8)
  v_mfma_f32_32x32x16_bf16 a[32:47], a[176:179], v[208:211], a[32:47]
  ds_read_b64_tr_b16 a[164:165], v15 offset:35968
  v_mfma_f32_32x32x16_bf16 a[112:127], a[176:179], v[212:215], a[112:127]
  ds_read_b64_tr_b16 a[166:167], v15 offset:38528
  s_waitcnt lgkmcnt(8)
  v_mfma_f32_32x32x16_bf16 a[48:63], a[180:183], v[208:211], a[48:63]
  ds_read_b64_tr_b16 a[168:169], v15 offset:36032
  v_mfma_f32_32x32x16_bf16 a[128:143], a[180:183], v[212:215], a[128:143]
  ds_read_b64_tr_b16 a[170:171], v15 offset:38592
  s_waitcnt lgkmcnt(8)
  v_mfma_f32_32x32x16_bf16 a[64:79], a[184:187], v[208:211], a[64:79]
  ds_read_b64_tr_b16 a[172:173], v15 offset:36096
  v_mfma_f32_32x32x16_bf16 a[144:159], a[184:187], v[212:215], a[144:159]
  ds_read_b64_tr_b16 a[174:175], v15 offset:38656
  s_waitcnt vmcnt(47)
  s_barrier
  s_waitcnt lgkmcnt(8)
  v_mfma_f32_32x32x16_bf16 a[0:15], a[188:191], v[216:219], a[0:15]
  ds_read_b64_tr_b16 a[176:177], v15 offset:40960
  s_mul_i32 s38, s44, 81920
  s_add_u32 s38, s38, s31
  s_add_u32 s44, s44, 1
  s_cmp_eq_u32 s44, 12
  s_cselect_b32 s44, 0, s44
  s_add_u32 m0, s32, 61440
  s_nop 0
  buffer_load_dwordx4 v2, s[8:11], s38 offen offset:0 lds
  v_mfma_f32_32x32x16_bf16 a[80:95], a[188:191], v[220:223], a[80:95]
  ds_read_b64_tr_b16 a[178:179], v15 offset:43520
  s_waitcnt lgkmcnt(8)
  v_mfma_f32_32x32x16_bf16 a[16:31], a[160:163], v[216:219], a[16:31]
  ds_read_b64_tr_b16 a[180:181], v15 offset:41024
  buffer_load_dwordx4 v3, s[8:11], s38 offen offset:1024 lds
  v_mfma_f32_32x32x16_bf16 a[96:111], a[160:163], v[220:223], a[96:111]
  ds_read_b64_tr_b16 a[182:183], v15 offset:43584
  s_waitcnt lgkmcnt(8)
  v_mfma_f32_32x32x16_bf16 a[32:47], a[164:167], v[216:219], a[32:47]
  ds_read_b64_tr_b16 a[184:185], v15 offset:41088
  buffer_load_dwordx4 v4, s[8:11], s38 offen offset:2048 lds
  v_mfma_f32_32x32x16_bf16 a[112:127], a[164:167], v[220:223], a[112:127]
  ds_read_b64_tr_b16 a[186:187], v15 offset:43648
  s_waitcnt lgkmcnt(8)
  v_mfma_f32_32x32x16_bf16 a[48:63], a[168:171], v[216:219], a[48:63]
  ds_read_b64_tr_b16 a[188:189], v15 offset:41152
  buffer_load_dwordx4 v5, s[8:11], s38 offen offset:3072 lds
  v_mfma_f32_32x32x16_bf16 a[128:143], a[168:171], v[220:223], a[128:143]
  ds_read_b64_tr_b16 a[190:191], v15 offset:43712
  s_waitcnt lgkmcnt(8)
  v_mfma_f32_32x32x16_bf16 a[64:79], a[172:175], v[216:219], a[64:79]
  ds_read_b64_tr_b16 a[160:161], v15 offset:41216
  s_add_u32 m0, s32, 65536
  s_nop 0
  buffer_load_dwordx4 v6, s[8:11], s38 offen offset:0 lds
  v_mfma_f32_32x32x16_bf16 a[144:159], a[172:175], v[220:223], a[144:159]
  ds_read_b64_tr_b16 a[162:163], v15 offset:43776
  s_waitcnt lgkmcnt(8)
  s_waitcnt vmcnt(46)
  v_mfma_f32_32x32x16_bf16 a[0:15], a[176:179], v[64:67], a[0:15]
  ds_read_b64_tr_b16 a[164:165], v15 offset:46080
  s_waitcnt vmcnt(45)
  v_mfma_f32_32x32x16_bf16 a[80:95], a[176:179], v[68:71], a[80:95]
  ds_read_b64_tr_b16 a[166:167], v15 offset:48640
  s_mul_i32 s46, s45, 43
  s_lshr_b32 s46, s46, 7
  s_mul_i32 s47, s46, 3
  s_sub_u32 s47, s45, s47
  s_mul_i32 s46, s46, 98304
  s_lshl_b32 s47, s47, 12
  s_add_u32 s37, s30, s46
  s_add_u32 s37, s37, s47
  s_add_u32 s45, s45, 1
  s_cmp_eq_u32 s45, 12
  s_cselect_b32 s45, 0, s45
  buffer_load_dwordx4 v[192:195], v12, s[4:7], s37 offen offset:0
  s_waitcnt lgkmcnt(8)
  v_mfma_f32_32x32x16_bf16 a[16:31], a[180:183], v[64:67], a[16:31]
  ds_read_b64_tr_b16 a[168:169], v15 offset:46144
  v_mfma_f32_32x32x16_bf16 a[96:111], a[180:183], v[68:71], a[96:111]
  ds_read_b64_tr_b16 a[170:171], v15 offset:48704
  s_waitcnt lgkmcnt(8)
  v_mfma_f32_32x32x16_bf16 a[32:47], a[184:187], v[64:67], a[32:47]
  ds_read_b64_tr_b16 a[172:173], v15 offset:46208
  buffer_load_dwordx4 v[196:199], v13, s[4:7], s37 offen offset:0
  v_mfma_f32_32x32x16_bf16 a[112:127], a[184:187], v[68:71], a[112:127]
  ds_read_b64_tr_b16 a[174:175], v15 offset:48768
  s_waitcnt lgkmcnt(8)
  v_mfma_f32_32x32x16_bf16 a[48:63], a[188:191], v[64:67], a[48:63]
  ds_read_b64_tr_b16 a[176:177], v15 offset:46272
  v_mfma_f32_32x32x16_bf16 a[128:143], a[188:191], v[68:71], a[128:143]
  ds_read_b64_tr_b16 a[178:179], v15 offset:48832
  buffer_load_dwordx4 v[200:203], v12, s[4:7], s37 offen offset:1024
  s_waitcnt lgkmcnt(8)
  v_mfma_f32_32x32x16_bf16 a[64:79], a[160:163], v[64:67], a[64:79]
  ds_read_b64_tr_b16 a[180:181], v15 offset:46336
  v_mfma_f32_32x32x16_bf16 a[144:159], a[160:163], v[68:71], a[144:159]
  ds_read_b64_tr_b16 a[182:183], v15 offset:48896
  s_waitcnt lgkmcnt(8)
  s_waitcnt vmcnt(47)
  v_mfma_f32_32x32x16_bf16 a[0:15], a[164:167], v[72:75], a[0:15]
  ds_read_b64_tr_b16 a[184:185], v15 offset:51200
  buffer_load_dwordx4 v[204:207], v13, s[4:7], s37 offen offset:1024
  s_waitcnt vmcnt(47)
  v_mfma_f32_32x32x16_bf16 a[80:95], a[164:167], v[76:79], a[80:95]
  ds_read_b64_tr_b16 a[186:187], v15 offset:53760
  s_waitcnt lgkmcnt(8)
  v_mfma_f32_32x32x16_bf16 a[16:31], a[168:171], v[72:75], a[16:31]
  ds_read_b64_tr_b16 a[188:189], v15 offset:51264
  v_mfma_f32_32x32x16_bf16 a[96:111], a[168:171], v[76:79], a[96:111]
  ds_read_b64_tr_b16 a[190:191], v15 offset:53824
  buffer_load_dwordx4 v[208:211], v12, s[4:7], s37 offen offset:2048
  s_waitcnt lgkmcnt(8)
  v_mfma_f32_32x32x16_bf16 a[32:47], a[172:175], v[72:75], a[32:47]
  ds_read_b64_tr_b16 a[160:161], v15 offset:51328
  v_mfma_f32_32x32x16_bf16 a[112:127], a[172:175], v[76:79], a[112:127]
  ds_read_b64_tr_b16 a[162:163], v15 offset:53888
  s_waitcnt lgkmcnt(8)
  v_mfma_f32_32x32x16_bf16 a[48:63], a[176:179], v[72:75], a[48:63]
  ds_read_b64_tr_b16 a[164:165], v15 offset:51392
  buffer_load_dwordx4 v[212:215], v13, s[4:7], s37 offen offset:2048
  v_mfma_f32_32x32x16_bf16 a[128:143], a[176:179], v[76:79], a[128:143]
  ds_read_b64_tr_b16 a[166:167], v15 offset:53952
  s_waitcnt lgkmcnt(8)
  v_mfma_f32_32x32x16_bf16 a[64:79], a[180:183], v[72:75], a[64:79]
  ds_read_b64_tr_b16 a[168:169], v15 offset:51456
  v_mfma_f32_32x32x16_bf16 a[144:159], a[180:183], v[76:79], a[144:159]
  ds_read_b64_tr_b16 a[170:171], v15 offset:54016
  buffer_load_dwordx4 v[216:219], v12, s[4:7], s37 offen offset:3072
  s_waitcnt lgkmcnt(8)
  s_waitcnt vmcnt(49)
  v_mfma_f32_32x32x16_bf16 a[0:15], a[184:187], v[80:83], a[0:15]
  ds_read_b64_tr_b16 a[172:173], v15 offset:56320
  s_waitcnt vmcnt(48)
  v_mfma_f32_32x32x16_bf16 a[80:95], a[184:187], v[84:87], a[80:95]
  ds_read_b64_tr_b16 a[174:175], v15 offset:58880
  s_waitcnt lgkmcnt(8)
  v_mfma_f32_32x32x16_bf16 a[16:31], a[188:191], v[80:83], a[16:31]
  ds_read_b64_tr_b16 a[176:177], v15 offset:56384
  buffer_load_dwordx4 v[220:223], v13, s[4:7], s37 offen offset:3072
  v_mfma_f32_32x32x16_bf16 a[96:111], a[188:191], v[84:87], a[96:111]
  ds_read_b64_tr_b16 a[178:179], v15 offset:58944
  s_waitcnt lgkmcnt(8)
  v_mfma_f32_32x32x16_bf16 a[32:47], a[160:163], v[80:83], a[32:47]
  ds_read_b64_tr_b16 a[180:181], v15 offset:56448
  v_mfma_f32_32x32x16_bf16 a[112:127], a[160:163], v[84:87], a[112:127]
  ds_read_b64_tr_b16 a[182:183], v15 offset:59008
  s_waitcnt lgkmcnt(8)
  v_mfma_f32_32x32x16_bf16 a[48:63], a[164:167], v[80:83], a[48:63]
  ds_read_b64_tr_b16 a[184:185], v15 offset:56512
  v_mfma_f32_32x32x16_bf16 a[128:143], a[164:167], v[84:87], a[128:143]
  ds_read_b64_tr_b16 a[186:187], v15 offset:59072
  s_waitcnt lgkmcnt(8)
  v_mfma_f32_32x32x16_bf16 a[64:79], a[168:171], v[80:83], a[64:79]
  ds_read_b64_tr_b16 a[188:189], v15 offset:56576
  v_mfma_f32_32x32x16_bf16 a[144:159], a[168:171], v[84:87], a[144:159]
  ds_read_b64_tr_b16 a[190:191], v15 offset:59136
  s_barrier
  s_waitcnt lgkmcnt(8)
  s_waitcnt vmcnt(48)
  v_mfma_f32_32x32x16_bf16 a[0:15], a[172:175], v[88:91], a[0:15]
  ds_read_b64_tr_b16 a[160:161], v14 offset:0
  s_mul_i32 s38, s44, 81920
  s_add_u32 s38, s38, s31
  s_add_u32 s44, s44, 1
  s_cmp_eq_u32 s44, 12
  s_cselect_b32 s44, 0, s44
  s_add_u32 m0, s32, 81920
  s_nop 0
  buffer_load_dwordx4 v2, s[8:11], s38 offen offset:0 lds
  s_waitcnt vmcnt(48)
  v_mfma_f32_32x32x16_bf16 a[80:95], a[172:175], v[92:95], a[80:95]
  ds_read_b64_tr_b16 a[162:163], v14 offset:2560
  s_waitcnt lgkmcnt(8)
  v_mfma_f32_32x32x16_bf16 a[16:31], a[176:179], v[88:91], a[16:31]
  ds_read_b64_tr_b16 a[164:165], v14 offset:64
  buffer_load_dwordx4 v3, s[8:11], s38 offen offset:1024 lds
  v_mfma_f32_32x32x16_bf16 a[96:111], a[176:179], v[92:95], a[96:111]
  ds_read_b64_tr_b16 a[166:167], v14 offset:2624
  s_waitcnt lgkmcnt(8)
  v_mfma_f32_32x32x16_bf16 a[32:47], a[180:183], v[88:91], a[32:47]
  ds_read_b64_tr_b16 a[168:169], v14 offset:128
  buffer_load_dwordx4 v4, s[8:11], s38 offen offset:2048 lds
  v_mfma_f32_32x32x16_bf16 a[112:127], a[180:183], v[92:95], a[112:127]
  ds_read_b64_tr_b16 a[170:171], v14 offset:2688
  s_waitcnt lgkmcnt(8)
  v_mfma_f32_32x32x16_bf16 a[48:63], a[184:187], v[88:91], a[48:63]
  ds_read_b64_tr_b16 a[172:173], v14 offset:192
  buffer_load_dwordx4 v5, s[8:11], s38 offen offset:3072 lds
  v_mfma_f32_32x32x16_bf16 a[128:143], a[184:187], v[92:95], a[128:143]
  ds_read_b64_tr_b16 a[174:175], v14 offset:2752
  s_waitcnt lgkmcnt(8)
  v_mfma_f32_32x32x16_bf16 a[64:79], a[188:191], v[88:91], a[64:79]
  ds_read_b64_tr_b16 a[176:177], v14 offset:256
  s_add_u32 m0, s32, 86016
  s_nop 0
  buffer_load_dwordx4 v6, s[8:11], s38 offen offset:0 lds
  v_mfma_f32_32x32x16_bf16 a[144:159], a[188:191], v[92:95], a[144:159]
  ds_read_b64_tr_b16 a[178:179], v14 offset:2816
  s_waitcnt lgkmcnt(8)
  s_waitcnt vmcnt(51)
  v_mfma_f32_32x32x16_bf16 a[0:15], a[160:163], v[96:99], a[0:15]
  ds_read_b64_tr_b16 a[180:181], v14 offset:5120
  s_waitcnt vmcnt(50)
  v_mfma_f32_32x32x16_bf16 a[80:95], a[160:163], v[100:103], a[80:95]
  ds_read_b64_tr_b16 a[182:183], v14 offset:7680
  s_mul_i32 s46, s45, 43
  s_lshr_b32 s46, s46, 7
  s_mul_i32 s47, s46, 3
  s_sub_u32 s47, s45, s47
  s_mul_i32 s46, s46, 98304
  s_lshl_b32 s47, s47, 12
  s_add_u32 s37, s30, s46
  s_add_u32 s37, s37, s47
  s_add_u32 s45, s45, 1
  s_cmp_eq_u32 s45, 12
  s_cselect_b32 s45, 0, s45
  buffer_load_dwordx4 v[64:67], v12, s[4:7], s37 offen offset:0
  s_waitcnt lgkmcnt(8)
  v_mfma_f32_32x32x16_bf16 a[16:31], a[164:167], v[96:99], a[16:31]
  ds_read_b64_tr_b16 a[184:185], v14 offset:5184
  v_mfma_f32_32x32x16_bf16 a[96:111], a[164:167], v[100:103], a[96:111]
  ds_read_b64_tr_b16 a[186:187], v14 offset:7744
  s_waitcnt lgkmcnt(8)
  v_mfma_f32_32x32x16_bf16 a[32:47], a[168:171], v[96:99], a[32:47]
  ds_read_b64_tr_b16 a[188:189], v14 offset:5248
  buffer_load_dwordx4 v[68:71], v13, s[4:7], s37 offen offset:0
  v_mfma_f32_32x32x16_bf16 a[112:127], a[168:171], v[100:103], a[112:127]
  ds_read_b64_tr_b16 a[190:191], v14 offset:7808
  s_waitcnt lgkmcnt(8)
  v_mfma_f32_32x32x16_bf16 a[48:63], a[172:175], v[96:99], a[48:63]
  ds_read_b64_tr_b16 a[160:161], v14 offset:5312
  v_mfma_f32_32x32x16_bf16 a[128:143], a[172:175], v[100:103], a[128:143]
  ds_read_b64_tr_b16 a[162:163], v14 offset:7872
  buffer_load_dwordx4 v[72:75], v12, s[4:7], s37 offen offset:1024
  s_waitcnt lgkmcnt(8)
  v_mfma_f32_32x32x16_bf16 a[64:79], a[176:179], v[96:99], a[64:79]
  ds_read_b64_tr_b16 a[164:165], v14 offset:5376
  v_mfma_f32_32x32x16_bf16 a[144:159], a[176:179], v[100:103], a[144:159]
  ds_read_b64_tr_b16 a[166:167], v14 offset:7936
  s_waitcnt lgkmcnt(8)
  s_waitcnt vmcnt(52)
  v_mfma_f32_32x32x16_bf16 a[0:15], a[180:183], v[104:107], a[0:15]
  ds_read_b64_tr_b16 a[168:169], v14 offset:10240
  buffer_load_dwordx4 v[76:79], v13, s[4:7], s37 offen offset:1024
  s_waitcnt vmcnt(52)
  v_mfma_f32_32x32x16_bf16 a[80:95], a[180:183], v[108:111], a[80:95]
  ds_read_b64_tr_b16 a[170:171], v14 offset:12800
  s_waitcnt lgkmcnt(8)
  v_mfma_f32_32x32x16_bf16 a[16:31], a[184:187], v[104:107], a[16:31]
  ds_read_b64_tr_b16 a[172:173], v14 offset:10304
  v_mfma_f32_32x32x16_bf16 a[96:111], a[184:187], v[108:111], a[96:111]
  ds_read_b64_tr_b16 a[174:175], v14 offset:12864
  buffer_load_dwordx4 v[80:83], v12, s[4:7], s37 offen offset:2048
  s_waitcnt lgkmcnt(8)
  v_mfma_f32_32x32x16_bf16 a[32:47], a[188:191], v[104:107], a[32:47]
  ds_read_b64_tr_b16 a[176:177], v14 offset:10368
  v_mfma_f32_32x32x16_bf16 a[112:127], a[188:191], v[108:111], a[112:127]
  ds_read_b64_tr_b16 a[178:179], v14 offset:12928
  s_waitcnt lgkmcnt(8)
  v_mfma_f32_32x32x16_bf16 a[48:63], a[160:163], v[104:107], a[48:63]
  ds_read_b64_tr_b16 a[180:181], v14 offset:10432
  buffer_load_dwordx4 v[84:87], v13, s[4:7], s37 offen offset:2048
  v_mfma_f32_32x32x16_bf16 a[128:143], a[160:163], v[108:111], a[128:143]
  ds_read_b64_tr_b16 a[182:183], v14 offset:12992
  s_waitcnt lgkmcnt(8)
  v_mfma_f32_32x32x16_bf16 a[64:79], a[164:167], v[104:107], a[64:79]
  ds_read_b64_tr_b16 a[184:185], v14 offset:10496
  v_mfma_f32_32x32x16_bf16 a[144:159], a[164:167], v[108:111], a[144:159]
  ds_read_b64_tr_b16 a[186:187], v14 offset:13056
  buffer_load_dwordx4 v[88:91], v12, s[4:7], s37 offen offset:3072
  s_waitcnt lgkmcnt(8)
  s_waitcnt vmcnt(54)
  v_mfma_f32_32x32x16_bf16 a[0:15], a[168:171], v[112:115], a[0:15]
  ds_read_b64_tr_b16 a[188:189], v14 offset:15360
  s_waitcnt vmcnt(53)
  v_mfma_f32_32x32x16_bf16 a[80:95], a[168:171], v[116:119], a[80:95]
  ds_read_b64_tr_b16 a[190:191], v14 offset:17920
  s_waitcnt lgkmcnt(8)
  v_mfma_f32_32x32x16_bf16 a[16:31], a[172:175], v[112:115], a[16:31]
  ds_read_b64_tr_b16 a[160:161], v14 offset:15424
  buffer_load_dwordx4 v[92:95], v13, s[4:7], s37 offen offset:3072
  v_mfma_f32_32x32x16_bf16 a[96:111], a[172:175], v[116:119], a[96:111]
  ds_read_b64_tr_b16 a[162:163], v14 offset:17984
  s_waitcnt lgkmcnt(8)
  v_mfma_f32_32x32x16_bf16 a[32:47], a[176:179], v[112:115], a[32:47]
  ds_read_b64_tr_b16 a[164:165], v14 offset:15488
  v_mfma_f32_32x32x16_bf16 a[112:127], a[176:179], v[116:119], a[112:127]
  ds_read_b64_tr_b16 a[166:167], v14 offset:18048
  s_waitcnt lgkmcnt(8)
  v_mfma_f32_32x32x16_bf16 a[48:63], a[180:183], v[112:115], a[48:63]
  ds_read_b64_tr_b16 a[168:169], v14 offset:15552
  v_mfma_f32_32x32x16_bf16 a[128:143], a[180:183], v[116:119], a[128:143]
  ds_read_b64_tr_b16 a[170:171], v14 offset:18112
  s_waitcnt lgkmcnt(8)
  v_mfma_f32_32x32x16_bf16 a[64:79], a[184:187], v[112:115], a[64:79]
  ds_read_b64_tr_b16 a[172:173], v14 offset:15616
  v_mfma_f32_32x32x16_bf16 a[144:159], a[184:187], v[116:119], a[144:159]
  ds_read_b64_tr_b16 a[174:175], v14 offset:18176
  s_waitcnt vmcnt(47)
  s_barrier
  s_waitcnt lgkmcnt(8)
  v_mfma_f32_32x32x16_bf16 a[0:15], a[188:191], v[120:123], a[0:15]
  ds_read_b64_tr_b16 a[176:177], v14 offset:20480
  s_mul_i32 s38, s44, 81920
  s_add_u32 s38, s38, s31
  s_add_u32 s44, s44, 1
  s_cmp_eq_u32 s44, 12
  s_cselect_b32 s44, 0, s44
  s_add_u32 m0, s32, 102400
  s_nop 0
  buffer_load_dwordx4 v2, s[8:11], s38 offen offset:0 lds
  v_mfma_f32_32x32x16_bf16 a[80:95], a[188:191], v[124:127], a[80:95]
  ds_read_b64_tr_b16 a[178:179], v14 offset:23040
  s_waitcnt lgkmcnt(8)
  v_mfma_f32_32x32x16_bf16 a[16:31], a[160:163], v[120:123], a[16:31]
  ds_read_b64_tr_b16 a[180:181], v14 offset:20544
  buffer_load_dwordx4 v3, s[8:11], s38 offen offset:1024 lds
  v_mfma_f32_32x32x16_bf16 a[96:111], a[160:163], v[124:127], a[96:111]
  ds_read_b64_tr_b16 a[182:183], v14 offset:23104
  s_waitcnt lgkmcnt(8)
  v_mfma_f32_32x32x16_bf16 a[32:47], a[164:167], v[120:123], a[32:47]
  ds_read_b64_tr_b16 a[184:185], v14 offset:20608
  buffer_load_dwordx4 v4, s[8:11], s38 offen offset:2048 lds
  v_mfma_f32_32x32x16_bf16 a[112:127], a[164:167], v[124:127], a[112:127]
  ds_read_b64_tr_b16 a[186:187], v14 offset:23168
  s_waitcnt lgkmcnt(8)
  v_mfma_f32_32x32x16_bf16 a[48:63], a[168:171], v[120:123], a[48:63]
  ds_read_b64_tr_b16 a[188:189], v14 offset:20672
  buffer_load_dwordx4 v5, s[8:11], s38 offen offset:3072 lds
  v_mfma_f32_32x32x16_bf16 a[128:143], a[168:171], v[124:127], a[128:143]
  ds_read_b64_tr_b16 a[190:191], v14 offset:23232
  s_waitcnt lgkmcnt(8)
  v_mfma_f32_32x32x16_bf16 a[64:79], a[172:175], v[120:123], a[64:79]
  ds_read_b64_tr_b16 a[160:161], v14 offset:20736
  s_add_u32 m0, s32, 106496
  s_nop 0
  buffer_load_dwordx4 v6, s[8:11], s38 offen offset:0 lds
  v_mfma_f32_32x32x16_bf16 a[144:159], a[172:175], v[124:127], a[144:159]
  ds_read_b64_tr_b16 a[162:163], v14 offset:23296
  s_waitcnt lgkmcnt(8)
  s_waitcnt vmcnt(51)
  v_mfma_f32_32x32x16_bf16 a[0:15], a[176:179], v[128:131], a[0:15]
  ds_read_b64_tr_b16 a[164:165], v14 offset:25600
  s_waitcnt vmcnt(50)
  v_mfma_f32_32x32x16_bf16 a[80:95], a[176:179], v[132:135], a[80:95]
  ds_read_b64_tr_b16 a[166:167], v14 offset:28160
  s_mul_i32 s46, s45, 43
  s_lshr_b32 s46, s46, 7
  s_mul_i32 s47, s46, 3
  s_sub_u32 s47, s45, s47
  s_mul_i32 s46, s46, 98304
  s_lshl_b32 s47, s47, 12
  s_add_u32 s37, s30, s46
  s_add_u32 s37, s37, s47
  s_add_u32 s45, s45, 1
  s_cmp_eq_u32 s45, 12
  s_cselect_b32 s45, 0, s45
  buffer_load_dwordx4 v[96:99], v12, s[4:7], s37 offen offset:0
  s_waitcnt lgkmcnt(8)
  v_mfma_f32_32x32x16_bf16 a[16:31], a[180:183], v[128:131], a[16:31]
  ds_read_b64_tr_b16 a[168:169], v14 offset:25664
  v_mfma_f32_32x32x16_bf16 a[96:111], a[180:183], v[132:135], a[96:111]
  ds_read_b64_tr_b16 a[170:171], v14 offset:28224
  s_waitcnt lgkmcnt(8)
  v_mfma_f32_32x32x16_bf16 a[32:47], a[184:187], v[128:131], a[32:47]
  ds_read_b64_tr_b16 a[172:173], v14 offset:25728
  buffer_load_dwordx4 v[100:103], v13, s[4:7], s37 offen offset:0
  v_mfma_f32_32x32x16_bf16 a[112:127], a[184:187], v[132:135], a[112:127]
  ds_read_b64_tr_b16 a[174:175], v14 offset:28288
  s_waitcnt lgkmcnt(8)
  v_mfma_f32_32x32x16_bf16 a[48:63], a[188:191], v[128:131], a[48:63]
  ds_read_b64_tr_b16 a[176:177], v14 offset:25792
  v_mfma_f32_32x32x16_bf16 a[128:143], a[188:191], v[132:135], a[128:143]
  ds_read_b64_tr_b16 a[178:179], v14 offset:28352
  buffer_load_dwordx4 v[104:107], v12, s[4:7], s37 offen offset:1024
  s_waitcnt lgkmcnt(8)
  v_mfma_f32_32x32x16_bf16 a[64:79], a[160:163], v[128:131], a[64:79]
  ds_read_b64_tr_b16 a[180:181], v14 offset:25856
  v_mfma_f32_32x32x16_bf16 a[144:159], a[160:163], v[132:135], a[144:159]
  ds_read_b64_tr_b16 a[182:183], v14 offset:28416
  s_waitcnt lgkmcnt(8)
  s_waitcnt vmcnt(52)
  v_mfma_f32_32x32x16_bf16 a[0:15], a[164:167], v[136:139], a[0:15]
  ds_read_b64_tr_b16 a[184:185], v14 offset:30720
  buffer_load_dwordx4 v[108:111], v13, s[4:7], s37 offen offset:1024
  s_waitcnt vmcnt(52)
  v_mfma_f32_32x32x16_bf16 a[80:95], a[164:167], v[140:143], a[80:95]
  ds_read_b64_tr_b16 a[186:187], v14 offset:33280
  s_waitcnt lgkmcnt(8)
  v_mfma_f32_32x32x16_bf16 a[16:31], a[168:171], v[136:139], a[16:31]
  ds_read_b64_tr_b16 a[188:189], v14 offset:30784
  v_mfma_f32_32x32x16_bf16 a[96:111], a[168:171], v[140:143], a[96:111]
  ds_read_b64_tr_b16 a[190:191], v14 offset:33344
  buffer_load_dwordx4 v[112:115], v12, s[4:7], s37 offen offset:2048
  s_waitcnt lgkmcnt(8)
  v_mfma_f32_32x32x16_bf16 a[32:47], a[172:175], v[136:139], a[32:47]
  ds_read_b64_tr_b16 a[160:161], v14 offset:30848
  v_mfma_f32_32x32x16_bf16 a[112:127], a[172:175], v[140:143], a[112:127]
  ds_read_b64_tr_b16 a[162:163], v14 offset:33408
  s_waitcnt lgkmcnt(8)
  v_mfma_f32_32x32x16_bf16 a[48:63], a[176:179], v[136:139], a[48:63]
  ds_read_b64_tr_b16 a[164:165], v14 offset:30912
  buffer_load_dwordx4 v[116:119], v13, s[4:7], s37 offen offset:2048
  v_mfma_f32_32x32x16_bf16 a[128:143], a[176:179], v[140:143], a[128:143]
  ds_read_b64_tr_b16 a[166:167], v14 offset:33472
  s_waitcnt lgkmcnt(8)
  v_mfma_f32_32x32x16_bf16 a[64:79], a[180:183], v[136:139], a[64:79]
  ds_read_b64_tr_b16 a[168:169], v14 offset:30976
  v_mfma_f32_32x32x16_bf16 a[144:159], a[180:183], v[140:143], a[144:159]
  ds_read_b64_tr_b16 a[170:171], v14 offset:33536
  buffer_load_dwordx4 v[120:123], v12, s[4:7], s37 offen offset:3072
  s_waitcnt lgkmcnt(8)
  s_waitcnt vmcnt(54)
  v_mfma_f32_32x32x16_bf16 a[0:15], a[184:187], v[144:147], a[0:15]
  ds_read_b64_tr_b16 a[172:173], v14 offset:35840
  s_waitcnt vmcnt(53)
  v_mfma_f32_32x32x16_bf16 a[80:95], a[184:187], v[148:151], a[80:95]
  ds_read_b64_tr_b16 a[174:175], v14 offset:38400
  s_waitcnt lgkmcnt(8)
  v_mfma_f32_32x32x16_bf16 a[16:31], a[188:191], v[144:147], a[16:31]
  ds_read_b64_tr_b16 a[176:177], v14 offset:35904
  buffer_load_dwordx4 v[124:127], v13, s[4:7], s37 offen offset:3072
  v_mfma_f32_32x32x16_bf16 a[96:111], a[188:191], v[148:151], a[96:111]
  ds_read_b64_tr_b16 a[178:179], v14 offset:38464
  s_waitcnt lgkmcnt(8)
  v_mfma_f32_32x32x16_bf16 a[32:47], a[160:163], v[144:147], a[32:47]
  ds_read_b64_tr_b16 a[180:181], v14 offset:35968
  v_mfma_f32_32x32x16_bf16 a[112:127], a[160:163], v[148:151], a[112:127]
  ds_read_b64_tr_b16 a[182:183], v14 offset:38528
  s_waitcnt lgkmcnt(8)
  v_mfma_f32_32x32x16_bf16 a[48:63], a[164:167], v[144:147], a[48:63]
  ds_read_b64_tr_b16 a[184:185], v14 offset:36032
  v_mfma_f32_32x32x16_bf16 a[128:143], a[164:167], v[148:151], a[128:143]
  ds_read_b64_tr_b16 a[186:187], v14 offset:38592
  s_waitcnt lgkmcnt(8)
  v_mfma_f32_32x32x16_bf16 a[64:79], a[168:171], v[144:147], a[64:79]
  ds_read_b64_tr_b16 a[188:189], v14 offset:36096
  v_mfma_f32_32x32x16_bf16 a[144:159], a[168:171], v[148:151], a[144:159]
  ds_read_b64_tr_b16 a[190:191], v14 offset:38656
  s_waitcnt vmcnt(47)
  s_barrier
  s_waitcnt lgkmcnt(8)
  v_mfma_f32_32x32x16_bf16 a[0:15], a[172:175], v[152:155], a[0:15]
  ds_read_b64_tr_b16 a[160:161], v14 offset:40960
  v_mfma_f32_32x32x16_bf16 a[80:95], a[172:175], v[156:159], a[80:95]
  ds_read_b64_tr_b16 a[162:163], v14 offset:43520
  s_waitcnt lgkmcnt(8)
  v_mfma_f32_32x32x16_bf16 a[16:31], a[176:179], v[152:155], a[16:31]
  ds_read_b64_tr_b16 a[164:165], v14 offset:41024
  v_mfma_f32_32x32x16_bf16 a[96:111], a[176:179], v[156:159], a[96:111]
  ds_read_b64_tr_b16 a[166:167], v14 offset:43584
  s_waitcnt lgkmcnt(8)
  v_mfma_f32_32x32x16_bf16 a[32:47], a[180:183], v[152:155], a[32:47]
  ds_read_b64_tr_b16 a[168:169], v14 offset:41088
  v_mfma_f32_32x32x16_bf16 a[112:127], a[180:183], v[156:159], a[112:127]
  ds_read_b64_tr_b16 a[170:171], v14 offset:43648
  s_waitcnt lgkmcnt(8)
  v_mfma_f32_32x32x16_bf16 a[48:63], a[184:187], v[152:155], a[48:63]
  ds_read_b64_tr_b16 a[172:173], v14 offset:41152
  v_mfma_f32_32x32x16_bf16 a[128:143], a[184:187], v[156:159], a[128:143]
  ds_read_b64_tr_b16 a[174:175], v14 offset:43712
  s_waitcnt lgkmcnt(8)
  v_mfma_f32_32x32x16_bf16 a[64:79], a[188:191], v[152:155], a[64:79]
  ds_read_b64_tr_b16 a[176:177], v14 offset:41216
  v_mfma_f32_32x32x16_bf16 a[144:159], a[188:191], v[156:159], a[144:159]
  ds_read_b64_tr_b16 a[178:179], v14 offset:43776
  s_waitcnt lgkmcnt(8)
  s_waitcnt vmcnt(46)
  v_mfma_f32_32x32x16_bf16 a[0:15], a[160:163], v[160:163], a[0:15]
  ds_read_b64_tr_b16 a[180:181], v14 offset:46080
  s_waitcnt vmcnt(45)
  v_mfma_f32_32x32x16_bf16 a[80:95], a[160:163], v[164:167], a[80:95]
  ds_read_b64_tr_b16 a[182:183], v14 offset:48640
  s_waitcnt lgkmcnt(8)
  v_mfma_f32_32x32x16_bf16 a[16:31], a[164:167], v[160:163], a[16:31]
  ds_read_b64_tr_b16 a[184:185], v14 offset:46144
  v_mfma_f32_32x32x16_bf16 a[96:111], a[164:167], v[164:167], a[96:111]
  ds_read_b64_tr_b16 a[186:187], v14 offset:48704
  s_waitcnt lgkmcnt(8)
  v_mfma_f32_32x32x16_bf16 a[32:47], a[168:171], v[160:163], a[32:47]
  ds_read_b64_tr_b16 a[188:189], v14 offset:46208
  v_mfma_f32_32x32x16_bf16 a[112:127], a[168:171], v[164:167], a[112:127]
  ds_read_b64_tr_b16 a[190:191], v14 offset:48768
  s_waitcnt lgkmcnt(8)
  v_mfma_f32_32x32x16_bf16 a[48:63], a[172:175], v[160:163], a[48:63]
  ds_read_b64_tr_b16 a[160:161], v14 offset:46272
  v_mfma_f32_32x32x16_bf16 a[128:143], a[172:175], v[164:167], a[128:143]
  ds_read_b64_tr_b16 a[162:163], v14 offset:48832
  s_waitcnt lgkmcnt(8)
  v_mfma_f32_32x32x16_bf16 a[64:79], a[176:179], v[160:163], a[64:79]
  ds_read_b64_tr_b16 a[164:165], v14 offset:46336
  v_mfma_f32_32x32x16_bf16 a[144:159], a[176:179], v[164:167], a[144:159]
  ds_read_b64_tr_b16 a[166:167], v14 offset:48896
  s_waitcnt lgkmcnt(8)
  s_waitcnt vmcnt(44)
  v_mfma_f32_32x32x16_bf16 a[0:15], a[180:183], v[168:171], a[0:15]
  ds_read_b64_tr_b16 a[168:169], v14 offset:51200
  s_waitcnt vmcnt(43)
  v_mfma_f32_32x32x16_bf16 a[80:95], a[180:183], v[172:175], a[80:95]
  ds_read_b64_tr_b16 a[170:171], v14 offset:53760
  s_waitcnt lgkmcnt(8)
  v_mfma_f32_32x32x16_bf16 a[16:31], a[184:187], v[168:171], a[16:31]
  ds_read_b64_tr_b16 a[172:173], v14 offset:51264
  v_mfma_f32_32x32x16_bf16 a[96:111], a[184:187], v[172:175], a[96:111]
  ds_read_b64_tr_b16 a[174:175], v14 offset:53824
  s_waitcnt lgkmcnt(8)
  v_mfma_f32_32x32x16_bf16 a[32:47], a[188:191], v[168:171], a[32:47]
  ds_read_b64_tr_b16 a[176:177], v14 offset:51328
  v_mfma_f32_32x32x16_bf16 a[112:127], a[188:191], v[172:175], a[112:127]
  ds_read_b64_tr_b16 a[178:179], v14 offset:53888
  s_waitcnt lgkmcnt(8)
  v_mfma_f32_32x32x16_bf16 a[48:63], a[160:163], v[168:171], a[48:63]
  ds_read_b64_tr_b16 a[180:181], v14 offset:51392
  v_mfma_f32_32x32x16_bf16 a[128:143], a[160:163], v[172:175], a[128:143]
  ds_read_b64_tr_b16 a[182:183], v14 offset:53952
  s_waitcnt lgkmcnt(8)
  v_mfma_f32_32x32x16_bf16 a[64:79], a[164:167], v[168:171], a[64:79]
  ds_read_b64_tr_b16 a[184:185], v14 offset:51456
  v_mfma_f32_32x32x16_bf16 a[144:159], a[164:167], v[172:175], a[144:159]
  ds_read_b64_tr_b16 a[186:187], v14 offset:54016
  s_waitcnt lgkmcnt(8)
  s_waitcnt vmcnt(42)
  v_mfma_f32_32x32x16_bf16 a[0:15], a[168:171], v[176:179], a[0:15]
  ds_read_b64_tr_b16 a[188:189], v14 offset:56320
  s_waitcnt vmcnt(41)
  v_mfma_f32_32x32x16_bf16 a[80:95], a[168:171], v[180:183], a[80:95]
  ds_read_b64_tr_b16 a[190:191], v14 offset:58880
  s_waitcnt lgkmcnt(8)
  v_mfma_f32_32x32x16_bf16 a[16:31], a[172:175], v[176:179], a[16:31]
  ds_read_b64_tr_b16 a[160:161], v14 offset:56384
  v_mfma_f32_32x32x16_bf16 a[96:111], a[172:175], v[180:183], a[96:111]
  ds_read_b64_tr_b16 a[162:163], v14 offset:58944
  s_waitcnt lgkmcnt(8)
  v_mfma_f32_32x32x16_bf16 a[32:47], a[176:179], v[176:179], a[32:47]
  ds_read_b64_tr_b16 a[164:165], v14 offset:56448
  v_mfma_f32_32x32x16_bf16 a[112:127], a[176:179], v[180:183], a[112:127]
  ds_read_b64_tr_b16 a[166:167], v14 offset:59008
  s_waitcnt lgkmcnt(8)
  v_mfma_f32_32x32x16_bf16 a[48:63], a[180:183], v[176:179], a[48:63]
  ds_read_b64_tr_b16 a[168:169], v14 offset:56512
  v_mfma_f32_32x32x16_bf16 a[128:143], a[180:183], v[180:183], a[128:143]
  ds_read_b64_tr_b16 a[170:171], v14 offset:59072
  s_waitcnt lgkmcnt(8)
  v_mfma_f32_32x32x16_bf16 a[64:79], a[184:187], v[176:179], a[64:79]
  ds_read_b64_tr_b16 a[172:173], v14 offset:56576
  v_mfma_f32_32x32x16_bf16 a[144:159], a[184:187], v[180:183], a[144:159]
  ds_read_b64_tr_b16 a[174:175], v14 offset:59136
  s_waitcnt vmcnt(34)
  s_barrier
  s_waitcnt lgkmcnt(8)
  v_mfma_f32_32x32x16_bf16 a[0:15], a[188:191], v[184:187], a[0:15]
  ds_read_b64_tr_b16 a[176:177], v15 offset:0
  v_mfma_f32_32x32x16_bf16 a[80:95], a[188:191], v[188:191], a[80:95]
  ds_read_b64_tr_b16 a[178:179], v15 offset:2560
  s_waitcnt lgkmcnt(8)
  v_mfma_f32_32x32x16_bf16 a[16:31], a[160:163], v[184:187], a[16:31]
  ds_read_b64_tr_b16 a[180:181], v15 offset:64
  v_mfma_f32_32x32x16_bf16 a[96:111], a[160:163], v[188:191], a[96:111]
  ds_read_b64_tr_b16 a[182:183], v15 offset:2624
  s_waitcnt lgkmcnt(8)
  v_mfma_f32_32x32x16_bf16 a[32:47], a[164:167], v[184:187], a[32:47]
  ds_read_b64_tr_b16 a[184:185], v15 offset:128
  v_mfma_f32_32x32x16_bf16 a[112:127], a[164:167], v[188:191], a[112:127]
  ds_read_b64_tr_b16 a[186:187], v15 offset:2688
  s_waitcnt lgkmcnt(8)
  v_mfma_f32_32x32x16_bf16 a[48:63], a[168:171], v[184:187], a[48:63]
  ds_read_b64_tr_b16 a[188:189], v15 offset:192
  v_mfma_f32_32x32x16_bf16 a[128:143], a[168:171], v[188:191], a[128:143]
  ds_read_b64_tr_b16 a[190:191], v15 offset:2752
  s_waitcnt lgkmcnt(8)
  v_mfma_f32_32x32x16_bf16 a[64:79], a[172:175], v[184:187], a[64:79]
  ds_read_b64_tr_b16 a[160:161], v15 offset:256
  v_mfma_f32_32x32x16_bf16 a[144:159], a[172:175], v[188:191], a[144:159]
  ds_read_b64_tr_b16 a[162:163], v15 offset:2816
  s_waitcnt lgkmcnt(8)
  s_waitcnt vmcnt(33)
  v_mfma_f32_32x32x16_bf16 a[0:15], a[176:179], v[192:195], a[0:15]
  ds_read_b64_tr_b16 a[164:165], v15 offset:5120
  s_waitcnt vmcnt(32)
  v_mfma_f32_32x32x16_bf16 a[80:95], a[176:179], v[196:199], a[80:95]
  ds_read_b64_tr_b16 a[166:167], v15 offset:7680
  s_waitcnt lgkmcnt(8)
  v_mfma_f32_32x32x16_bf16 a[16:31], a[180:183], v[192:195], a[16:31]
  ds_read_b64_tr_b16 a[168:169], v15 offset:5184
  v_mfma_f32_32x32x16_bf16 a[96:111], a[180:183], v[196:199], a[96:111]
  ds_read_b64_tr_b16 a[170:171], v15 offset:7744
  s_waitcnt lgkmcnt(8)
  v_mfma_f32_32x32x16_bf16 a[32:47], a[184:187], v[192:195], a[32:47]
  ds_read_b64_tr_b16 a[172:173], v15 offset:5248
  v_mfma_f32_32x32x16_bf16 a[112:127], a[184:187], v[196:199], a[112:127]
  ds_read_b64_tr_b16 a[174:175], v15 offset:7808
  s_waitcnt lgkmcnt(8)
  v_mfma_f32_32x32x16_bf16 a[48:63], a[188:191], v[192:195], a[48:63]
  ds_read_b64_tr_b16 a[176:177], v15 offset:5312
  v_mfma_f32_32x32x16_bf16 a[128:143], a[188:191], v[196:199], a[128:143]
  ds_read_b64_tr_b16 a[178:179], v15 offset:7872
  s_waitcnt lgkmcnt(8)
  v_mfma_f32_32x32x16_bf16 a[64:79], a[160:163], v[192:195], a[64:79]
  ds_read_b64_tr_b16 a[180:181], v15 offset:5376
  v_mfma_f32_32x32x16_bf16 a[144:159], a[160:163], v[196:199], a[144:159]
  ds_read_b64_tr_b16 a[182:183], v15 offset:7936
  s_waitcnt lgkmcnt(8)
  s_waitcnt vmcnt(31)
  v_mfma_f32_32x32x16_bf16 a[0:15], a[164:167], v[200:203], a[0:15]
  ds_read_b64_tr_b16 a[184:185], v15 offset:10240
  s_waitcnt vmcnt(30)
  v_mfma_f32_32x32x16_bf16 a[80:95], a[164:167], v[204:207], a[80:95]
  ds_read_b64_tr_b16 a[186:187], v15 offset:12800
  s_waitcnt lgkmcnt(8)
  v_mfma_f32_32x32x16_bf16 a[16:31], a[168:171], v[200:203], a[16:31]
  ds_read_b64_tr_b16 a[188:189], v15 offset:10304
  v_mfma_f32_32x32x16_bf16 a[96:111], a[168:171], v[204:207], a[96:111]
  ds_read_b64_tr_b16 a[190:191], v15 offset:12864
  s_waitcnt lgkmcnt(8)
  v_mfma_f32_32x32x16_bf16 a[32:47], a[172:175], v[200:203], a[32:47]
  ds_read_b64_tr_b16 a[160:161], v15 offset:10368
  v_mfma_f32_32x32x16_bf16 a[112:127], a[172:175], v[204:207], a[112:127]
  ds_read_b64_tr_b16 a[162:163], v15 offset:12928
  s_waitcnt lgkmcnt(8)
  v_mfma_f32_32x32x16_bf16 a[48:63], a[176:179], v[200:203], a[48:63]
  ds_read_b64_tr_b16 a[164:165], v15 offset:10432
  v_mfma_f32_32x32x16_bf16 a[128:143], a[176:179], v[204:207], a[128:143]
  ds_read_b64_tr_b16 a[166:167], v15 offset:12992
  s_waitcnt lgkmcnt(8)
  v_mfma_f32_32x32x16_bf16 a[64:79], a[180:183], v[200:203], a[64:79]
  ds_read_b64_tr_b16 a[168:169], v15 offset:10496
  v_mfma_f32_32x32x16_bf16 a[144:159], a[180:183], v[204:207], a[144:159]
  ds_read_b64_tr_b16 a[170:171], v15 offset:13056
  s_waitcnt lgkmcnt(8)
  s_waitcnt vmcnt(29)
  v_mfma_f32_32x32x16_bf16 a[0:15], a[184:187], v[208:211], a[0:15]
  ds_read_b64_tr_b16 a[172:173], v15 offset:15360
  s_waitcnt vmcnt(28)
  v_mfma_f32_32x32x16_bf16 a[80:95], a[184:187], v[212:215], a[80:95]
  ds_read_b64_tr_b16 a[174:175], v15 offset:17920
  s_waitcnt lgkmcnt(8)
  v_mfma_f32_32x32x16_bf16 a[16:31], a[188:191], v[208:211], a[16:31]
  ds_read_b64_tr_b16 a[176:177], v15 offset:15424
  v_mfma_f32_32x32x16_bf16 a[96:111], a[188:191], v[212:215], a[96:111]
  ds_read_b64_tr_b16 a[178:179], v15 offset:17984
  s_waitcnt lgkmcnt(8)
  v_mfma_f32_32x32x16_bf16 a[32:47], a[160:163], v[208:211], a[32:47]
  ds_read_b64_tr_b16 a[180:181], v15 offset:15488
  v_mfma_f32_32x32x16_bf16 a[112:127], a[160:163], v[212:215], a[112:127]
  ds_read_b64_tr_b16 a[182:183], v15 offset:18048
  s_waitcnt lgkmcnt(8)
  v_mfma_f32_32x32x16_bf16 a[48:63], a[164:167], v[208:211], a[48:63]
  ds_read_b64_tr_b16 a[184:185], v15 offset:15552
  v_mfma_f32_32x32x16_bf16 a[128:143], a[164:167], v[212:215], a[128:143]
  ds_read_b64_tr_b16 a[186:187], v15 offset:18112
  s_waitcnt lgkmcnt(8)
  v_mfma_f32_32x32x16_bf16 a[64:79], a[168:171], v[208:211], a[64:79]
  ds_read_b64_tr_b16 a[188:189], v15 offset:15616
  v_mfma_f32_32x32x16_bf16 a[144:159], a[168:171], v[212:215], a[144:159]
  ds_read_b64_tr_b16 a[190:191], v15 offset:18176
  s_waitcnt vmcnt(21)
  s_barrier
  s_waitcnt lgkmcnt(8)
  v_mfma_f32_32x32x16_bf16 a[0:15], a[172:175], v[216:219], a[0:15]
  ds_read_b64_tr_b16 a[160:161], v15 offset:20480
  v_mfma_f32_32x32x16_bf16 a[80:95], a[172:175], v[220:223], a[80:95]
  ds_read_b64_tr_b16 a[162:163], v15 offset:23040
  s_waitcnt lgkmcnt(8)
  v_mfma_f32_32x32x16_bf16 a[16:31], a[176:179], v[216:219], a[16:31]
  ds_read_b64_tr_b16 a[164:165], v15 offset:20544
  v_mfma_f32_32x32x16_bf16 a[96:111], a[176:179], v[220:223], a[96:111]
  ds_read_b64_tr_b16 a[166:167], v15 offset:23104
  s_waitcnt lgkmcnt(8)
  v_mfma_f32_32x32x16_bf16 a[32:47], a[180:183], v[216:219], a[32:47]
  ds_read_b64_tr_b16 a[168:169], v15 offset:20608
  v_mfma_f32_32x32x16_bf16 a[112:127], a[180:183], v[220:223], a[112:127]
  ds_read_b64_tr_b16 a[170:171], v15 offset:23168
  s_waitcnt lgkmcnt(8)
  v_mfma_f32_32x32x16_bf16 a[48:63], a[184:187], v[216:219], a[48:63]
  ds_read_b64_tr_b16 a[172:173], v15 offset:20672
  v_mfma_f32_32x32x16_bf16 a[128:143], a[184:187], v[220:223], a[128:143]
  ds_read_b64_tr_b16 a[174:175], v15 offset:23232
  s_waitcnt lgkmcnt(8)
  v_mfma_f32_32x32x16_bf16 a[64:79], a[188:191], v[216:219], a[64:79]
  ds_read_b64_tr_b16 a[176:177], v15 offset:20736
  v_mfma_f32_32x32x16_bf16 a[144:159], a[188:191], v[220:223], a[144:159]
  ds_read_b64_tr_b16 a[178:179], v15 offset:23296
  s_waitcnt lgkmcnt(8)
  s_waitcnt vmcnt(20)
  v_mfma_f32_32x32x16_bf16 a[0:15], a[160:163], v[64:67], a[0:15]
  ds_read_b64_tr_b16 a[180:181], v15 offset:25600
  s_waitcnt vmcnt(19)
  v_mfma_f32_32x32x16_bf16 a[80:95], a[160:163], v[68:71], a[80:95]
  ds_read_b64_tr_b16 a[182:183], v15 offset:28160
  s_waitcnt lgkmcnt(8)
  v_mfma_f32_32x32x16_bf16 a[16:31], a[164:167], v[64:67], a[16:31]
  ds_read_b64_tr_b16 a[184:185], v15 offset:25664
  v_mfma_f32_32x32x16_bf16 a[96:111], a[164:167], v[68:71], a[96:111]
  ds_read_b64_tr_b16 a[186:187], v15 offset:28224
  s_waitcnt lgkmcnt(8)
  v_mfma_f32_32x32x16_bf16 a[32:47], a[168:171], v[64:67], a[32:47]
  ds_read_b64_tr_b16 a[188:189], v15 offset:25728
  v_mfma_f32_32x32x16_bf16 a[112:127], a[168:171], v[68:71], a[112:127]
  ds_read_b64_tr_b16 a[190:191], v15 offset:28288
  s_waitcnt lgkmcnt(8)
  v_mfma_f32_32x32x16_bf16 a[48:63], a[172:175], v[64:67], a[48:63]
  ds_read_b64_tr_b16 a[160:161], v15 offset:25792
  v_mfma_f32_32x32x16_bf16 a[128:143], a[172:175], v[68:71], a[128:143]
  ds_read_b64_tr_b16 a[162:163], v15 offset:28352
  s_waitcnt lgkmcnt(8)
  v_mfma_f32_32x32x16_bf16 a[64:79], a[176:179], v[64:67], a[64:79]
  ds_read_b64_tr_b16 a[164:165], v15 offset:25856
  v_mfma_f32_32x32x16_bf16 a[144:159], a[176:179], v[68:71], a[144:159]
  ds_read_b64_tr_b16 a[166:167], v15 offset:28416
  s_waitcnt lgkmcnt(8)
  s_waitcnt vmcnt(18)
  v_mfma_f32_32x32x16_bf16 a[0:15], a[180:183], v[72:75], a[0:15]
  ds_read_b64_tr_b16 a[168:169], v15 offset:30720
  s_waitcnt vmcnt(17)
  v_mfma_f32_32x32x16_bf16 a[80:95], a[180:183], v[76:79], a[80:95]
  ds_read_b64_tr_b16 a[170:171], v15 offset:33280
  s_waitcnt lgkmcnt(8)
  v_mfma_f32_32x32x16_bf16 a[16:31], a[184:187], v[72:75], a[16:31]
  ds_read_b64_tr_b16 a[172:173], v15 offset:30784
  v_mfma_f32_32x32x16_bf16 a[96:111], a[184:187], v[76:79], a[96:111]
  ds_read_b64_tr_b16 a[174:175], v15 offset:33344
  s_waitcnt lgkmcnt(8)
  v_mfma_f32_32x32x16_bf16 a[32:47], a[188:191], v[72:75], a[32:47]
  ds_read_b64_tr_b16 a[176:177], v15 offset:30848
  v_mfma_f32_32x32x16_bf16 a[112:127], a[188:191], v[76:79], a[112:127]
  ds_read_b64_tr_b16 a[178:179], v15 offset:33408
  s_waitcnt lgkmcnt(8)
  v_mfma_f32_32x32x16_bf16 a[48:63], a[160:163], v[72:75], a[48:63]
  ds_read_b64_tr_b16 a[180:181], v15 offset:30912
  v_mfma_f32_32x32x16_bf16 a[128:143], a[160:163], v[76:79], a[128:143]
  ds_read_b64_tr_b16 a[182:183], v15 offset:33472
  s_waitcnt lgkmcnt(8)
  v_mfma_f32_32x32x16_bf16 a[64:79], a[164:167], v[72:75], a[64:79]
  ds_read_b64_tr_b16 a[184:185], v15 offset:30976
  v_mfma_f32_32x32x16_bf16 a[144:159], a[164:167], v[76:79], a[144:159]
  ds_read_b64_tr_b16 a[186:187], v15 offset:33536
  s_waitcnt lgkmcnt(8)
  s_waitcnt vmcnt(16)
  v_mfma_f32_32x32x16_bf16 a[0:15], a[168:171], v[80:83], a[0:15]
  ds_read_b64_tr_b16 a[188:189], v15 offset:35840
  s_waitcnt vmcnt(15)
  v_mfma_f32_32x32x16_bf16 a[80:95], a[168:171], v[84:87], a[80:95]
  ds_read_b64_tr_b16 a[190:191], v15 offset:38400
  s_waitcnt lgkmcnt(8)
  v_mfma_f32_32x32x16_bf16 a[16:31], a[172:175], v[80:83], a[16:31]
  ds_read_b64_tr_b16 a[160:161], v15 offset:35904
  v_mfma_f32_32x32x16_bf16 a[96:111], a[172:175], v[84:87], a[96:111]
  ds_read_b64_tr_b16 a[162:163], v15 offset:38464
  s_waitcnt lgkmcnt(8)
  v_mfma_f32_32x32x16_bf16 a[32:47], a[176:179], v[80:83], a[32:47]
  ds_read_b64_tr_b16 a[164:165], v15 offset:35968
  v_mfma_f32_32x32x16_bf16 a[112:127], a[176:179], v[84:87], a[112:127]
  ds_read_b64_tr_b16 a[166:167], v15 offset:38528
  s_waitcnt lgkmcnt(8)
  v_mfma_f32_32x32x16_bf16 a[48:63], a[180:183], v[80:83], a[48:63]
  ds_read_b64_tr_b16 a[168:169], v15 offset:36032
  v_mfma_f32_32x32x16_bf16 a[128:143], a[180:183], v[84:87], a[128:143]
  ds_read_b64_tr_b16 a[170:171], v15 offset:38592
  s_waitcnt lgkmcnt(8)
  v_mfma_f32_32x32x16_bf16 a[64:79], a[184:187], v[80:83], a[64:79]
  ds_read_b64_tr_b16 a[172:173], v15 offset:36096
  v_mfma_f32_32x32x16_bf16 a[144:159], a[184:187], v[84:87], a[144:159]
  ds_read_b64_tr_b16 a[174:175], v15 offset:38656
  s_waitcnt vmcnt(8)
  s_barrier
  s_waitcnt lgkmcnt(8)
  v_mfma_f32_32x32x16_bf16 a[0:15], a[188:191], v[88:91], a[0:15]
  ds_read_b64_tr_b16 a[176:177], v15 offset:40960
  v_mfma_f32_32x32x16_bf16 a[80:95], a[188:191], v[92:95], a[80:95]
  ds_read_b64_tr_b16 a[178:179], v15 offset:43520
  s_waitcnt lgkmcnt(8)
  v_mfma_f32_32x32x16_bf16 a[16:31], a[160:163], v[88:91], a[16:31]
  ds_read_b64_tr_b16 a[180:181], v15 offset:41024
  v_mfma_f32_32x32x16_bf16 a[96:111], a[160:163], v[92:95], a[96:111]
  ds_read_b64_tr_b16 a[182:183], v15 offset:43584
  s_waitcnt lgkmcnt(8)
  v_mfma_f32_32x32x16_bf16 a[32:47], a[164:167], v[88:91], a[32:47]
  ds_read_b64_tr_b16 a[184:185], v15 offset:41088
  v_mfma_f32_32x32x16_bf16 a[112:127], a[164:167], v[92:95], a[112:127]
  ds_read_b64_tr_b16 a[186:187], v15 offset:43648
  s_waitcnt lgkmcnt(8)
  v_mfma_f32_32x32x16_bf16 a[48:63], a[168:171], v[88:91], a[48:63]
  ds_read_b64_tr_b16 a[188:189], v15 offset:41152
  v_mfma_f32_32x32x16_bf16 a[128:143], a[168:171], v[92:95], a[128:143]
  ds_read_b64_tr_b16 a[190:191], v15 offset:43712
  s_waitcnt lgkmcnt(8)
  v_mfma_f32_32x32x16_bf16 a[64:79], a[172:175], v[88:91], a[64:79]
  ds_read_b64_tr_b16 a[160:161], v15 offset:41216
  v_mfma_f32_32x32x16_bf16 a[144:159], a[172:175], v[92:95], a[144:159]
  ds_read_b64_tr_b16 a[162:163], v15 offset:43776
  s_waitcnt lgkmcnt(8)
  s_waitcnt vmcnt(7)
  v_mfma_f32_32x32x16_bf16 a[0:15], a[176:179], v[96:99], a[0:15]
  ds_read_b64_tr_b16 a[164:165], v15 offset:46080
  s_waitcnt vmcnt(6)
  v_mfma_f32_32x32x16_bf16 a[80:95], a[176:179], v[100:103], a[80:95]
  ds_read_b64_tr_b16 a[166:167], v15 offset:48640
  s_waitcnt lgkmcnt(8)
  v_mfma_f32_32x32x16_bf16 a[16:31], a[180:183], v[96:99], a[16:31]
  ds_read_b64_tr_b16 a[168:169], v15 offset:46144
  v_mfma_f32_32x32x16_bf16 a[96:111], a[180:183], v[100:103], a[96:111]
  ds_read_b64_tr_b16 a[170:171], v15 offset:48704
  s_waitcnt lgkmcnt(8)
  v_mfma_f32_32x32x16_bf16 a[32:47], a[184:187], v[96:99], a[32:47]
  ds_read_b64_tr_b16 a[172:173], v15 offset:46208
  v_mfma_f32_32x32x16_bf16 a[112:127], a[184:187], v[100:103], a[112:127]
  ds_read_b64_tr_b16 a[174:175], v15 offset:48768
  s_waitcnt lgkmcnt(8)
  v_mfma_f32_32x32x16_bf16 a[48:63], a[188:191], v[96:99], a[48:63]
  ds_read_b64_tr_b16 a[176:177], v15 offset:46272
  v_mfma_f32_32x32x16_bf16 a[128:143], a[188:191], v[100:103], a[128:143]
  ds_read_b64_tr_b16 a[178:179], v15 offset:48832
  s_waitcnt lgkmcnt(8)
  v_mfma_f32_32x32x16_bf16 a[64:79], a[160:163], v[96:99], a[64:79]
  ds_read_b64_tr_b16 a[180:181], v15 offset:46336
  v_mfma_f32_32x32x16_bf16 a[144:159], a[160:163], v[100:103], a[144:159]
  ds_read_b64_tr_b16 a[182:183], v15 offset:48896
  s_waitcnt lgkmcnt(8)
  s_waitcnt vmcnt(5)
  v_mfma_f32_32x32x16_bf16 a[0:15], a[164:167], v[104:107], a[0:15]
  ds_read_b64_tr_b16 a[184:185], v15 offset:51200
  s_waitcnt vmcnt(4)
  v_mfma_f32_32x32x16_bf16 a[80:95], a[164:167], v[108:111], a[80:95]
  ds_read_b64_tr_b16 a[186:187], v15 offset:53760
  s_waitcnt lgkmcnt(8)
  v_mfma_f32_32x32x16_bf16 a[16:31], a[168:171], v[104:107], a[16:31]
  ds_read_b64_tr_b16 a[188:189], v15 offset:51264
  v_mfma_f32_32x32x16_bf16 a[96:111], a[168:171], v[108:111], a[96:111]
  ds_read_b64_tr_b16 a[190:191], v15 offset:53824
  s_waitcnt lgkmcnt(8)
  v_mfma_f32_32x32x16_bf16 a[32:47], a[172:175], v[104:107], a[32:47]
  ds_read_b64_tr_b16 a[160:161], v15 offset:51328
  v_mfma_f32_32x32x16_bf16 a[112:127], a[172:175], v[108:111], a[112:127]
  ds_read_b64_tr_b16 a[162:163], v15 offset:53888
  s_waitcnt lgkmcnt(8)
  v_mfma_f32_32x32x16_bf16 a[48:63], a[176:179], v[104:107], a[48:63]
  ds_read_b64_tr_b16 a[164:165], v15 offset:51392
  v_mfma_f32_32x32x16_bf16 a[128:143], a[176:179], v[108:111], a[128:143]
  ds_read_b64_tr_b16 a[166:167], v15 offset:53952
  s_waitcnt lgkmcnt(8)
  v_mfma_f32_32x32x16_bf16 a[64:79], a[180:183], v[104:107], a[64:79]
  ds_read_b64_tr_b16 a[168:169], v15 offset:51456
  v_mfma_f32_32x32x16_bf16 a[144:159], a[180:183], v[108:111], a[144:159]
  ds_read_b64_tr_b16 a[170:171], v15 offset:54016
  s_waitcnt lgkmcnt(8)
  s_waitcnt vmcnt(3)
  v_mfma_f32_32x32x16_bf16 a[0:15], a[184:187], v[112:115], a[0:15]
  ds_read_b64_tr_b16 a[172:173], v15 offset:56320
  s_waitcnt vmcnt(2)
  v_mfma_f32_32x32x16_bf16 a[80:95], a[184:187], v[116:119], a[80:95]
  ds_read_b64_tr_b16 a[174:175], v15 offset:58880
  s_waitcnt lgkmcnt(8)
  v_mfma_f32_32x32x16_bf16 a[16:31], a[188:191], v[112:115], a[16:31]
  ds_read_b64_tr_b16 a[176:177], v15 offset:56384
  v_mfma_f32_32x32x16_bf16 a[96:111], a[188:191], v[116:119], a[96:111]
  ds_read_b64_tr_b16 a[178:179], v15 offset:58944
  s_waitcnt lgkmcnt(8)
  v_mfma_f32_32x32x16_bf16 a[32:47], a[160:163], v[112:115], a[32:47]
  ds_read_b64_tr_b16 a[180:181], v15 offset:56448
  v_mfma_f32_32x32x16_bf16 a[112:127], a[160:163], v[116:119], a[112:127]
  ds_read_b64_tr_b16 a[182:183], v15 offset:59008
  s_waitcnt lgkmcnt(8)
  v_mfma_f32_32x32x16_bf16 a[48:63], a[164:167], v[112:115], a[48:63]
  ds_read_b64_tr_b16 a[184:185], v15 offset:56512
  v_mfma_f32_32x32x16_bf16 a[128:143], a[164:167], v[116:119], a[128:143]
  ds_read_b64_tr_b16 a[186:187], v15 offset:59072
  s_waitcnt lgkmcnt(8)
  v_mfma_f32_32x32x16_bf16 a[64:79], a[168:171], v[112:115], a[64:79]
  ds_read_b64_tr_b16 a[188:189], v15 offset:56576
  v_mfma_f32_32x32x16_bf16 a[144:159], a[168:171], v[116:119], a[144:159]
  ds_read_b64_tr_b16 a[190:191], v15 offset:59136
  s_waitcnt lgkmcnt(8)
  s_waitcnt vmcnt(1)
  v_mfma_f32_32x32x16_bf16 a[0:15], a[172:175], v[120:123], a[0:15]
  s_waitcnt vmcnt(0)
  v_mfma_f32_32x32x16_bf16 a[80:95], a[172:175], v[124:127], a[80:95]
  s_waitcnt lgkmcnt(6)
  v_mfma_f32_32x32x16_bf16 a[16:31], a[176:179], v[120:123], a[16:31]
  v_mfma_f32_32x32x16_bf16 a[96:111], a[176:179], v[124:127], a[96:111]
  s_waitcnt lgkmcnt(4)
  v_mfma_f32_32x32x16_bf16 a[32:47], a[180:183], v[120:123], a[32:47]
  v_mfma_f32_32x32x16_bf16 a[112:127], a[180:183], v[124:127], a[112:127]
  s_waitcnt lgkmcnt(2)
  v_mfma_f32_32x32x16_bf16 a[48:63], a[184:187], v[120:123], a[48:63]
  v_mfma_f32_32x32x16_bf16 a[128:143], a[184:187], v[124:127], a[128:143]
  s_waitcnt lgkmcnt(0)
  v_mfma_f32_32x32x16_bf16 a[64:79], a[188:191], v[120:123], a[64:79]
  v_mfma_f32_32x32x16_bf16 a[144:159], a[188:191], v[124:127], a[144:159]
  s_nop 15
  v_lshlrev_b32 v16, 4, v1
  s_lshl_b32 s36, s29, 6
  s_lshl_b32 s37, s27, 3
  s_add_u32 s36, s36, s37
  s_lshl_b32 s37, s24, 1
  s_add_u32 s36, s36, s37
  s_mul_i32 s36, s36, 20
  s_mul_i32 s37, s28, 5
  s_add_u32 s36, s36, s37
  s_lshl_b32 s38, s36, 11
  s_add_u32 s39, s38, 0
  v_accvgpr_read_b32 v64, a0
  v_accvgpr_read_b32 v65, a1
  v_accvgpr_read_b32 v66, a2
  v_accvgpr_read_b32 v67, a3
  v_accvgpr_read_b32 v68, a4
  v_accvgpr_read_b32 v69, a5
  v_accvgpr_read_b32 v70, a6
  v_accvgpr_read_b32 v71, a7
  v_cvt_pk_bf16_f32 v72, v64, v65
  v_cvt_pk_bf16_f32 v73, v66, v67
  v_cvt_pk_bf16_f32 v74, v68, v69
  v_cvt_pk_bf16_f32 v75, v70, v71
  buffer_store_dwordx4 v[72:75], v16, s[12:15], s39 offen offset:0 sc1
  v_accvgpr_read_b32 v76, a8
  v_accvgpr_read_b32 v77, a9
  v_accvgpr_read_b32 v78, a10
  v_accvgpr_read_b32 v79, a11
  v_accvgpr_read_b32 v80, a12
  v_accvgpr_read_b32 v81, a13
  v_accvgpr_read_b32 v82, a14
  v_accvgpr_read_b32 v83, a15
  v_cvt_pk_bf16_f32 v84, v76, v77
  v_cvt_pk_bf16_f32 v85, v78, v79
  v_cvt_pk_bf16_f32 v86, v80, v81
  v_cvt_pk_bf16_f32 v87, v82, v83
  buffer_store_dwordx4 v[84:87], v16, s[12:15], s39 offen offset:1024 sc1
  s_add_u32 s39, s38, 2048
  v_accvgpr_read_b32 v88, a16
  v_accvgpr_read_b32 v89, a17
  v_accvgpr_read_b32 v90, a18
  v_accvgpr_read_b32 v91, a19
  v_accvgpr_read_b32 v92, a20
  v_accvgpr_read_b32 v93, a21
  v_accvgpr_read_b32 v94, a22
  v_accvgpr_read_b32 v95, a23
  v_cvt_pk_bf16_f32 v96, v88, v89
  v_cvt_pk_bf16_f32 v97, v90, v91
  v_cvt_pk_bf16_f32 v98, v92, v93
  v_cvt_pk_bf16_f32 v99, v94, v95
  buffer_store_dwordx4 v[96:99], v16, s[12:15], s39 offen offset:0 sc1
  v_accvgpr_read_b32 v100, a24
  v_accvgpr_read_b32 v101, a25
  v_accvgpr_read_b32 v102, a26
  v_accvgpr_read_b32 v103, a27
  v_accvgpr_read_b32 v104, a28
  v_accvgpr_read_b32 v105, a29
  v_accvgpr_read_b32 v106, a30
  v_accvgpr_read_b32 v107, a31
  v_cvt_pk_bf16_f32 v108, v100, v101
  v_cvt_pk_bf16_f32 v109, v102, v103
  v_cvt_pk_bf16_f32 v110, v104, v105
  v_cvt_pk_bf16_f32 v111, v106, v107
  buffer_store_dwordx4 v[108:111], v16, s[12:15], s39 offen offset:1024 sc1
  s_add_u32 s39, s38, 4096
  v_accvgpr_read_b32 v112, a32
  v_accvgpr_read_b32 v113, a33
  v_accvgpr_read_b32 v114, a34
  v_accvgpr_read_b32 v115, a35
  v_accvgpr_read_b32 v116, a36
  v_accvgpr_read_b32 v117, a37
  v_accvgpr_read_b32 v118, a38
  v_accvgpr_read_b32 v119, a39
  v_cvt_pk_bf16_f32 v120, v112, v113
  v_cvt_pk_bf16_f32 v121, v114, v115
  v_cvt_pk_bf16_f32 v122, v116, v117
  v_cvt_pk_bf16_f32 v123, v118, v119
  buffer_store_dwordx4 v[120:123], v16, s[12:15], s39 offen offset:0 sc1
  v_accvgpr_read_b32 v124, a40
  v_accvgpr_read_b32 v125, a41
  v_accvgpr_read_b32 v126, a42
  v_accvgpr_read_b32 v127, a43
  v_accvgpr_read_b32 v128, a44
  v_accvgpr_read_b32 v129, a45
  v_accvgpr_read_b32 v130, a46
  v_accvgpr_read_b32 v131, a47
  v_cvt_pk_bf16_f32 v132, v124, v125
  v_cvt_pk_bf16_f32 v133, v126, v127
  v_cvt_pk_bf16_f32 v134, v128, v129
  v_cvt_pk_bf16_f32 v135, v130, v131
  buffer_store_dwordx4 v[132:135], v16, s[12:15], s39 offen offset:1024 sc1
  s_add_u32 s39, s38, 6144
  v_accvgpr_read_b32 v136, a48
  v_accvgpr_read_b32 v137, a49
  v_accvgpr_read_b32 v138, a50
  v_accvgpr_read_b32 v139, a51
  v_accvgpr_read_b32 v140, a52
  v_accvgpr_read_b32 v141, a53
  v_accvgpr_read_b32 v142, a54
  v_accvgpr_read_b32 v143, a55
  v_cvt_pk_bf16_f32 v144, v136, v137
  v_cvt_pk_bf16_f32 v145, v138, v139
  v_cvt_pk_bf16_f32 v146, v140, v141
  v_cvt_pk_bf16_f32 v147, v142, v143
  buffer_store_dwordx4 v[144:147], v16, s[12:15], s39 offen offset:0 sc1
  v_accvgpr_read_b32 v148, a56
  v_accvgpr_read_b32 v149, a57
  v_accvgpr_read_b32 v150, a58
  v_accvgpr_read_b32 v151, a59
  v_accvgpr_read_b32 v152, a60
  v_accvgpr_read_b32 v153, a61
  v_accvgpr_read_b32 v154, a62
  v_accvgpr_read_b32 v155, a63
  v_cvt_pk_bf16_f32 v156, v148, v149
  v_cvt_pk_bf16_f32 v157, v150, v151
  v_cvt_pk_bf16_f32 v158, v152, v153
  v_cvt_pk_bf16_f32 v159, v154, v155
  buffer_store_dwordx4 v[156:159], v16, s[12:15], s39 offen offset:1024 sc1
  s_add_u32 s39, s38, 8192
  v_accvgpr_read_b32 v160, a64
  v_accvgpr_read_b32 v161, a65
  v_accvgpr_read_b32 v162, a66
  v_accvgpr_read_b32 v163, a67
  v_accvgpr_read_b32 v164, a68
  v_accvgpr_read_b32 v165, a69
  v_accvgpr_read_b32 v166, a70
  v_accvgpr_read_b32 v167, a71
  v_cvt_pk_bf16_f32 v168, v160, v161
  v_cvt_pk_bf16_f32 v169, v162, v163
  v_cvt_pk_bf16_f32 v170, v164, v165
  v_cvt_pk_bf16_f32 v171, v166, v167
  buffer_store_dwordx4 v[168:171], v16, s[12:15], s39 offen offset:0 sc1
  v_accvgpr_read_b32 v172, a72
  v_accvgpr_read_b32 v173, a73
  v_accvgpr_read_b32 v174, a74
  v_accvgpr_read_b32 v175, a75
  v_accvgpr_read_b32 v176, a76
  v_accvgpr_read_b32 v177, a77
  v_accvgpr_read_b32 v178, a78
  v_accvgpr_read_b32 v179, a79
  v_cvt_pk_bf16_f32 v180, v172, v173
  v_cvt_pk_bf16_f32 v181, v174, v175
  v_cvt_pk_bf16_f32 v182, v176, v177
  v_cvt_pk_bf16_f32 v183, v178, v179
  buffer_store_dwordx4 v[180:183], v16, s[12:15], s39 offen offset:1024 sc1
  s_add_u32 s39, s38, 40960
  v_accvgpr_read_b32 v184, a80
  v_accvgpr_read_b32 v185, a81
  v_accvgpr_read_b32 v186, a82
  v_accvgpr_read_b32 v187, a83
  v_accvgpr_read_b32 v188, a84
  v_accvgpr_read_b32 v189, a85
  v_accvgpr_read_b32 v190, a86
  v_accvgpr_read_b32 v191, a87
  v_cvt_pk_bf16_f32 v192, v184, v185
  v_cvt_pk_bf16_f32 v193, v186, v187
  v_cvt_pk_bf16_f32 v194, v188, v189
  v_cvt_pk_bf16_f32 v195, v190, v191
  buffer_store_dwordx4 v[192:195], v16, s[12:15], s39 offen offset:0 sc1
  v_accvgpr_read_b32 v196, a88
  v_accvgpr_read_b32 v197, a89
  v_accvgpr_read_b32 v198, a90
  v_accvgpr_read_b32 v199, a91
  v_accvgpr_read_b32 v200, a92
  v_accvgpr_read_b32 v201, a93
  v_accvgpr_read_b32 v202, a94
  v_accvgpr_read_b32 v203, a95
  v_cvt_pk_bf16_f32 v204, v196, v197
  v_cvt_pk_bf16_f32 v205, v198, v199
  v_cvt_pk_bf16_f32 v206, v200, v201
  v_cvt_pk_bf16_f32 v207, v202, v203
  buffer_store_dwordx4 v[204:207], v16, s[12:15], s39 offen offset:1024 sc1
  s_add_u32 s39, s38, 43008
  v_accvgpr_read_b32 v64, a96
  v_accvgpr_read_b32 v65, a97
  v_accvgpr_read_b32 v66, a98
  v_accvgpr_read_b32 v67, a99
  v_accvgpr_read_b32 v68, a100
  v_accvgpr_read_b32 v69, a101
  v_accvgpr_read_b32 v70, a102
  v_accvgpr_read_b32 v71, a103
  v_cvt_pk_bf16_f32 v72, v64, v65
  v_cvt_pk_bf16_f32 v73, v66, v67
  v_cvt_pk_bf16_f32 v74, v68, v69
  v_cvt_pk_bf16_f32 v75, v70, v71
  buffer_store_dwordx4 v[72:75], v16, s[12:15], s39 offen offset:0 sc1
  v_accvgpr_read_b32 v76, a104
  v_accvgpr_read_b32 v77, a105
  v_accvgpr_read_b32 v78, a106
  v_accvgpr_read_b32 v79, a107
  v_accvgpr_read_b32 v80, a108
  v_accvgpr_read_b32 v81, a109
  v_accvgpr_read_b32 v82, a110
  v_accvgpr_read_b32 v83, a111
  v_cvt_pk_bf16_f32 v84, v76, v77
  v_cvt_pk_bf16_f32 v85, v78, v79
  v_cvt_pk_bf16_f32 v86, v80, v81
  v_cvt_pk_bf16_f32 v87, v82, v83
  buffer_store_dwordx4 v[84:87], v16, s[12:15], s39 offen offset:1024 sc1
  s_add_u32 s39, s38, 45056
  v_accvgpr_read_b32 v88, a112
  v_accvgpr_read_b32 v89, a113
  v_accvgpr_read_b32 v90, a114
  v_accvgpr_read_b32 v91, a115
  v_accvgpr_read_b32 v92, a116
  v_accvgpr_read_b32 v93, a117
  v_accvgpr_read_b32 v94, a118
  v_accvgpr_read_b32 v95, a119
  v_cvt_pk_bf16_f32 v96, v88, v89
  v_cvt_pk_bf16_f32 v97, v90, v91
  v_cvt_pk_bf16_f32 v98, v92, v93
  v_cvt_pk_bf16_f32 v99, v94, v95
  buffer_store_dwordx4 v[96:99], v16, s[12:15], s39 offen offset:0 sc1
  v_accvgpr_read_b32 v100, a120
  v_accvgpr_read_b32 v101, a121
  v_accvgpr_read_b32 v102, a122
  v_accvgpr_read_b32 v103, a123
  v_accvgpr_read_b32 v104, a124
  v_accvgpr_read_b32 v105, a125
  v_accvgpr_read_b32 v106, a126
  v_accvgpr_read_b32 v107, a127
  v_cvt_pk_bf16_f32 v108, v100, v101
  v_cvt_pk_bf16_f32 v109, v102, v103
  v_cvt_pk_bf16_f32 v110, v104, v105
  v_cvt_pk_bf16_f32 v111, v106, v107
  buffer_store_dwordx4 v[108:111], v16, s[12:15], s39 offen offset:1024 sc1
  s_add_u32 s39, s38, 47104
  v_accvgpr_read_b32 v112, a128
  v_accvgpr_read_b32 v113, a129
  v_accvgpr_read_b32 v114, a130
  v_accvgpr_read_b32 v115, a131
  v_accvgpr_read_b32 v116, a132
  v_accvgpr_read_b32 v117, a133
  v_accvgpr_read_b32 v118, a134
  v_accvgpr_read_b32 v119, a135
  v_cvt_pk_bf16_f32 v120, v112, v113
  v_cvt_pk_bf16_f32 v121, v114, v115
  v_cvt_pk_bf16_f32 v122, v116, v117
  v_cvt_pk_bf16_f32 v123, v118, v119
  buffer_store_dwordx4 v[120:123], v16, s[12:15], s39 offen offset:0 sc1
  v_accvgpr_read_b32 v124, a136
  v_accvgpr_read_b32 v125, a137
  v_accvgpr_read_b32 v126, a138
  v_accvgpr_read_b32 v127, a139
  v_accvgpr_read_b32 v128, a140
  v_accvgpr_read_b32 v129, a141
  v_accvgpr_read_b32 v130, a142
  v_accvgpr_read_b32 v131, a143
  v_cvt_pk_bf16_f32 v132, v124, v125
  v_cvt_pk_bf16_f32 v133, v126, v127
  v_cvt_pk_bf16_f32 v134, v128, v129
  v_cvt_pk_bf16_f32 v135, v130, v131
  buffer_store_dwordx4 v[132:135], v16, s[12:15], s39 offen offset:1024 sc1
  s_add_u32 s39, s38, 49152
  v_accvgpr_read_b32 v136, a144
  v_accvgpr_read_b32 v137, a145
  v_accvgpr_read_b32 v138, a146
  v_accvgpr_read_b32 v139, a147
  v_accvgpr_read_b32 v140, a148
  v_accvgpr_read_b32 v141, a149
  v_accvgpr_read_b32 v142, a150
  v_accvgpr_read_b32 v143, a151
  v_cvt_pk_bf16_f32 v144, v136, v137
  v_cvt_pk_bf16_f32 v145, v138, v139
  v_cvt_pk_bf16_f32 v146, v140, v141
  v_cvt_pk_bf16_f32 v147, v142, v143
  buffer_store_dwordx4 v[144:147], v16, s[12:15], s39 offen offset:0 sc1
  v_accvgpr_read_b32 v148, a152
  v_accvgpr_read_b32 v149, a153
  v_accvgpr_read_b32 v150, a154
  v_accvgpr_read_b32 v151, a155
  v_accvgpr_read_b32 v152, a156
  v_accvgpr_read_b32 v153, a157
  v_accvgpr_read_b32 v154, a158
  v_accvgpr_read_b32 v155, a159
  v_cvt_pk_bf16_f32 v156, v148, v149
  v_cvt_pk_bf16_f32 v157, v150, v151
  v_cvt_pk_bf16_f32 v158, v152, v153
  v_cvt_pk_bf16_f32 v159, v154, v155
  buffer_store_dwordx4 v[156:159], v16, s[12:15], s39 offen offset:1024 sc1
L_k2_end:
  s_endpgm
.p2align 8
.type reduce_kernel,@function
reduce_kernel:
  s_cmp_ge_u32 s2, 320
  s_cbranch_scc1 L_k3_end
  s_load_dwordx2 s[40:41], s[0:1], 40
  s_load_dwordx2 s[42:43], s[0:1], 56
  v_and_b32 v1, 63, v0
  v_lshrrev_b32 v2, 6, v0
  s_nop 0
  v_readfirstlane_b32 s24, v2
  s_lshl_b32 s25, s2, 2
  s_nop 2
  s_nop 0
  s_add_u32 s25, s25, s24
  s_mul_hi_u32 s26, s25, 0xccccccd
  s_mul_i32 s27, s26, 20
  s_sub_u32 s27, s25, s27
  v_lshlrev_b32 v2, 4, v1
  s_lshl_b32 s28, s25, 11
  s_waitcnt lgkmcnt(0)
  s_mov_b32 s36, 25165824
  s_add_u32 s42, s42, s36
  s_addc_u32 s43, s43, 0
  s_mov_b32 s4, s42
  s_and_b32 s5, s43, 0xffff
  s_mov_b32 s6, 20971520
  s_mov_b32 s7, 0x20000
  s_mov_b32 s8, s40
  s_and_b32 s9, s41, 0xffff
  s_mov_b32 s10, 2621440
  s_mov_b32 s11, 0x20000
  s_add_u32 s29, s28, 0
  buffer_load_dwordx4 v[32:35], v2, s[4:7], s29 offen offset:0
  buffer_load_dwordx4 v[36:39], v2, s[4:7], s29 offen offset:1024
  s_add_u32 s29, s28, 2621440
  buffer_load_dwordx4 v[40:43], v2, s[4:7], s29 offen offset:0
  buffer_load_dwordx4 v[44:47], v2, s[4:7], s29 offen offset:1024
  s_add_u32 s29, s28, 5242880
  buffer_load_dwordx4 v[48:51], v2, s[4:7], s29 offen offset:0
  buffer_load_dwordx4 v[52:55], v2, s[4:7], s29 offen offset:1024
  s_add_u32 s29, s28, 7864320
  buffer_load_dwordx4 v[56:59], v2, s[4:7], s29 offen offset:0
  buffer_load_dwordx4 v[60:63], v2, s[4:7], s29 offen offset:1024
  s_add_u32 s29, s28, 10485760
  buffer_load_dwordx4 v[64:67], v2, s[4:7], s29 offen offset:0
  buffer_load_dwordx4 v[68:71], v2, s[4:7], s29 offen offset:1024
  s_add_u32 s29, s28, 13107200
  buffer_load_dwordx4 v[72:75], v2, s[4:7], s29 offen offset:0
  buffer_load_dwordx4 v[76:79], v2, s[4:7], s29 offen offset:1024
  s_add_u32 s29, s28, 15728640
  buffer_load_dwordx4 v[80:83], v2, s[4:7], s29 offen offset:0
  buffer_load_dwordx4 v[84:87], v2, s[4:7], s29 offen offset:1024
  s_add_u32 s29, s28, 18350080
  buffer_load_dwordx4 v[88:91], v2, s[4:7], s29 offen offset:0
  buffer_load_dwordx4 v[92:95], v2, s[4:7], s29 offen offset:1024
  v_and_b32 v3, 31, v1
  v_mul_u32_u24 v3, 1280, v3
  v_lshrrev_b32 v4, 5, v1
  v_lshlrev_b32 v4, 5, v4
  v_add_u32 v3, v3, v4
  s_mul_i32 s30, s26, 40960
  s_lshl_b32 s31, s27, 6
  s_add_u32 s30, s30, s31
  s_mov_b32 s33, 0xffff0000
  s_waitcnt vmcnt(15)
  v_lshlrev_b32 v16, 16, v32
  v_and_b32 v17, s33, v32
  v_lshlrev_b32 v18, 16, v33
  v_and_b32 v19, s33, v33
  v_lshlrev_b32 v20, 16, v34
  v_and_b32 v21, s33, v34
  v_lshlrev_b32 v22, 16, v35
  v_and_b32 v23, s33, v35
  s_waitcnt vmcnt(14)
  v_lshlrev_b32 v24, 16, v36
  v_and_b32 v25, s33, v36
  v_lshlrev_b32 v26, 16, v37
  v_and_b32 v27, s33, v37
  v_lshlrev_b32 v28, 16, v38
  v_and_b32 v29, s33, v38
  v_lshlrev_b32 v30, 16, v39
  v_and_b32 v31, s33, v39
  s_waitcnt vmcnt(13)
  v_lshlrev_b32 v5, 16, v40
  v_and_b32 v6, s33, v40
  v_add_f32 v16, v16, v5
  v_add_f32 v17, v17, v6
  v_lshlrev_b32 v5, 16, v41
  v_and_b32 v6, s33, v41
  v_add_f32 v18, v18, v5
  v_add_f32 v19, v19, v6
  v_lshlrev_b32 v5, 16, v42
  v_and_b32 v6, s33, v42
  v_add_f32 v20, v20, v5
  v_add_f32 v21, v21, v6
  v_lshlrev_b32 v5, 16, v43
  v_and_b32 v6, s33, v43
  v_add_f32 v22, v22, v5
  v_add_f32 v23, v23, v6
  s_waitcnt vmcnt(12)
  v_lshlrev_b32 v5, 16, v44
  v_and_b32 v6, s33, v44
  v_add_f32 v24, v24, v5
  v_add_f32 v25, v25, v6
  v_lshlrev_b32 v5, 16, v45
  v_and_b32 v6, s33, v45
  v_add_f32 v26, v26, v5
  v_add_f32 v27, v27, v6
  v_lshlrev_b32 v5, 16, v46
  v_and_b32 v6, s33, v46
  v_add_f32 v28, v28, v5
  v_add_f32 v29, v29, v6
  v_lshlrev_b32 v5, 16, v47
  v_and_b32 v6, s33, v47
  v_add_f32 v30, v30, v5
  v_add_f32 v31, v31, v6
  s_waitcnt vmcnt(11)
  v_lshlrev_b32 v5, 16, v48
  v_and_b32 v6, s33, v48
  v_add_f32 v16, v16, v5
  v_add_f32 v17, v17, v6
  v_lshlrev_b32 v5, 16, v49
  v_and_b32 v6, s33, v49
  v_add_f32 v18, v18, v5
  v_add_f32 v19, v19, v6
  v_lshlrev_b32 v5, 16, v50
  v_and_b32 v6, s33, v50
  v_add_f32 v20, v20, v5
  v_add_f32 v21, v21, v6
  v_lshlrev_b32 v5, 16, v51
  v_and_b32 v6, s33, v51
  v_add_f32 v22, v22, v5
  v_add_f32 v23, v23, v6
  s_waitcnt vmcnt(10)
  v_lshlrev_b32 v5, 16, v52
  v_and_b32 v6, s33, v52
  v_add_f32 v24, v24, v5
  v_add_f32 v25, v25, v6
  v_lshlrev_b32 v5, 16, v53
  v_and_b32 v6, s33, v53
  v_add_f32 v26, v26, v5
  v_add_f32 v27, v27, v6
  v_lshlrev_b32 v5, 16, v54
  v_and_b32 v6, s33, v54
  v_add_f32 v28, v28, v5
  v_add_f32 v29, v29, v6
  v_lshlrev_b32 v5, 16, v55
  v_and_b32 v6, s33, v55
  v_add_f32 v30, v30, v5
  v_add_f32 v31, v31, v6
  s_waitcnt vmcnt(9)
  v_lshlrev_b32 v5, 16, v56
  v_and_b32 v6, s33, v56
  v_add_f32 v16, v16, v5
  v_add_f32 v17, v17, v6
  v_lshlrev_b32 v5, 16, v57
  v_and_b32 v6, s33, v57
  v_add_f32 v18, v18, v5
  v_add_f32 v19, v19, v6
  v_lshlrev_b32 v5, 16, v58
  v_and_b32 v6, s33, v58
  v_add_f32 v20, v20, v5
  v_add_f32 v21, v21, v6
  v_lshlrev_b32 v5, 16, v59
  v_and_b32 v6, s33, v59
  v_add_f32 v22, v22, v5
  v_add_f32 v23, v23, v6
  s_waitcnt vmcnt(8)
  v_lshlrev_b32 v5, 16, v60
  v_and_b32 v6, s33, v60
  v_add_f32 v24, v24, v5
  v_add_f32 v25, v25, v6
  v_lshlrev_b32 v5, 16, v61
  v_and_b32 v6, s33, v61
  v_add_f32 v26, v26, v5
  v_add_f32 v27, v27, v6
  v_lshlrev_b32 v5, 16, v62
  v_and_b32 v6, s33, v62
  v_add_f32 v28, v28, v5
  v_add_f32 v29, v29, v6
  v_lshlrev_b32 v5, 16, v63
  v_and_b32 v6, s33, v63
  v_add_f32 v30, v30, v5
  v_add_f32 v31, v31, v6
  s_waitcnt vmcnt(7)
  v_lshlrev_b32 v5, 16, v64
  v_and_b32 v6, s33, v64
  v_add_f32 v16, v16, v5
  v_add_f32 v17, v17, v6
  v_lshlrev_b32 v5, 16, v65
  v_and_b32 v6, s33, v65
  v_add_f32 v18, v18, v5
  v_add_f32 v19, v19, v6
  v_lshlrev_b32 v5, 16, v66
  v_and_b32 v6, s33, v66
  v_add_f32 v20, v20, v5
  v_add_f32 v21, v21, v6
  v_lshlrev_b32 v5, 16, v67
  v_and_b32 v6, s33, v67
  v_add_f32 v22, v22, v5
  v_add_f32 v23, v23, v6
  s_waitcnt vmcnt(6)
  v_lshlrev_b32 v5, 16, v68
  v_and_b32 v6, s33, v68
  v_add_f32 v24, v24, v5
  v_add_f32 v25, v25, v6
  v_lshlrev_b32 v5, 16, v69
  v_and_b32 v6, s33, v69
  v_add_f32 v26, v26, v5
  v_add_f32 v27, v27, v6
  v_lshlrev_b32 v5, 16, v70
  v_and_b32 v6, s33, v70
  v_add_f32 v28, v28, v5
  v_add_f32 v29, v29, v6
  v_lshlrev_b32 v5, 16, v71
  v_and_b32 v6, s33, v71
  v_add_f32 v30, v30, v5
  v_add_f32 v31, v31, v6
  s_waitcnt vmcnt(5)
  v_lshlrev_b32 v5, 16, v72
  v_and_b32 v6, s33, v72
  v_add_f32 v16, v16, v5
  v_add_f32 v17, v17, v6
  v_lshlrev_b32 v5, 16, v73
  v_and_b32 v6, s33, v73
  v_add_f32 v18, v18, v5
  v_add_f32 v19, v19, v6
  v_lshlrev_b32 v5, 16, v74
  v_and_b32 v6, s33, v74
  v_add_f32 v20, v20, v5
  v_add_f32 v21, v21, v6
  v_lshlrev_b32 v5, 16, v75
  v_and_b32 v6, s33, v75
  v_add_f32 v22, v22, v5
  v_add_f32 v23, v23, v6
  s_waitcnt vmcnt(4)
  v_lshlrev_b32 v5, 16, v76
  v_and_b32 v6, s33, v76
  v_add_f32 v24, v24, v5
  v_add_f32 v25, v25, v6
  v_lshlrev_b32 v5, 16, v77
  v_and_b32 v6, s33, v77
  v_add_f32 v26, v26, v5
  v_add_f32 v27, v27, v6
  v_lshlrev_b32 v5, 16, v78
  v_and_b32 v6, s33, v78
  v_add_f32 v28, v28, v5
  v_add_f32 v29, v29, v6
  v_lshlrev_b32 v5, 16, v79
  v_and_b32 v6, s33, v79
  v_add_f32 v30, v30, v5
  v_add_f32 v31, v31, v6
  s_waitcnt vmcnt(3)
  v_lshlrev_b32 v5, 16, v80
  v_and_b32 v6, s33, v80
  v_add_f32 v16, v16, v5
  v_add_f32 v17, v17, v6
  v_lshlrev_b32 v5, 16, v81
  v_and_b32 v6, s33, v81
  v_add_f32 v18, v18, v5
  v_add_f32 v19, v19, v6
  v_lshlrev_b32 v5, 16, v82
  v_and_b32 v6, s33, v82
  v_add_f32 v20, v20, v5
  v_add_f32 v21, v21, v6
  v_lshlrev_b32 v5, 16, v83
  v_and_b32 v6, s33, v83
  v_add_f32 v22, v22, v5
  v_add_f32 v23, v23, v6
  s_waitcnt vmcnt(2)
  v_lshlrev_b32 v5, 16, v84
  v_and_b32 v6, s33, v84
  v_add_f32 v24, v24, v5
  v_add_f32 v25, v25, v6
  v_lshlrev_b32 v5, 16, v85
  v_and_b32 v6, s33, v85
  v_add_f32 v26, v26, v5
  v_add_f32 v27, v27, v6
  v_lshlrev_b32 v5, 16, v86
  v_and_b32 v6, s33, v86
  v_add_f32 v28, v28, v5
  v_add_f32 v29, v29, v6
  v_lshlrev_b32 v5, 16, v87
  v_and_b32 v6, s33, v87
  v_add_f32 v30, v30, v5
  v_add_f32 v31, v31, v6
  s_waitcnt vmcnt(1)
  v_lshlrev_b32 v5, 16, v88
  v_and_b32 v6, s33, v88
  v_add_f32 v16, v16, v5
  v_add_f32 v17, v17, v6
  v_lshlrev_b32 v5, 16, v89
  v_and_b32 v6, s33, v89
  v_add_f32 v18, v18, v5
  v_add_f32 v19, v19, v6
  v_lshlrev_b32 v5, 16, v90
  v_and_b32 v6, s33, v90
  v_add_f32 v20, v20, v5
  v_add_f32 v21, v21, v6
  v_lshlrev_b32 v5, 16, v91
  v_and_b32 v6, s33, v91
  v_add_f32 v22, v22, v5
  v_add_f32 v23, v23, v6
  s_waitcnt vmcnt(0)
  v_lshlrev_b32 v5, 16, v92
  v_and_b32 v6, s33, v92
  v_add_f32 v24, v24, v5
  v_add_f32 v25, v25, v6
  v_lshlrev_b32 v5, 16, v93
  v_and_b32 v6, s33, v93
  v_add_f32 v26, v26, v5
  v_add_f32 v27, v27, v6
  v_lshlrev_b32 v5, 16, v94
  v_and_b32 v6, s33, v94
  v_add_f32 v28, v28, v5
  v_add_f32 v29, v29, v6
  v_lshlrev_b32 v5, 16, v95
  v_and_b32 v6, s33, v95
  v_add_f32 v30, v30, v5
  v_add_f32 v31, v31, v6
  v_cvt_pk_bf16_f32 v8, v16, v17
  v_cvt_pk_bf16_f32 v9, v18, v19
  v_cvt_pk_bf16_f32 v10, v20, v21
  v_cvt_pk_bf16_f32 v11, v22, v23
  v_cvt_pk_bf16_f32 v12, v24, v25
  v_cvt_pk_bf16_f32 v13, v26, v27
  v_cvt_pk_bf16_f32 v14, v28, v29
  v_cvt_pk_bf16_f32 v15, v30, v31
  buffer_store_dwordx4 v[8:11], v3, s[8:11], s30 offen offset:0
  buffer_store_dwordx4 v[12:15], v3, s[8:11], s30 offen offset:16
L_k3_end:
  s_endpgm
.section .rodata,"a"
.p2align 6
.amdhsa_kernel attn_kernel
  .amdhsa_next_free_vgpr 512
  .amdhsa_next_free_sgpr 64
  .amdhsa_accum_offset 256
  .amdhsa_group_segment_fixed_size 0
  .amdhsa_kernarg_size 64
  .amdhsa_user_sgpr_count 2
  .amdhsa_user_sgpr_kernarg_segment_ptr 1
  .amdhsa_system_sgpr_workgroup_id_x 1
.end_amdhsa_kernel
.p2align 6
.amdhsa_kernel oproj_kernel
  .amdhsa_next_free_vgpr 512
  .amdhsa_next_free_sgpr 64
  .amdhsa_accum_offset 256
  .amdhsa_group_segment_fixed_size 0
  .amdhsa_kernarg_size 64
  .amdhsa_user_sgpr_count 2
  .amdhsa_user_sgpr_kernarg_segment_ptr 1
  .amdhsa_system_sgpr_workgroup_id_x 1
.end_amdhsa_kernel
.p2align 6
.amdhsa_kernel reduce_kernel
  .amdhsa_next_free_vgpr 96
  .amdhsa_next_free_sgpr 48
  .amdhsa_accum_offset 96
  .amdhsa_group_segment_fixed_size 0
  .amdhsa_kernarg_size 64
  .amdhsa_user_sgpr_count 2
  .amdhsa_user_sgpr_kernarg_segment_ptr 1
  .amdhsa_system_sgpr_workgroup_id_x 1
.end_amdhsa_kernel
```
